```python
import torch

def _softmax(x, axis=-1):
    return torch.softmax(x, dim=axis)
def _gelu(x):
    return torch.nn.functional.gelu(x, approximate="tanh")
def _silu(x):
    return torch.nn.functional.silu(x)
def _sigmoid(x):
    return torch.sigmoid(x)
def _layernorm(x, axis=-1, eps=1e-5):
    m = x.mean(dim=axis, keepdim=True)
    v = x.var(dim=axis, keepdim=True, unbiased=False)
    return (x - m) / torch.sqrt(v + eps)
def _scatter_add(tgt, idx, src, axis=0):
    return tgt.clone().index_add_(axis, idx, src)
def _segment_sum(src, seg, n):
    out = torch.zeros((n,) + src.shape[1:], dtype=src.dtype)
    return out.index_add_(0, seg, src)
def _pad(x, pw):
    flat = tuple(v for pair in reversed(pw) for v in pair)
    return torch.nn.functional.pad(x, flat)

kernel_name = 'concat_heads__mha_block__ssm_conv_s5__prompt'

def setup_inputs():

    _w = (lambda a: (lambda t: t.to(torch.bfloat16) if t.is_floating_point() else t)(torch.as_tensor(a)))
    def _A_setup():
        B, S, D, H = 1, 2048, 640, 32
        return {
            "x": _w((lambda *s: torch.randn(*s, dtype=torch.bfloat16) * 0.2)(B, S, D)),
            "wqkv": _w((lambda *s: torch.randn(*s, dtype=torch.bfloat16) * 0.2)(D, 3 * D)),
            "wo": _w((lambda *s: torch.randn(*s, dtype=torch.bfloat16) * 0.05)(D, D)),
        }
    _A_in = _A_setup()

    def _B_setup():
        B, S, D = 1, 2048, 640
        P = D
        Lambda_re = -0.5 * (lambda _x: torch.exp(torch.as_tensor(_x)))((lambda *s: torch.randn(*s, dtype=torch.bfloat16) * 0.8)(P))
        Lambda_im = (lambda *s: torch.randn(*s, dtype=torch.bfloat16) * 0.8)(P) * 1.0
        B_re = (lambda *s: torch.randn(*s, dtype=torch.bfloat16) * 0.8)(P, D) * (D ** -0.5)
        B_im = (lambda *s: torch.randn(*s, dtype=torch.bfloat16) * 0.8)(P, D) * (D ** -0.5)
        C_re = (lambda *s: torch.randn(*s, dtype=torch.bfloat16) * 0.8)(D, P) * (P ** -0.5)
        C_im = (lambda *s: torch.randn(*s, dtype=torch.bfloat16) * 0.8)(D, P) * (P ** -0.5)
        log_dt = (lambda *s: torch.randn(*s, dtype=torch.bfloat16) * 0.8)(P) * 0.3 - 2.0
        Dskip = (lambda *s: torch.randn(*s, dtype=torch.bfloat16) * 0.8)(D)
        return {
            "x": _w((lambda *s: torch.randn(*s, dtype=torch.bfloat16) * 0.05)(B, S, D)),
            "Lambda_re": _w(Lambda_re),
            "Lambda_im": _w(Lambda_im),
            "B_re": _w(B_re),
            "B_im": _w(B_im),
            "C_re": _w(C_re),
            "C_im": _w(C_im),
            "log_dt": _w(log_dt),
            "Dskip": _w(Dskip),
        }
    _B_in = _B_setup()

    return {
        "A_x": _A_in["x"],
        "A_wqkv": _A_in["wqkv"],
        "A_wo": _A_in["wo"],
        "B_x": _B_in["x"],
        "B_Lambda_re": _B_in["Lambda_re"],
        "B_Lambda_im": _B_in["Lambda_im"],
        "B_B_re": _B_in["B_re"],
        "B_B_im": _B_in["B_im"],
        "B_C_re": _B_in["C_re"],
        "B_C_im": _B_in["C_im"],
        "B_log_dt": _B_in["log_dt"],
        "B_Dskip": _B_in["Dskip"],
    }

def reference(A_x, A_wqkv, A_wo, B_x, B_Lambda_re, B_Lambda_im, B_B_re, B_B_im, B_C_re, B_C_im, B_log_dt, B_Dskip):
    def _A_ref(x, wqkv, wo):
        B, S, D = x.shape
        H = 32
        Dh = D // H
        qkv = (lambda x, *d: x.permute(*d))((x @ wqkv).reshape(B, S, 3, H, Dh), 2, 0, 3, 1, 4)
        q, k, v = qkv[0], qkv[1], qkv[2]
        scores = torch.einsum("bhqd,bhkd->bhqk", q, k) * (Dh ** -0.5)
        p = _softmax(scores, axis=-1)
        o = torch.einsum("bhqk,bhkd->bhqd", p, v)
        return (lambda x, *d: x.permute(*d))(o, 0, 2, 1, 3).reshape(B, S, D) @ wo

    def _B_ref(x, Lambda_re, Lambda_im, B_re, B_im, C_re, C_im, log_dt, Dskip):
        Bsz, L, H = x.shape
        Lam = Lambda_re + 1j * Lambda_im
        Bmat = B_re + 1j * B_im
        Cmat = C_re + 1j * C_im
        dt = torch.exp(log_dt)
        Lam_bar = torch.exp(dt * Lam)
        B_bar = ((Lam_bar - 1.0) / Lam)[:, None] * Bmat
        Bu = torch.einsum("bld,pd->blp", x + 0j, B_bar)
        h = torch.zeros_like(Bu[:, 0, :])
        hs = []
        for t in range(L):
            h = Lam_bar[None, :] * h + Bu[:, t, :]
            hs.append(h)
        hseq = torch.stack(hs, 1)
        y = 2.0 * torch.einsum("blp,dp->bld", hseq, Cmat).real + x * Dskip[None, None, :]
        return y

    a = _A_ref(A_x, A_wqkv, A_wo)
    b = _B_ref(B_x, B_Lambda_re, B_Lambda_im, B_B_re, B_B_im, B_C_re, B_C_im, B_log_dt, B_Dskip)
    return torch.concatenate([a, b], axis=-1)
```

```asm
; @launch grid=(256,1,1) block=(512,1,1) lds=163840
.amdgcn_target "amdgcn-amd-amdhsa--gfx950"
.text
.globl concat_heads__mha_block__ssm_conv_s5__prompt_kernel
.p2align 8
.type concat_heads__mha_block__ssm_conv_s5__prompt_kernel,@function
concat_heads__mha_block__ssm_conv_s5__prompt_kernel:
    s_cmp_ge_u32 s2, 256
    s_cbranch_scc0 L_go
    s_endpgm
L_go:
    s_load_dwordx16 s[4:19], s[0:1], 0
    s_load_dwordx8 s[20:27], s[0:1], 64
    s_load_dwordx4 s[28:31], s[0:1], 96
    s_load_dwordx2 s[32:33], s[0:1], 112
    s_lshr_b32 s35, s2, 3
    s_getpc_b64 s[76:77]
    v_lshrrev_b32 v1, 5, v0
    v_lshl_add_u32 v1, s35, 4, v1
    v_min_u32 v1, (L_codeend - L_go) / 128 - 1, v1
    v_lshlrev_b32 v1, 7, v1
    global_load_dword v149, v1, s[76:77]
    v_lshrrev_b32 v1, 6, v0
    v_and_b32 v254, 63, v0
    v_readfirstlane_b32 s34, v1
    s_and_b32 s3, s2, 7
    s_and_b32 s70, s35, 3
    s_lshr_b32 s69, s35, 2
    s_lshr_b32 s71, s3, 1
    s_lshl2_add_u32 s64, s71, s70
    s_and_b32 s71, s3, 1
    s_lshl3_add_u32 s97, s71, s69
    s_cmp_ge_u32 s35, 30
    s_cselect_b32 s71, 8, 0
    s_xor_b32 s65, s97, s71
    s_cmp_ge_u32 s34, 4
    s_cbranch_scc0 L_roleA
L_roleS:
    s_sub_u32 s34, s34, 4
    v_lshrrev_b32 v1, 3, v254
    v_and_b32 v2, 7, v254
    v_lshrrev_b32 v3, 4, v254
    v_xor_b32 v4, v2, v3
    s_cmp_ge_u32 s65, 10
    s_cselect_b32 s70, 4, 0
    s_cselect_b32 s71, 19, 9
    s_cselect_b32 s75, 3, 18
    v_and_b32 v5, s70, v1
    v_add_u32 v5, v5, v1
    v_mul_u32_u24 v5, 1280, v5
    v_lshl_add_u32 v161, v4, 4, v5
    v_xor_b32 v6, 64, v161
    v_lshl_add_u32 v162, s71, 10, v6
    v_lshl_add_u32 v163, s75, 10, v161
    v_lshl_add_u32 v164, s75, 10, v162
    v_and_b32 v7, 15, v254
    v_lshlrev_b32 v8, 2, v3
    v_xor_b32 v7, v7, v8
    v_mul_u32_u24 v8, 3840, v3
    v_lshl_add_u32 v165, v7, 4, v8
    v_xor_b32 v7, 48, v165
    v_add_u32 v166, 14336, v165
    v_add_u32 v167, 28672, v7
    v_add_u32 v168, 43008, v7
    s_lshl2_add_u32 s72, s64, s34
    s_mul_i32 s72, s72, 40960
    s_mul_i32 s73, s34, 61440
    s_lshl_b32 s70, s65, 8
    s_add_u32 s73, s73, s70
    s_lshl_b32 s74, s34, 12
    s_add_u32 s81, s35, s69
    s_add_u32 s85, s3, 1
    s_lshr_b32 s85, s85, 1
    s_mul_i32 s85, s85, 2
    s_and_b32 s81, s81, 3
    s_mov_b32 s86, 0x68534210
    s_cmp_eq_u32 s81, 1
    s_cselect_b32 s86, 0x69405321, s86
    s_cmp_eq_u32 s81, 2
    s_cselect_b32 s86, 0x75461032, s86
    s_cmp_eq_u32 s81, 3
    s_cselect_b32 s86, 0x65472103, s86
    s_lshl_b32 s81, s81, 3
    s_lshr_b32 s87, 0x98988797, s81
    s_mov_b32 s38, 0x280000
    s_mov_b32 s39, 0x20000
    s_mov_b32 s42, 0x258000
    s_mov_b32 s43, 0x20000
    s_bfe_u32 s82, s86, 0x40000
    s_add_u32 s82, s82, s85
    s_cmp_ge_u32 s82, 10
    s_cselect_b32 s83, 10, 0
    s_sub_u32 s82, s82, s83
    s_add_u32 m0, s74, 32768
    s_lshl_b32 s83, s82, 7
    s_add_u32 s76, s72, s83
    s_cmp_eq_u32 s65, 15
    s_waitcnt lgkmcnt(0)
    s_mov_b64 s[36:37], s[4:5]
    s_mov_b64 s[40:41], s[6:7]
    s_cbranch_scc1 L_skip0
    buffer_load_dwordx4 v161, s[36:39], s76 offen offset:0 lds
    buffer_load_dwordx4 v162, s[36:39], s76 offen offset:1024 lds
    buffer_load_dwordx4 v163, s[36:39], s76 offen offset:2048 lds
    buffer_load_dwordx4 v164, s[36:39], s76 offen offset:3072 lds
    s_add_u32 m0, s74, 49152
    s_mul_i32 s83, s82, 245760
    s_add_u32 s76, s73, s83
    buffer_load_dwordx4 v165, s[40:43], s76 offen offset:0 lds
    buffer_load_dwordx4 v166, s[40:43], s76 offen offset:1024 lds
    buffer_load_dwordx4 v167, s[40:43], s76 offen offset:2048 lds
    buffer_load_dwordx4 v168, s[40:43], s76 offen offset:3072 lds
L_skip0:
    v_lshlrev_b32 v253, 2, v0
    v_add_u32 v253, 161792, v253
    v_mov_b32 v0, 0
    ds_write_b32 v253, v0
    s_lshr_b32 s71, s35, 3
    s_lshl2_add_u32 s66, s3, s71
    s_and_b32 s67, s35, 7
    s_and_b32 s70, s35, 3
    s_lshl2_add_u32 s68, s3, s70
    s_mov_b32 s96, 0x200000
    s_mov_b32 s94, 0
    s_mov_b32 s95, -1
    s_mov_b32 s44, s32
    s_mov_b32 s45, s33
    s_mov_b32 s46, 0x10c8000
    s_mov_b32 s47, 0x20000
    s_mul_i32 s70, s97, 40
    v_min_u32 v9, 39, v254
    v_add_lshl_u32 v9, v9, s70, 1
    global_load_ushort v10, v9, s[24:25]
    global_load_ushort v11, v9, s[12:13]
    global_load_ushort v12, v9, s[14:15]
    s_mov_b32 s48, s10
    s_mov_b32 s49, s11
    s_mov_b32 s50, 0x280000
    s_mov_b32 s51, 0x20000
    s_cmp_ge_u32 s34, 2
    s_cselect_b32 s70, s18, s16
    s_cselect_b32 s71, s19, s17
    s_mov_b32 s52, s70
    s_mov_b32 s53, s71
    s_mov_b32 s54, 0xc8000
    s_mov_b32 s55, 0x20000
    v_lshrrev_b32 v1, 3, v254
    v_and_b32 v2, 7, v254
    v_lshrrev_b32 v3, 4, v254
    v_xor_b32 v4, v2, v3
    v_and_b32 v5, 3, v1
    v_lshrrev_b32 v6, 2, v1
    v_lshl_add_u32 v5, v6, 3, v5
    v_mul_u32_u24 v5, 1280, v5
    v_lshl_add_u32 v169, v4, 4, v5
    v_xor_b32 v6, 64, v169
    v_add_u32 v170, 19456, v6
    v_add_u32 v171, 3072, v169
    v_add_u32 v172, 22528, v6
    s_lshr_b32 s70, s34, 1
    s_lshl_b32 s71, s70, 6
    v_mul_u32_u24 v5, 1280, v1
    v_lshl_add_u32 v5, v4, 4, v5
    v_xor_b32 v173, s71, v5
    v_add_u32 v174, 9216, v173
    v_add_u32 v175, 18432, v173
    s_and_b32 s71, s34, 1
    s_mul_i32 s75, s70, 5120
    s_mul_i32 s77, s71, 2048
    s_add_u32 s75, s75, s77
    s_mul_i32 s77, s97, 51200
    s_mul_i32 s71, s71, 20480
    s_add_u32 s77, s77, s71
    v_and_b32 v5, 3, v254
    v_lshlrev_b32 v5, 8, v5
    v_lshl_add_u32 v5, v254, 2, v5
    v_add_u32 v191, 162816, v5
    v_and_b32 v40, 15, v254
    v_lshrrev_b32 v41, 4, v254
    v_lshrrev_b32 v42, 1, v40
    v_xor_b32 v42, v42, v41
    v_lshlrev_b32 v42, 4, v42
    v_lshl_add_u32 v42, v40, 7, v42
    v_xor_b32 v43, 64, v42
    v_add_u32 v96, s74, v42
    v_add_u32 v97, s74, v43
    s_mul_i32 s70, s34, 14848
    s_add_u32 s70, s70, 102400
    v_add_u32 v250, s70, v42
    v_add_u32 v251, s70, v43
    v_lshrrev_b32 v44, 3, v40
    v_lshl_add_u32 v42, v44, 12, v42
    v_add_u32 v100, 16384, v42
    v_xor_b32 v101, 64, v100
    v_add_u32 v98, 0x10000, v96
    v_add_u32 v102, 0x10000, v100
    v_add_u32 v99, 0x10000, v97
    v_add_u32 v103, 0x10000, v101
    v_and_b32 v42, 7, v254
    v_lshlrev_b32 v44, 2, v44
    v_lshl_add_u32 v42, v42, 3, v44
    v_add_u32 v157, 86016, v42
    v_mul_u32_u24 v43, 320, v41
    s_mul_i32 s71, s34, 1280
    s_add_u32 s71, s71, 86528
    v_add3_u32 v150, v42, v43, s71
    v_lshlrev_b32 v155, 3, v254
    v_add_u32 v156, 86016, v155
    v_lshlrev_b32 v160, 9, v254
    v_lshlrev_b32 v107, 2, v254
    v_add_u32 v107, 161792, v107
    v_and_b32 v158, 0xfffffdff, v191
    v_bfe_u32 v42, v254, 1, 2
    v_xor_b32 v42, v42, v41
    v_lshlrev_b32 v42, 4, v42
    s_mul_i32 s71, s34, 5120
    s_add_u32 s71, s71, 65536
    v_lshl_add_u32 v42, v40, 6, v42
    v_add_u32 v151, s71, v42
    v_bfe_u32 v42, v254, 2, 2
    v_lshrrev_b32 v43, 5, v254
    v_lshl_add_u32 v152, v43, 3, v42
    v_lshlrev_b32 v152, 6, v152
    v_mul_u32_u24 v154, 20480, v43
    v_lshrrev_b32 v42, 1, v42
    v_bfe_u32 v43, v254, 4, 1
    v_bfe_u32 v44, v254, 1, 1
    v_lshl_add_u32 v44, v43, 1, v44
    v_xor_b32 v44, v44, v42
    v_lshl_add_u32 v152, v44, 4, v152
    v_and_b32 v44, 1, v254
    v_lshl_add_u32 v152, v44, 3, v152
    v_xor_b32 v153, 32, v152
    v_add_u32 v152, s71, v152
    v_add_u32 v153, s71, v153
    v_mul_u32_u24 v43, 40960, v43
    v_lshl_add_u32 v43, v40, 4, v43
    v_add_u32 v154, v154, v43
    v_mul_u32_u24 v42, 1280, v1
    v_lshl_add_u32 v248, v4, 4, v42
    v_xor_b32 v42, 64, v248
    v_add_u32 v249, 9216, v42
    v_lshlrev_b32 v252, 4, v254
    v_lshlrev_b32 v192, 7, v254
    v_min_u32 v193, 4992, v192
    s_xor_b32 s92, s34, 1
    s_mul_i32 s92, s92, 14848
    s_add_u32 s92, s92, 102400
    s_xor_b32 s93, s34, 3
    s_mul_i32 s93, s93, 14848
    s_add_u32 s93, s93, 107776
    v_add_u32 v40, 0, v254
    v_mul_u32_u24 v41, 6554, v40
    v_lshrrev_b32 v41, 16, v41
    v_mul_u32_u24 v42, 10, v41
    v_sub_u32 v40, v40, v42
    v_and_b32 v42, 0x13, v41
    v_and_b32 v43, 4, v41
    v_lshl_or_b32 v42, v43, 1, v42
    v_and_b32 v43, 8, v41
    v_lshrrev_b32 v43, 1, v43
    v_or_b32 v42, v43, v42
    v_mul_u32_u24 v42, 1280, v42
    v_lshl_add_u32 v186, v40, 4, v42
    v_add_u32 v40, 64, v254
    v_mul_u32_u24 v41, 6554, v40
    v_lshrrev_b32 v41, 16, v41
    v_mul_u32_u24 v42, 10, v41
    v_sub_u32 v40, v40, v42
    v_and_b32 v42, 0x13, v41
    v_and_b32 v43, 4, v41
    v_lshl_or_b32 v42, v43, 1, v42
    v_and_b32 v43, 8, v41
    v_lshrrev_b32 v43, 1, v43
    v_or_b32 v42, v43, v42
    v_mul_u32_u24 v42, 1280, v42
    v_lshl_add_u32 v187, v40, 4, v42
    v_subrev_u32 v187, 1024, v187
    v_add_u32 v40, 128, v254
    v_mul_u32_u24 v41, 6554, v40
    v_lshrrev_b32 v41, 16, v41
    v_mul_u32_u24 v42, 10, v41
    v_sub_u32 v40, v40, v42
    v_and_b32 v42, 0x13, v41
    v_and_b32 v43, 4, v41
    v_lshl_or_b32 v42, v43, 1, v42
    v_and_b32 v43, 8, v41
    v_lshrrev_b32 v43, 1, v43
    v_or_b32 v42, v43, v42
    v_mul_u32_u24 v42, 1280, v42
    v_lshl_add_u32 v188, v40, 4, v42
    v_subrev_u32 v188, 2048, v188
    v_add_u32 v40, 192, v254
    v_mul_u32_u24 v41, 6554, v40
    v_lshrrev_b32 v41, 16, v41
    v_mul_u32_u24 v42, 10, v41
    v_sub_u32 v40, v40, v42
    v_and_b32 v42, 0x13, v41
    v_and_b32 v43, 4, v41
    v_lshl_or_b32 v42, v43, 1, v42
    v_and_b32 v43, 8, v41
    v_lshrrev_b32 v43, 1, v43
    v_or_b32 v42, v43, v42
    v_mul_u32_u24 v42, 1280, v42
    v_lshl_add_u32 v189, v40, 4, v42
    v_subrev_u32 v189, 3072, v189
    v_add_u32 v40, 256, v254
    v_mul_u32_u24 v41, 6554, v40
    v_lshrrev_b32 v41, 16, v41
    v_mul_u32_u24 v42, 10, v41
    v_sub_u32 v40, v40, v42
    v_and_b32 v42, 0x13, v41
    v_and_b32 v43, 4, v41
    v_lshl_or_b32 v42, v43, 1, v42
    v_and_b32 v43, 8, v41
    v_lshrrev_b32 v43, 1, v43
    v_or_b32 v42, v43, v42
    v_mul_u32_u24 v42, 1280, v42
    v_lshl_add_u32 v190, v40, 4, v42
    s_cmp_eq_u32 s65, 15
    s_cbranch_scc1 L_skip_1
    s_bfe_u32 s82, s86, 0x40004
    s_add_u32 s82, s82, s85
    s_cmp_ge_u32 s82, 10
    s_cselect_b32 s83, 10, 0
    s_sub_u32 s82, s82, s83
    s_add_u32 m0, s74, 65536
    s_lshl_b32 s83, s82, 7
    s_add_u32 s76, s72, s83
    buffer_load_dwordx4 v161, s[36:39], s76 offen offset:0 lds
    buffer_load_dwordx4 v162, s[36:39], s76 offen offset:1024 lds
    buffer_load_dwordx4 v163, s[36:39], s76 offen offset:2048 lds
    buffer_load_dwordx4 v164, s[36:39], s76 offen offset:3072 lds
    s_add_u32 m0, s74, 81920
    s_mul_i32 s83, s82, 245760
    s_add_u32 s76, s73, s83
    buffer_load_dwordx4 v165, s[40:43], s76 offen offset:0 lds
    buffer_load_dwordx4 v166, s[40:43], s76 offen offset:1024 lds
    buffer_load_dwordx4 v167, s[40:43], s76 offen offset:2048 lds
    buffer_load_dwordx4 v168, s[40:43], s76 offen offset:3072 lds
L_skip_1:
    s_waitcnt vmcnt(11) lgkmcnt(0)
    s_barrier
    s_cmp_eq_u32 s65, 15
    s_cbranch_scc1 L_skip_2
    s_bfe_u32 s82, s86, 0x40008
    s_add_u32 s82, s82, s85
    s_cmp_ge_u32 s82, 10
    s_cselect_b32 s83, 10, 0
    s_sub_u32 s82, s82, s83
    s_add_u32 m0, s74, 98304
    s_lshl_b32 s83, s82, 7
    s_add_u32 s76, s72, s83
    buffer_load_dwordx4 v161, s[36:39], s76 offen offset:0 lds
    buffer_load_dwordx4 v162, s[36:39], s76 offen offset:1024 lds
    buffer_load_dwordx4 v163, s[36:39], s76 offen offset:2048 lds
    buffer_load_dwordx4 v164, s[36:39], s76 offen offset:3072 lds
    s_add_u32 m0, s74, 114688
    s_mul_i32 s83, s82, 245760
    s_add_u32 s76, s73, s83
    buffer_load_dwordx4 v165, s[40:43], s76 offen offset:0 lds
    buffer_load_dwordx4 v166, s[40:43], s76 offen offset:1024 lds
    buffer_load_dwordx4 v167, s[40:43], s76 offen offset:2048 lds
    buffer_load_dwordx4 v168, s[40:43], s76 offen offset:3072 lds
L_skip_2:
    s_waitcnt vmcnt(8)
    s_barrier
    s_cmp_eq_u32 s65, 15
    s_cbranch_scc1 L_skip_3
    s_bfe_u32 s82, s86, 0x4000c
    s_add_u32 s82, s82, s85
    s_cmp_ge_u32 s82, 10
    s_cselect_b32 s83, 10, 0
    s_sub_u32 s82, s82, s83
    s_add_u32 m0, s74, 0
    s_lshl_b32 s83, s82, 7
    s_add_u32 s76, s72, s83
    buffer_load_dwordx4 v161, s[36:39], s76 offen offset:0 lds
    buffer_load_dwordx4 v162, s[36:39], s76 offen offset:1024 lds
    buffer_load_dwordx4 v163, s[36:39], s76 offen offset:2048 lds
    buffer_load_dwordx4 v164, s[36:39], s76 offen offset:3072 lds
    s_add_u32 m0, s74, 16384
    s_mul_i32 s83, s82, 245760
    s_add_u32 s76, s73, s83
    buffer_load_dwordx4 v165, s[40:43], s76 offen offset:0 lds
    buffer_load_dwordx4 v166, s[40:43], s76 offen offset:1024 lds
    buffer_load_dwordx4 v167, s[40:43], s76 offen offset:2048 lds
    buffer_load_dwordx4 v168, s[40:43], s76 offen offset:3072 lds
L_skip_3:
    s_cmp_eq_u32 s65, 15
    s_cbranch_scc1 L_skip_4
    s_bfe_u32 s82, s86, 0x40010
    s_add_u32 s82, s82, s85
    s_cmp_ge_u32 s82, 10
    s_cselect_b32 s83, 10, 0
    s_sub_u32 s82, s82, s83
    s_add_u32 m0, s74, 32768
    s_lshl_b32 s83, s82, 7
    s_add_u32 s76, s72, s83
    buffer_load_dwordx4 v161, s[36:39], s76 offen offset:0 lds
    buffer_load_dwordx4 v162, s[36:39], s76 offen offset:1024 lds
    buffer_load_dwordx4 v163, s[36:39], s76 offen offset:2048 lds
    buffer_load_dwordx4 v164, s[36:39], s76 offen offset:3072 lds
    s_add_u32 m0, s74, 49152
    s_mul_i32 s83, s82, 245760
    s_add_u32 s76, s73, s83
    buffer_load_dwordx4 v165, s[40:43], s76 offen offset:0 lds
    buffer_load_dwordx4 v166, s[40:43], s76 offen offset:1024 lds
    buffer_load_dwordx4 v167, s[40:43], s76 offen offset:2048 lds
    buffer_load_dwordx4 v168, s[40:43], s76 offen offset:3072 lds
L_skip_4:
    s_waitcnt vmcnt(16)
    s_barrier
    s_cmp_eq_u32 s65, 15
    s_cbranch_scc1 L_skip_5
    s_bfe_u32 s82, s86, 0x40014
    s_add_u32 s82, s82, s85
    s_cmp_ge_u32 s82, 10
    s_cselect_b32 s83, 10, 0
    s_sub_u32 s82, s82, s83
    s_add_u32 m0, s74, 65536
    s_lshl_b32 s83, s82, 7
    s_add_u32 s76, s72, s83
    buffer_load_dwordx4 v161, s[36:39], s76 offen offset:0 lds
    buffer_load_dwordx4 v162, s[36:39], s76 offen offset:1024 lds
    buffer_load_dwordx4 v163, s[36:39], s76 offen offset:2048 lds
    buffer_load_dwordx4 v164, s[36:39], s76 offen offset:3072 lds
    s_add_u32 m0, s74, 81920
    s_mul_i32 s83, s82, 245760
    s_add_u32 s76, s73, s83
    buffer_load_dwordx4 v165, s[40:43], s76 offen offset:0 lds
    buffer_load_dwordx4 v166, s[40:43], s76 offen offset:1024 lds
    buffer_load_dwordx4 v167, s[40:43], s76 offen offset:2048 lds
    buffer_load_dwordx4 v168, s[40:43], s76 offen offset:3072 lds
L_skip_5:
    s_waitcnt vmcnt(16)
    s_barrier
    s_cmp_eq_u32 s65, 15
    s_cbranch_scc1 L_skip_6
    s_bfe_u32 s82, s86, 0x40018
    s_add_u32 s82, s82, s85
    s_cmp_ge_u32 s82, 10
    s_cselect_b32 s83, 10, 0
    s_sub_u32 s82, s82, s83
    s_add_u32 m0, s74, 98304
    s_lshl_b32 s83, s82, 7
    s_add_u32 s76, s72, s83
    buffer_load_dwordx4 v161, s[36:39], s76 offen offset:0 lds
    buffer_load_dwordx4 v162, s[36:39], s76 offen offset:1024 lds
    buffer_load_dwordx4 v163, s[36:39], s76 offen offset:2048 lds
    buffer_load_dwordx4 v164, s[36:39], s76 offen offset:3072 lds
    s_add_u32 m0, s74, 114688
    s_mul_i32 s83, s82, 245760
    s_add_u32 s76, s73, s83
    buffer_load_dwordx4 v165, s[40:43], s76 offen offset:0 lds
    buffer_load_dwordx4 v166, s[40:43], s76 offen offset:1024 lds
    buffer_load_dwordx4 v167, s[40:43], s76 offen offset:2048 lds
    buffer_load_dwordx4 v168, s[40:43], s76 offen offset:3072 lds
L_skip_6:
    s_waitcnt vmcnt(16)
    s_barrier
    s_cmp_eq_u32 s65, 15
    s_cbranch_scc1 L_skip_7
    s_bfe_u32 s82, s86, 0x4001c
    s_add_u32 s82, s82, s85
    s_cmp_ge_u32 s82, 10
    s_cselect_b32 s83, 10, 0
    s_sub_u32 s82, s82, s83
    s_add_u32 m0, s74, 0
    s_lshl_b32 s83, s82, 7
    s_add_u32 s76, s72, s83
    buffer_load_dwordx4 v161, s[36:39], s76 offen offset:0 lds
    buffer_load_dwordx4 v162, s[36:39], s76 offen offset:1024 lds
    buffer_load_dwordx4 v163, s[36:39], s76 offen offset:2048 lds
    buffer_load_dwordx4 v164, s[36:39], s76 offen offset:3072 lds
    s_add_u32 m0, s74, 16384
    s_mul_i32 s83, s82, 245760
    s_add_u32 s76, s73, s83
    buffer_load_dwordx4 v165, s[40:43], s76 offen offset:0 lds
    buffer_load_dwordx4 v166, s[40:43], s76 offen offset:1024 lds
    buffer_load_dwordx4 v167, s[40:43], s76 offen offset:2048 lds
    buffer_load_dwordx4 v168, s[40:43], s76 offen offset:3072 lds
L_skip_7:
    s_waitcnt vmcnt(16)
    s_barrier
    s_cmp_eq_u32 s65, 15
    s_cbranch_scc1 L_skip_8
    s_bfe_u32 s82, s87, 0x40000
    s_add_u32 s82, s82, s85
    s_cmp_ge_u32 s82, 10
    s_cselect_b32 s83, 10, 0
    s_sub_u32 s82, s82, s83
    s_add_u32 m0, s74, 32768
    s_lshl_b32 s83, s82, 7
    s_add_u32 s76, s72, s83
    buffer_load_dwordx4 v161, s[36:39], s76 offen offset:0 lds
    buffer_load_dwordx4 v162, s[36:39], s76 offen offset:1024 lds
    buffer_load_dwordx4 v163, s[36:39], s76 offen offset:2048 lds
    buffer_load_dwordx4 v164, s[36:39], s76 offen offset:3072 lds
    s_add_u32 m0, s74, 49152
    s_mul_i32 s83, s82, 245760
    s_add_u32 s76, s73, s83
    buffer_load_dwordx4 v165, s[40:43], s76 offen offset:0 lds
    buffer_load_dwordx4 v166, s[40:43], s76 offen offset:1024 lds
    buffer_load_dwordx4 v167, s[40:43], s76 offen offset:2048 lds
    buffer_load_dwordx4 v168, s[40:43], s76 offen offset:3072 lds
L_skip_8:
    s_waitcnt vmcnt(16)
    s_barrier
    v_and_b32 v32, 15, v254
    v_lshlrev_b32 v32, 4, v32
    v_mov_b32 v33, 1
    s_cmp_eq_u32 s34, 3
    s_cbranch_scc0 L_nodbg
    global_load_dword v33, v32, s[30:31] sc1
L_nodbg:
    s_cmp_eq_u32 s65, 15
    s_cbranch_scc0 L_cw
    s_waitcnt vmcnt(0)
L_cw:
    s_cmp_eq_u32 s65, 15
    s_cbranch_scc1 L_skip_9
    s_bfe_u32 s82, s87, 0x40004
    s_add_u32 s82, s82, s85
    s_cmp_ge_u32 s82, 10
    s_cselect_b32 s83, 10, 0
    s_sub_u32 s82, s82, s83
    s_add_u32 m0, s74, 65536
    s_lshl_b32 s83, s82, 7
    s_add_u32 s76, s72, s83
    buffer_load_dwordx4 v161, s[36:39], s76 offen offset:0 lds
    buffer_load_dwordx4 v162, s[36:39], s76 offen offset:1024 lds
    buffer_load_dwordx4 v163, s[36:39], s76 offen offset:2048 lds
    buffer_load_dwordx4 v164, s[36:39], s76 offen offset:3072 lds
    s_add_u32 m0, s74, 81920
    s_mul_i32 s83, s82, 245760
    s_add_u32 s76, s73, s83
    buffer_load_dwordx4 v165, s[40:43], s76 offen offset:0 lds
    buffer_load_dwordx4 v166, s[40:43], s76 offen offset:1024 lds
    buffer_load_dwordx4 v167, s[40:43], s76 offen offset:2048 lds
    buffer_load_dwordx4 v168, s[40:43], s76 offen offset:3072 lds
L_skip_9:
    s_waitcnt vmcnt(16)
    s_barrier
    s_and_b32 s82, s35, 3
    s_xor_b32 s82, s82, 1
    s_mul_i32 s82, s82, 5
    s_lshr_b32 s82, s82, 1
    s_mul_i32 s83, s69, 5
    s_lshr_b32 s83, s83, 2
    s_add_u32 s82, s82, s83
    s_add_u32 s83, s3, 1
    s_lshr_b32 s83, s83, 1
    s_add_u32 s82, s82, s83
    s_cmp_ge_u32 s82, 10
    s_cselect_b32 s83, 10, 0
    s_sub_u32 s82, s82, s83
    s_add_u32 m0, s74, 98304
    s_lshl_b32 s83, s82, 7
    s_add_u32 s76, s72, s83
    buffer_load_dwordx4 v169, s[48:51], s76 offen offset:0 lds
    buffer_load_dwordx4 v170, s[48:51], s76 offen offset:1024 lds
    buffer_load_dwordx4 v171, s[48:51], s76 offen offset:2048 lds
    buffer_load_dwordx4 v172, s[48:51], s76 offen offset:3072 lds
    s_add_u32 m0, s75, 114688
    s_add_u32 s76, s77, s83
    buffer_load_dwordx4 v173, s[52:55], s76 offen offset:0 lds
    buffer_load_dwordx4 v174, s[52:55], s76 offen offset:1024 lds
    buffer_load_dwordx4 v175, s[52:55], s76 offen offset:2048 lds
    s_add_u32 s82, s82, 1
    s_cmp_eq_u32 s82, 10
    s_cselect_b32 s82, 0, s82
    s_waitcnt vmcnt(15)
    s_barrier
    s_add_u32 m0, s74, 0
    s_lshl_b32 s83, s82, 7
    s_add_u32 s76, s72, s83
    buffer_load_dwordx4 v169, s[48:51], s76 offen offset:0 lds
    buffer_load_dwordx4 v170, s[48:51], s76 offen offset:1024 lds
    buffer_load_dwordx4 v171, s[48:51], s76 offen offset:2048 lds
    buffer_load_dwordx4 v172, s[48:51], s76 offen offset:3072 lds
    s_add_u32 m0, s75, 16384
    s_add_u32 s76, s77, s83
    buffer_load_dwordx4 v173, s[52:55], s76 offen offset:0 lds
    buffer_load_dwordx4 v174, s[52:55], s76 offen offset:1024 lds
    buffer_load_dwordx4 v175, s[52:55], s76 offen offset:2048 lds
    s_add_u32 s82, s82, 1
    s_cmp_eq_u32 s82, 10
    s_cselect_b32 s82, 0, s82
    s_waitcnt vmcnt(14)
    s_barrier
    s_add_u32 m0, s74, 32768
    s_lshl_b32 s83, s82, 7
    s_add_u32 s76, s72, s83
    buffer_load_dwordx4 v169, s[48:51], s76 offen offset:0 lds
    buffer_load_dwordx4 v170, s[48:51], s76 offen offset:1024 lds
    buffer_load_dwordx4 v171, s[48:51], s76 offen offset:2048 lds
    buffer_load_dwordx4 v172, s[48:51], s76 offen offset:3072 lds
    s_add_u32 m0, s75, 49152
    s_add_u32 s76, s77, s83
    buffer_load_dwordx4 v173, s[52:55], s76 offen offset:0 lds
    buffer_load_dwordx4 v174, s[52:55], s76 offen offset:1024 lds
    buffer_load_dwordx4 v175, s[52:55], s76 offen offset:2048 lds
    s_add_u32 s82, s82, 1
    s_cmp_eq_u32 s82, 10
    s_cselect_b32 s82, 0, s82
    v_cmp_eq_u32 vcc, 0, v33
    s_cbranch_vccz L_clrok
L_pf_13:
    global_load_dword v33, v32, s[30:31] sc1
    s_waitcnt vmcnt(0)
    v_cmp_eq_u32 vcc, 0, v33
    s_cbranch_vccnz L_pfr_14
    s_mov_b64 exec, -1
L_clrok:
    s_barrier
    s_cmp_eq_u32 s34, 0
    s_cbranch_scc0 L_nopar
    v_lshlrev_b32 v10, 16, v10
    v_lshlrev_b32 v11, 16, v11
    v_lshlrev_b32 v12, 16, v12
    s_mov_b32 s80, 0x3fb8aa3b
    v_mul_f32 v14, s80, v10
    v_fma_f32 v15, v10, s80, -v14
    v_fmac_f32 v15, 0x32a57060, v10
    v_exp_f32 v13, v14
    v_mul_f32 v15, 0x3f317218, v15
    v_fmac_f32 v13, v13, v15
    v_cvt_pk_bf16_f32 v13, v13, v13
    v_and_b32 v13, 0xffff0000, v13
    v_mul_f32 v14, v13, v11
    v_mul_f32 v15, v13, v12
    s_mov_b32 s80, 0x3fb8aa3b
    v_mul_f32 v17, s80, v14
    v_fma_f32 v18, v14, s80, -v17
    v_fmac_f32 v18, 0x32a57060, v14
    v_exp_f32 v16, v17
    v_mul_f32 v18, 0x3f317218, v18
    v_fmac_f32 v16, v16, v18
    s_mov_b32 s80, 0x3e22f983
    v_mul_f32 v17, s80, v15
    v_rndne_f32 v17, v17
    v_fma_f32 v17, v15, s80, -v17
    v_fmac_f32 v17, 0x31dc9c88, v15
    v_cos_f32 v20, v17
    v_sin_f32 v21, v17
    v_mul_f32 v18, v11, v11
    v_fmac_f32 v18, v12, v12
    v_rcp_f32 v19, v18
    v_mul_f32 v20, v16, v20
    v_mul_f32 v21, v16, v21
    v_fma_f32 v18, -v18, v19, 1.0
    v_fmac_f32 v19, v19, v18
    v_add_f32 v19, v19, v19
    v_add_f32 v17, -1.0, v20
    v_mul_f32 v22, v17, v11
    v_fmac_f32 v22, v21, v12
    v_mul_f32 v23, v17, v12
    v_fma_f32 v23, -v21, v11, v23
    v_mul_f32 v22, v22, v19
    v_mul_f32 v23, v23, v19
    v_lshlrev_b32 v9, 4, v254
    v_add_u32 v9, 131072, v9
    ds_write_b128 v9, v[20:23]
    v_mov_b32 v24, v20
    v_sub_f32 v25, 0, v21
    v_mul_f32 v26, v25, v25
    v_add_f32 v27, v24, v24
    v_fma_f32 v24, v24, v24, -v26
    v_mul_f32 v25, v27, v25
    v_mul_f32 v26, v25, v25
    v_add_f32 v27, v24, v24
    v_fma_f32 v24, v24, v24, -v26
    v_mul_f32 v25, v27, v25
    v_mul_f32 v26, v25, v25
    v_add_f32 v27, v24, v24
    v_fma_f32 v24, v24, v24, -v26
    v_mul_f32 v25, v27, v25
L_nopar:
    s_cmp_eq_u32 s34, 0
    s_cbranch_scc0 L_nopar2
    s_mov_b32 exec_hi, 0xff
    v_mov_b32 v14, 1.0
    v_mov_b32 v15, 0
    ds_write_b64 v156, v[14:15] offset:46080
    ds_write_b64 v156, v[24:25] offset:46400
    v_mul_f32 v20, v24, v24
    v_mul_f32 v21, v24, v25
    v_fma_f32 v20, -v25, v25, v20
    v_fmac_f32 v21, v25, v24
    ds_write_b64 v156, v[20:21] offset:46720
    v_mul_f32 v16, v24, v20
    v_mul_f32 v17, v24, v21
    v_fma_f32 v16, -v25, v21, v16
    v_fmac_f32 v17, v25, v20
    ds_write_b64 v156, v[16:17] offset:47040
    v_mul_f32 v18, v24, v16
    v_mul_f32 v19, v24, v17
    v_fma_f32 v18, -v25, v17, v18
    v_fmac_f32 v19, v25, v16
    ds_write_b64 v156, v[18:19] offset:47360
    v_mul_f32 v20, v24, v18
    v_mul_f32 v21, v24, v19
    v_fma_f32 v20, -v25, v19, v20
    v_fmac_f32 v21, v25, v18
    ds_write_b64 v156, v[20:21] offset:47680
    v_mul_f32 v16, v24, v20
    v_mul_f32 v17, v24, v21
    v_fma_f32 v16, -v25, v21, v16
    v_fmac_f32 v17, v25, v20
    ds_write_b64 v156, v[16:17] offset:48000
    v_mul_f32 v18, v24, v16
    v_mul_f32 v19, v24, v17
    v_fma_f32 v18, -v25, v17, v18
    v_fmac_f32 v19, v25, v16
    ds_write_b64 v156, v[18:19] offset:48320
    v_mul_f32 v20, v24, v18
    v_mul_f32 v21, v24, v19
    v_fma_f32 v20, -v25, v19, v20
    v_fmac_f32 v21, v25, v18
    ds_write_b64 v156, v[20:21] offset:48640
    v_mul_f32 v16, v24, v20
    v_mul_f32 v17, v24, v21
    v_fma_f32 v16, -v25, v21, v16
    v_fmac_f32 v17, v25, v20
    ds_write_b64 v156, v[16:17] offset:48960
    v_mul_f32 v18, v24, v16
    v_mul_f32 v19, v24, v17
    v_fma_f32 v18, -v25, v17, v18
    v_fmac_f32 v19, v25, v16
    ds_write_b64 v156, v[18:19] offset:49280
    v_mul_f32 v20, v24, v18
    v_mul_f32 v21, v24, v19
    v_fma_f32 v20, -v25, v19, v20
    v_fmac_f32 v21, v25, v18
    ds_write_b64 v156, v[20:21] offset:49600
    v_mul_f32 v16, v24, v20
    v_mul_f32 v17, v24, v21
    v_fma_f32 v16, -v25, v21, v16
    v_fmac_f32 v17, v25, v20
    ds_write_b64 v156, v[16:17] offset:49920
    v_mul_f32 v18, v24, v16
    v_mul_f32 v19, v24, v17
    v_fma_f32 v18, -v25, v17, v18
    v_fmac_f32 v19, v25, v16
    ds_write_b64 v156, v[18:19] offset:50240
    v_mul_f32 v20, v24, v18
    v_mul_f32 v21, v24, v19
    v_fma_f32 v20, -v25, v19, v20
    v_fmac_f32 v21, v25, v18
    ds_write_b64 v156, v[20:21] offset:50560
    v_mul_f32 v16, v24, v20
    v_mul_f32 v17, v24, v21
    v_fma_f32 v16, -v25, v21, v16
    v_fmac_f32 v17, v25, v20
    ds_write_b64 v156, v[16:17] offset:50880
    v_mul_f32 v18, v24, v16
    v_mul_f32 v19, v24, v17
    v_fma_f32 v18, -v25, v17, v18
    v_fmac_f32 v19, v25, v16
    ds_write_b64 v156, v[18:19] offset:51200
    s_mov_b32 exec_hi, -1
    s_waitcnt lgkmcnt(0)
L_nopar2:
    s_lshl4_add_u32 s84, s65, s64
    s_lshl_b32 s84, s84, 7
    s_add_u32 s84, s84, 0xfa0000
    s_waitcnt vmcnt(14)
    s_barrier
    ds_read_b128 v[40:43], v98 offset:32768
    ds_read_b128 v[44:47], v98 offset:34816
    ds_read_b128 v[48:51], v102 offset:32768
    ds_read_b128 v[52:55], v102 offset:33792
    ds_read_b128 v[56:59], v102 offset:34816
    ds_read_b128 v[60:63], v102 offset:35840
    ds_read_b128 v[64:67], v102 offset:36864
    s_waitcnt lgkmcnt(0)
    v_mfma_f32_16x16x32_bf16 v[0:3], v[40:43], v[48:51], 0
    ds_read_b128 v[68:71], v99 offset:32768
    v_mfma_f32_16x16x32_bf16 v[4:7], v[44:47], v[48:51], 0
    ds_read_b128 v[72:75], v99 offset:34816
    ds_read_b128 v[76:79], v103 offset:32768
    v_mfma_f32_16x16x32_bf16 v[8:11], v[40:43], v[52:55], 0
    ds_read_b128 v[80:83], v103 offset:33792
    ds_read_b128 v[84:87], v103 offset:34816
    v_mfma_f32_16x16x32_bf16 v[12:15], v[44:47], v[52:55], 0
    ds_read_b128 v[88:91], v103 offset:35840
    ds_read_b128 v[92:95], v103 offset:36864
    v_mfma_f32_16x16x32_bf16 v[16:19], v[40:43], v[56:59], 0
    v_mfma_f32_16x16x32_bf16 v[20:23], v[44:47], v[56:59], 0
    v_mfma_f32_16x16x32_bf16 v[24:27], v[40:43], v[60:63], 0
    v_mfma_f32_16x16x32_bf16 v[28:31], v[44:47], v[60:63], 0
    v_mfma_f32_16x16x32_bf16 v[32:35], v[40:43], v[64:67], 0
    v_mfma_f32_16x16x32_bf16 v[36:39], v[44:47], v[64:67], 0
    s_waitcnt vmcnt(7) lgkmcnt(0)
    s_barrier
    v_mfma_f32_16x16x32_bf16 v[0:3], v[68:71], v[76:79], v[0:3]
    ds_read_b128 v[40:43], v96 offset:0
    v_mfma_f32_16x16x32_bf16 v[4:7], v[72:75], v[76:79], v[4:7]
    ds_read_b128 v[44:47], v96 offset:2048
    ds_read_b128 v[48:51], v100 offset:0
    v_mfma_f32_16x16x32_bf16 v[8:11], v[68:71], v[80:83], v[8:11]
    ds_read_b128 v[52:55], v100 offset:1024
    ds_read_b128 v[56:59], v100 offset:2048
    v_mfma_f32_16x16x32_bf16 v[12:15], v[72:75], v[80:83], v[12:15]
    ds_read_b128 v[60:63], v100 offset:3072
    ds_read_b128 v[64:67], v100 offset:4096
    v_mfma_f32_16x16x32_bf16 v[16:19], v[68:71], v[84:87], v[16:19]
    v_mfma_f32_16x16x32_bf16 v[20:23], v[72:75], v[84:87], v[20:23]
    v_mfma_f32_16x16x32_bf16 v[24:27], v[68:71], v[88:91], v[24:27]
    v_mfma_f32_16x16x32_bf16 v[28:31], v[72:75], v[88:91], v[28:31]
    v_mfma_f32_16x16x32_bf16 v[32:35], v[68:71], v[92:95], v[32:35]
    v_mfma_f32_16x16x32_bf16 v[36:39], v[72:75], v[92:95], v[36:39]
    s_waitcnt lgkmcnt(0)
    v_mfma_f32_16x16x32_bf16 v[0:3], v[40:43], v[48:51], v[0:3]
    ds_read_b128 v[68:71], v97 offset:0
    v_mfma_f32_16x16x32_bf16 v[4:7], v[44:47], v[48:51], v[4:7]
    ds_read_b128 v[72:75], v97 offset:2048
    ds_read_b128 v[76:79], v101 offset:0
    v_mfma_f32_16x16x32_bf16 v[8:11], v[40:43], v[52:55], v[8:11]
    ds_read_b128 v[80:83], v101 offset:1024
    ds_read_b128 v[84:87], v101 offset:2048
    v_mfma_f32_16x16x32_bf16 v[12:15], v[44:47], v[52:55], v[12:15]
    ds_read_b128 v[88:91], v101 offset:3072
    ds_read_b128 v[92:95], v101 offset:4096
    v_mfma_f32_16x16x32_bf16 v[16:19], v[40:43], v[56:59], v[16:19]
    v_mfma_f32_16x16x32_bf16 v[20:23], v[44:47], v[56:59], v[20:23]
    v_mfma_f32_16x16x32_bf16 v[24:27], v[40:43], v[60:63], v[24:27]
    v_mfma_f32_16x16x32_bf16 v[28:31], v[44:47], v[60:63], v[28:31]
    v_mfma_f32_16x16x32_bf16 v[32:35], v[40:43], v[64:67], v[32:35]
    v_mfma_f32_16x16x32_bf16 v[36:39], v[44:47], v[64:67], v[36:39]
    s_waitcnt vmcnt(0) lgkmcnt(0)
    s_barrier
    v_mfma_f32_16x16x32_bf16 v[0:3], v[68:71], v[76:79], v[0:3]
    ds_read_b128 v[40:43], v96 offset:32768
    v_mfma_f32_16x16x32_bf16 v[4:7], v[72:75], v[76:79], v[4:7]
    ds_read_b128 v[44:47], v96 offset:34816
    ds_read_b128 v[48:51], v100 offset:32768
    v_mfma_f32_16x16x32_bf16 v[8:11], v[68:71], v[80:83], v[8:11]
    ds_read_b128 v[52:55], v100 offset:33792
    ds_read_b128 v[56:59], v100 offset:34816
    v_mfma_f32_16x16x32_bf16 v[12:15], v[72:75], v[80:83], v[12:15]
    ds_read_b128 v[60:63], v100 offset:35840
    ds_read_b128 v[64:67], v100 offset:36864
    v_mfma_f32_16x16x32_bf16 v[16:19], v[68:71], v[84:87], v[16:19]
    v_mfma_f32_16x16x32_bf16 v[20:23], v[72:75], v[84:87], v[20:23]
    v_mfma_f32_16x16x32_bf16 v[24:27], v[68:71], v[88:91], v[24:27]
    v_mfma_f32_16x16x32_bf16 v[28:31], v[72:75], v[88:91], v[28:31]
    v_mfma_f32_16x16x32_bf16 v[32:35], v[68:71], v[92:95], v[32:35]
    v_mfma_f32_16x16x32_bf16 v[36:39], v[72:75], v[92:95], v[36:39]
    s_waitcnt lgkmcnt(0)
    v_mfma_f32_16x16x32_bf16 v[0:3], v[40:43], v[48:51], v[0:3]
    ds_read_b128 v[68:71], v97 offset:32768
    v_mfma_f32_16x16x32_bf16 v[4:7], v[44:47], v[48:51], v[4:7]
    ds_read_b128 v[72:75], v97 offset:34816
    ds_read_b128 v[76:79], v101 offset:32768
    v_mfma_f32_16x16x32_bf16 v[8:11], v[40:43], v[52:55], v[8:11]
    ds_read_b128 v[80:83], v101 offset:33792
    ds_read_b128 v[84:87], v101 offset:34816
    v_mfma_f32_16x16x32_bf16 v[12:15], v[44:47], v[52:55], v[12:15]
    ds_read_b128 v[88:91], v101 offset:35840
    ds_read_b128 v[92:95], v101 offset:36864
    v_mfma_f32_16x16x32_bf16 v[16:19], v[40:43], v[56:59], v[16:19]
    v_mfma_f32_16x16x32_bf16 v[20:23], v[44:47], v[56:59], v[20:23]
    v_mfma_f32_16x16x32_bf16 v[24:27], v[40:43], v[60:63], v[24:27]
    v_mfma_f32_16x16x32_bf16 v[28:31], v[44:47], v[60:63], v[28:31]
    v_mfma_f32_16x16x32_bf16 v[32:35], v[40:43], v[64:67], v[32:35]
    v_mfma_f32_16x16x32_bf16 v[36:39], v[44:47], v[64:67], v[36:39]
    v_and_b32 v104, 7, v254
    v_lshlrev_b32 v104, 4, v104
    v_add_u32 v104, 131072, v104
    ds_read_b128 v[200:203], v104 offset:0
    ds_read_b128 v[204:207], v104 offset:128
    ds_read_b128 v[208:211], v104 offset:256
    ds_read_b128 v[212:215], v104 offset:384
    ds_read_b128 v[216:219], v104 offset:512
    v_and_b32 v105, -8, v150
    v_add_u32 v105, 45568, v105
    ds_read_b64 v[176:177], v105 offset:0
    ds_read_b64 v[178:179], v105 offset:64
    ds_read_b64 v[180:181], v105 offset:128
    ds_read_b64 v[182:183], v105 offset:192
    ds_read_b64 v[184:185], v105 offset:256
    s_cmp_eq_u32 s34, 0
    s_cselect_b32 s70, 1, 16
    s_mul_i32 s70, s70, 320
    v_add_u32 v106, s70, v156
    ds_read_b64 v[146:147], v106 offset:46080
    v_bfe_u32 v145, v254, 3, 1
    v_lshlrev_b32 v145, 31, v145
    v_xor_b32 v144, 0x80000000, v145
    s_waitcnt lgkmcnt(0)
    v_xor_b32 v201, v145, v201
    v_xor_b32 v202, v145, v202
    v_xor_b32 v177, v144, v177
    v_xor_b32 v205, v145, v205
    v_xor_b32 v206, v145, v206
    v_xor_b32 v179, v144, v179
    v_xor_b32 v209, v145, v209
    v_xor_b32 v210, v145, v210
    v_xor_b32 v181, v144, v181
    v_xor_b32 v213, v145, v213
    v_xor_b32 v214, v145, v214
    v_xor_b32 v183, v144, v183
    v_xor_b32 v217, v145, v217
    v_xor_b32 v218, v145, v218
    v_xor_b32 v185, v144, v185
    s_waitcnt lgkmcnt(0)
    s_barrier
    s_cmp_eq_u32 s34, 3
    s_cbranch_scc0 L_noflag
    v_mov_b32 v104, 1
    s_mov_b64 exec, 1
    buffer_store_dword v104, off, s[44:47], s84 sc1
    s_mov_b64 exec, -1
L_noflag:
    v_mfma_f32_16x16x32_bf16 v[0:3], v[68:71], v[76:79], v[0:3]
    ds_read_b128 v[40:43], v98 offset:0
    v_mfma_f32_16x16x32_bf16 v[4:7], v[72:75], v[76:79], v[4:7]
    ds_read_b128 v[44:47], v98 offset:2048
    ds_read_b128 v[48:51], v102 offset:0
    v_mfma_f32_16x16x32_bf16 v[8:11], v[68:71], v[80:83], v[8:11]
    ds_read_b128 v[52:55], v102 offset:1024
    ds_read_b128 v[56:59], v102 offset:2048
    v_mfma_f32_16x16x32_bf16 v[12:15], v[72:75], v[80:83], v[12:15]
    ds_read_b128 v[60:63], v102 offset:3072
    ds_read_b128 v[64:67], v102 offset:4096
    v_mfma_f32_16x16x32_bf16 v[16:19], v[68:71], v[84:87], v[16:19]
    v_mfma_f32_16x16x32_bf16 v[20:23], v[72:75], v[84:87], v[20:23]
    v_mfma_f32_16x16x32_bf16 v[24:27], v[68:71], v[88:91], v[24:27]
    v_mfma_f32_16x16x32_bf16 v[28:31], v[72:75], v[88:91], v[28:31]
    v_mfma_f32_16x16x32_bf16 v[32:35], v[68:71], v[92:95], v[32:35]
    v_mfma_f32_16x16x32_bf16 v[36:39], v[72:75], v[92:95], v[36:39]
    s_waitcnt lgkmcnt(0)
    v_mfma_f32_16x16x32_bf16 v[0:3], v[40:43], v[48:51], v[0:3]
    ds_read_b128 v[68:71], v99 offset:0
    v_mfma_f32_16x16x32_bf16 v[4:7], v[44:47], v[48:51], v[4:7]
    ds_read_b128 v[72:75], v99 offset:2048
    ds_read_b128 v[76:79], v103 offset:0
    v_mfma_f32_16x16x32_bf16 v[8:11], v[40:43], v[52:55], v[8:11]
    ds_read_b128 v[80:83], v103 offset:1024
    ds_read_b128 v[84:87], v103 offset:2048
    v_mfma_f32_16x16x32_bf16 v[12:15], v[44:47], v[52:55], v[12:15]
    ds_read_b128 v[88:91], v103 offset:3072
    ds_read_b128 v[92:95], v103 offset:4096
    v_mfma_f32_16x16x32_bf16 v[16:19], v[40:43], v[56:59], v[16:19]
    v_mfma_f32_16x16x32_bf16 v[20:23], v[44:47], v[56:59], v[20:23]
    v_mfma_f32_16x16x32_bf16 v[24:27], v[40:43], v[60:63], v[24:27]
    v_mfma_f32_16x16x32_bf16 v[28:31], v[44:47], v[60:63], v[28:31]
    v_mfma_f32_16x16x32_bf16 v[32:35], v[40:43], v[64:67], v[32:35]
    v_mfma_f32_16x16x32_bf16 v[36:39], v[44:47], v[64:67], v[36:39]
    s_waitcnt lgkmcnt(0)
    s_barrier
    v_mfma_f32_16x16x32_bf16 v[0:3], v[68:71], v[76:79], v[0:3]
    ds_read_b128 v[40:43], v98 offset:32768
    v_mfma_f32_16x16x32_bf16 v[4:7], v[72:75], v[76:79], v[4:7]
    ds_read_b128 v[44:47], v98 offset:34816
    ds_read_b128 v[48:51], v102 offset:32768
    v_mfma_f32_16x16x32_bf16 v[8:11], v[68:71], v[80:83], v[8:11]
    ds_read_b128 v[52:55], v102 offset:33792
    ds_read_b128 v[56:59], v102 offset:34816
    v_mfma_f32_16x16x32_bf16 v[12:15], v[72:75], v[80:83], v[12:15]
    ds_read_b128 v[60:63], v102 offset:35840
    ds_read_b128 v[64:67], v102 offset:36864
    v_mfma_f32_16x16x32_bf16 v[16:19], v[68:71], v[84:87], v[16:19]
    v_mfma_f32_16x16x32_bf16 v[20:23], v[72:75], v[84:87], v[20:23]
    v_mfma_f32_16x16x32_bf16 v[24:27], v[68:71], v[88:91], v[24:27]
    v_mfma_f32_16x16x32_bf16 v[28:31], v[72:75], v[88:91], v[28:31]
    v_mfma_f32_16x16x32_bf16 v[32:35], v[68:71], v[92:95], v[32:35]
    v_mfma_f32_16x16x32_bf16 v[36:39], v[72:75], v[92:95], v[36:39]
    s_waitcnt lgkmcnt(0)
    v_mfma_f32_16x16x32_bf16 v[0:3], v[40:43], v[48:51], v[0:3]
    ds_read_b128 v[68:71], v99 offset:32768
    v_mfma_f32_16x16x32_bf16 v[4:7], v[44:47], v[48:51], v[4:7]
    ds_read_b128 v[72:75], v99 offset:34816
    ds_read_b128 v[76:79], v103 offset:32768
    v_mfma_f32_16x16x32_bf16 v[8:11], v[40:43], v[52:55], v[8:11]
    ds_read_b128 v[80:83], v103 offset:33792
    ds_read_b128 v[84:87], v103 offset:34816
    v_mfma_f32_16x16x32_bf16 v[12:15], v[44:47], v[52:55], v[12:15]
    ds_read_b128 v[88:91], v103 offset:35840
    ds_read_b128 v[92:95], v103 offset:36864
    v_mfma_f32_16x16x32_bf16 v[16:19], v[40:43], v[56:59], v[16:19]
    v_mfma_f32_16x16x32_bf16 v[20:23], v[44:47], v[56:59], v[20:23]
    v_mfma_f32_16x16x32_bf16 v[24:27], v[40:43], v[60:63], v[24:27]
    v_mfma_f32_16x16x32_bf16 v[28:31], v[44:47], v[60:63], v[28:31]
    v_mfma_f32_16x16x32_bf16 v[32:35], v[40:43], v[64:67], v[32:35]
    v_mfma_f32_16x16x32_bf16 v[36:39], v[44:47], v[64:67], v[36:39]
    s_waitcnt lgkmcnt(0)
    s_barrier
    v_mfma_f32_16x16x32_bf16 v[0:3], v[68:71], v[76:79], v[0:3]
    ds_read_b128 v[40:43], v96 offset:0
    v_mfma_f32_16x16x32_bf16 v[4:7], v[72:75], v[76:79], v[4:7]
    ds_read_b128 v[44:47], v96 offset:2048
    ds_read_b128 v[48:51], v100 offset:0
    v_mfma_f32_16x16x32_bf16 v[8:11], v[68:71], v[80:83], v[8:11]
    ds_read_b128 v[52:55], v100 offset:1024
    ds_read_b128 v[56:59], v100 offset:2048
    v_mfma_f32_16x16x32_bf16 v[12:15], v[72:75], v[80:83], v[12:15]
    ds_read_b128 v[60:63], v100 offset:3072
    ds_read_b128 v[64:67], v100 offset:4096
    v_mfma_f32_16x16x32_bf16 v[16:19], v[68:71], v[84:87], v[16:19]
    v_mfma_f32_16x16x32_bf16 v[20:23], v[72:75], v[84:87], v[20:23]
    v_mfma_f32_16x16x32_bf16 v[24:27], v[68:71], v[88:91], v[24:27]
    v_mfma_f32_16x16x32_bf16 v[28:31], v[72:75], v[88:91], v[28:31]
    v_mfma_f32_16x16x32_bf16 v[32:35], v[68:71], v[92:95], v[32:35]
    v_mfma_f32_16x16x32_bf16 v[36:39], v[72:75], v[92:95], v[36:39]
    s_waitcnt lgkmcnt(0)
    v_mfma_f32_16x16x32_bf16 v[0:3], v[40:43], v[48:51], v[0:3]
    ds_read_b128 v[68:71], v97 offset:0
    v_mfma_f32_16x16x32_bf16 v[4:7], v[44:47], v[48:51], v[4:7]
    ds_read_b128 v[72:75], v97 offset:2048
    ds_read_b128 v[76:79], v101 offset:0
    v_mfma_f32_16x16x32_bf16 v[8:11], v[40:43], v[52:55], v[8:11]
    ds_read_b128 v[80:83], v101 offset:1024
    ds_read_b128 v[84:87], v101 offset:2048
    v_mfma_f32_16x16x32_bf16 v[12:15], v[44:47], v[52:55], v[12:15]
    ds_read_b128 v[88:91], v101 offset:3072
    ds_read_b128 v[92:95], v101 offset:4096
    v_mfma_f32_16x16x32_bf16 v[16:19], v[40:43], v[56:59], v[16:19]
    v_mfma_f32_16x16x32_bf16 v[20:23], v[44:47], v[56:59], v[20:23]
    v_mfma_f32_16x16x32_bf16 v[24:27], v[40:43], v[60:63], v[24:27]
    v_mfma_f32_16x16x32_bf16 v[28:31], v[44:47], v[60:63], v[28:31]
    v_mfma_f32_16x16x32_bf16 v[32:35], v[40:43], v[64:67], v[32:35]
    v_mfma_f32_16x16x32_bf16 v[36:39], v[44:47], v[64:67], v[36:39]
    s_waitcnt lgkmcnt(0)
    s_barrier
    v_mfma_f32_16x16x32_bf16 v[0:3], v[68:71], v[76:79], v[0:3]
    ds_read_b128 v[40:43], v96 offset:32768
    v_mfma_f32_16x16x32_bf16 v[4:7], v[72:75], v[76:79], v[4:7]
    ds_read_b128 v[44:47], v96 offset:34816
    ds_read_b128 v[48:51], v100 offset:32768
    v_mfma_f32_16x16x32_bf16 v[8:11], v[68:71], v[80:83], v[8:11]
    ds_read_b128 v[52:55], v100 offset:33792
    ds_read_b128 v[56:59], v100 offset:34816
    v_mfma_f32_16x16x32_bf16 v[12:15], v[72:75], v[80:83], v[12:15]
    ds_read_b128 v[60:63], v100 offset:35840
    ds_read_b128 v[64:67], v100 offset:36864
    v_mfma_f32_16x16x32_bf16 v[16:19], v[68:71], v[84:87], v[16:19]
    v_mfma_f32_16x16x32_bf16 v[20:23], v[72:75], v[84:87], v[20:23]
    v_mfma_f32_16x16x32_bf16 v[24:27], v[68:71], v[88:91], v[24:27]
    v_mfma_f32_16x16x32_bf16 v[28:31], v[72:75], v[88:91], v[28:31]
    v_mfma_f32_16x16x32_bf16 v[32:35], v[68:71], v[92:95], v[32:35]
    v_mfma_f32_16x16x32_bf16 v[36:39], v[72:75], v[92:95], v[36:39]
    s_waitcnt lgkmcnt(0)
    v_mfma_f32_16x16x32_bf16 v[0:3], v[40:43], v[48:51], v[0:3]
    ds_read_b128 v[68:71], v97 offset:32768
    v_mfma_f32_16x16x32_bf16 v[4:7], v[44:47], v[48:51], v[4:7]
    ds_read_b128 v[72:75], v97 offset:34816
    ds_read_b128 v[76:79], v101 offset:32768
    v_mfma_f32_16x16x32_bf16 v[8:11], v[40:43], v[52:55], v[8:11]
    ds_read_b128 v[80:83], v101 offset:33792
    ds_read_b128 v[84:87], v101 offset:34816
    v_mfma_f32_16x16x32_bf16 v[12:15], v[44:47], v[52:55], v[12:15]
    ds_read_b128 v[88:91], v101 offset:35840
    ds_read_b128 v[92:95], v101 offset:36864
    v_mfma_f32_16x16x32_bf16 v[16:19], v[40:43], v[56:59], v[16:19]
    v_mfma_f32_16x16x32_bf16 v[20:23], v[44:47], v[56:59], v[20:23]
    v_mfma_f32_16x16x32_bf16 v[24:27], v[40:43], v[60:63], v[24:27]
    v_mfma_f32_16x16x32_bf16 v[28:31], v[44:47], v[60:63], v[28:31]
    v_mfma_f32_16x16x32_bf16 v[32:35], v[40:43], v[64:67], v[32:35]
    v_mfma_f32_16x16x32_bf16 v[36:39], v[44:47], v[64:67], v[36:39]
    s_waitcnt lgkmcnt(0)
    s_barrier
    v_mfma_f32_16x16x32_bf16 v[0:3], v[68:71], v[76:79], v[0:3]
    ds_read_b128 v[40:43], v98 offset:0
    v_mfma_f32_16x16x32_bf16 v[4:7], v[72:75], v[76:79], v[4:7]
    ds_read_b128 v[44:47], v98 offset:2048
    ds_read_b128 v[48:51], v102 offset:0
    v_mfma_f32_16x16x32_bf16 v[8:11], v[68:71], v[80:83], v[8:11]
    ds_read_b128 v[52:55], v102 offset:1024
    ds_read_b128 v[56:59], v102 offset:2048
    v_mfma_f32_16x16x32_bf16 v[12:15], v[72:75], v[80:83], v[12:15]
    ds_read_b128 v[60:63], v102 offset:3072
    ds_read_b128 v[64:67], v102 offset:4096
    v_mfma_f32_16x16x32_bf16 v[16:19], v[68:71], v[84:87], v[16:19]
    v_mfma_f32_16x16x32_bf16 v[20:23], v[72:75], v[84:87], v[20:23]
    v_mfma_f32_16x16x32_bf16 v[24:27], v[68:71], v[88:91], v[24:27]
    v_mfma_f32_16x16x32_bf16 v[28:31], v[72:75], v[88:91], v[28:31]
    v_mfma_f32_16x16x32_bf16 v[32:35], v[68:71], v[92:95], v[32:35]
    v_mfma_f32_16x16x32_bf16 v[36:39], v[72:75], v[92:95], v[36:39]
    s_waitcnt lgkmcnt(0)
    v_mfma_f32_16x16x32_bf16 v[0:3], v[40:43], v[48:51], v[0:3]
    ds_read_b128 v[68:71], v99 offset:0
    v_mfma_f32_16x16x32_bf16 v[4:7], v[44:47], v[48:51], v[4:7]
    ds_read_b128 v[72:75], v99 offset:2048
    ds_read_b128 v[76:79], v103 offset:0
    v_mfma_f32_16x16x32_bf16 v[8:11], v[40:43], v[52:55], v[8:11]
    ds_read_b128 v[80:83], v103 offset:1024
    ds_read_b128 v[84:87], v103 offset:2048
    v_mfma_f32_16x16x32_bf16 v[12:15], v[44:47], v[52:55], v[12:15]
    ds_read_b128 v[88:91], v103 offset:3072
    ds_read_b128 v[92:95], v103 offset:4096
    v_mfma_f32_16x16x32_bf16 v[16:19], v[40:43], v[56:59], v[16:19]
    v_mfma_f32_16x16x32_bf16 v[20:23], v[44:47], v[56:59], v[20:23]
    v_mfma_f32_16x16x32_bf16 v[24:27], v[40:43], v[60:63], v[24:27]
    v_mfma_f32_16x16x32_bf16 v[28:31], v[44:47], v[60:63], v[28:31]
    v_mfma_f32_16x16x32_bf16 v[32:35], v[40:43], v[64:67], v[32:35]
    v_mfma_f32_16x16x32_bf16 v[36:39], v[44:47], v[64:67], v[36:39]
    s_waitcnt lgkmcnt(0)
    s_barrier
    v_mfma_f32_16x16x32_bf16 v[0:3], v[68:71], v[76:79], v[0:3]
    ds_read_b128 v[40:43], v98 offset:32768
    v_mfma_f32_16x16x32_bf16 v[4:7], v[72:75], v[76:79], v[4:7]
    ds_read_b128 v[44:47], v98 offset:34816
    ds_read_b128 v[48:51], v102 offset:32768
    v_mfma_f32_16x16x32_bf16 v[8:11], v[68:71], v[80:83], v[8:11]
    ds_read_b128 v[52:55], v102 offset:33792
    ds_read_b128 v[56:59], v102 offset:34816
    v_mfma_f32_16x16x32_bf16 v[12:15], v[72:75], v[80:83], v[12:15]
    ds_read_b128 v[60:63], v102 offset:35840
    ds_read_b128 v[64:67], v102 offset:36864
    v_mfma_f32_16x16x32_bf16 v[16:19], v[68:71], v[84:87], v[16:19]
    v_mfma_f32_16x16x32_bf16 v[20:23], v[72:75], v[84:87], v[20:23]
    v_mfma_f32_16x16x32_bf16 v[24:27], v[68:71], v[88:91], v[24:27]
    v_mfma_f32_16x16x32_bf16 v[28:31], v[72:75], v[88:91], v[28:31]
    v_mfma_f32_16x16x32_bf16 v[32:35], v[68:71], v[92:95], v[32:35]
    v_mfma_f32_16x16x32_bf16 v[36:39], v[72:75], v[92:95], v[36:39]
    s_waitcnt lgkmcnt(0)
    v_mfma_f32_16x16x32_bf16 v[0:3], v[40:43], v[48:51], v[0:3]
    ds_read_b128 v[68:71], v99 offset:32768
    v_mfma_f32_16x16x32_bf16 v[4:7], v[44:47], v[48:51], v[4:7]
    ds_read_b128 v[72:75], v99 offset:34816
    ds_read_b128 v[76:79], v103 offset:32768
    v_mfma_f32_16x16x32_bf16 v[8:11], v[40:43], v[52:55], v[8:11]
    ds_read_b128 v[80:83], v103 offset:33792
    ds_read_b128 v[84:87], v103 offset:34816
    v_mfma_f32_16x16x32_bf16 v[12:15], v[44:47], v[52:55], v[12:15]
    ds_read_b128 v[88:91], v103 offset:35840
    ds_read_b128 v[92:95], v103 offset:36864
    v_mfma_f32_16x16x32_bf16 v[16:19], v[40:43], v[56:59], v[16:19]
    v_mfma_f32_16x16x32_bf16 v[20:23], v[44:47], v[56:59], v[20:23]
    v_mfma_f32_16x16x32_bf16 v[24:27], v[40:43], v[60:63], v[24:27]
    v_mfma_f32_16x16x32_bf16 v[28:31], v[44:47], v[60:63], v[28:31]
    v_mfma_f32_16x16x32_bf16 v[32:35], v[40:43], v[64:67], v[32:35]
    v_mfma_f32_16x16x32_bf16 v[36:39], v[44:47], v[64:67], v[36:39]
    s_waitcnt lgkmcnt(0)
    s_barrier
    v_mfma_f32_16x16x32_bf16 v[0:3], v[68:71], v[76:79], v[0:3]
    ds_read_b128 v[40:43], v96 offset:0
    v_mfma_f32_16x16x32_bf16 v[4:7], v[72:75], v[76:79], v[4:7]
    ds_read_b128 v[44:47], v96 offset:2048
    ds_read_b128 v[48:51], v100 offset:0
    v_mfma_f32_16x16x32_bf16 v[8:11], v[68:71], v[80:83], v[8:11]
    ds_read_b128 v[52:55], v100 offset:1024
    ds_read_b128 v[56:59], v100 offset:2048
    v_mfma_f32_16x16x32_bf16 v[12:15], v[72:75], v[80:83], v[12:15]
    ds_read_b128 v[60:63], v100 offset:3072
    ds_read_b128 v[64:67], v100 offset:4096
    v_mfma_f32_16x16x32_bf16 v[16:19], v[68:71], v[84:87], v[16:19]
    v_mfma_f32_16x16x32_bf16 v[20:23], v[72:75], v[84:87], v[20:23]
    v_mfma_f32_16x16x32_bf16 v[24:27], v[68:71], v[88:91], v[24:27]
    v_mfma_f32_16x16x32_bf16 v[28:31], v[72:75], v[88:91], v[28:31]
    v_mfma_f32_16x16x32_bf16 v[32:35], v[68:71], v[92:95], v[32:35]
    v_mfma_f32_16x16x32_bf16 v[36:39], v[72:75], v[92:95], v[36:39]
    s_waitcnt lgkmcnt(0)
    v_mfma_f32_16x16x32_bf16 v[0:3], v[40:43], v[48:51], v[0:3]
    ds_read_b128 v[68:71], v97 offset:0
    v_mfma_f32_16x16x32_bf16 v[4:7], v[44:47], v[48:51], v[4:7]
    ds_read_b128 v[72:75], v97 offset:2048
    ds_read_b128 v[76:79], v101 offset:0
    v_mfma_f32_16x16x32_bf16 v[8:11], v[40:43], v[52:55], v[8:11]
    ds_read_b128 v[80:83], v101 offset:1024
    ds_read_b128 v[84:87], v101 offset:2048
    v_mfma_f32_16x16x32_bf16 v[12:15], v[44:47], v[52:55], v[12:15]
    ds_read_b128 v[88:91], v101 offset:3072
    ds_read_b128 v[92:95], v101 offset:4096
    v_mfma_f32_16x16x32_bf16 v[16:19], v[40:43], v[56:59], v[16:19]
    v_mfma_f32_16x16x32_bf16 v[20:23], v[44:47], v[56:59], v[20:23]
    v_mfma_f32_16x16x32_bf16 v[24:27], v[40:43], v[60:63], v[24:27]
    v_mfma_f32_16x16x32_bf16 v[28:31], v[44:47], v[60:63], v[28:31]
    v_mfma_f32_16x16x32_bf16 v[32:35], v[40:43], v[64:67], v[32:35]
    v_mfma_f32_16x16x32_bf16 v[36:39], v[44:47], v[64:67], v[36:39]
    s_waitcnt lgkmcnt(0)
    v_mfma_f32_16x16x32_bf16 v[0:3], v[68:71], v[76:79], v[0:3]
    v_mfma_f32_16x16x32_bf16 v[4:7], v[72:75], v[76:79], v[4:7]
    v_mfma_f32_16x16x32_bf16 v[8:11], v[68:71], v[80:83], v[8:11]
    v_mfma_f32_16x16x32_bf16 v[12:15], v[72:75], v[80:83], v[12:15]
    v_mfma_f32_16x16x32_bf16 v[16:19], v[68:71], v[84:87], v[16:19]
    v_mfma_f32_16x16x32_bf16 v[20:23], v[72:75], v[84:87], v[20:23]
    v_mfma_f32_16x16x32_bf16 v[24:27], v[68:71], v[88:91], v[24:27]
    v_mfma_f32_16x16x32_bf16 v[28:31], v[72:75], v[88:91], v[28:31]
    v_mfma_f32_16x16x32_bf16 v[32:35], v[68:71], v[92:95], v[32:35]
    v_mfma_f32_16x16x32_bf16 v[36:39], v[72:75], v[92:95], v[36:39]
    s_setprio 1
    s_lshl_b32 s70, s97, 13
    s_add_u32 s70, s70, 0xf80000
    s_add_u32 s70, s70, s32
    s_addc_u32 s71, s33, 0
    s_mov_b32 s56, s70
    s_mov_b32 s57, s71
    s_mov_b32 s58, 0x2000
    s_mov_b32 s59, 0x20000
    s_sub_u32 s70, 15, s64
    s_lshl_b32 s70, s70, 9
    s_add_u32 s71, s70, 4096
    v_mul_f32_dpp v40, v0, v203 row_ror:8 row_mask:0xf bank_mask:0xf
    v_mul_f32_dpp v41, v1, v203 row_ror:8 row_mask:0xf bank_mask:0xf
    v_mul_f32_dpp v42, v2, v203 row_ror:8 row_mask:0xf bank_mask:0xf
    v_mul_f32_dpp v43, v3, v203 row_ror:8 row_mask:0xf bank_mask:0xf
    v_mul_f32_dpp v44, v4, v203 row_ror:8 row_mask:0xf bank_mask:0xf
    v_mul_f32_dpp v45, v5, v203 row_ror:8 row_mask:0xf bank_mask:0xf
    v_mul_f32_dpp v46, v6, v203 row_ror:8 row_mask:0xf bank_mask:0xf
    v_mul_f32_dpp v47, v7, v203 row_ror:8 row_mask:0xf bank_mask:0xf
    v_fma_f32 v0, v202, v0, v40
    v_fma_f32 v1, v202, v1, v41
    v_fma_f32 v2, v202, v2, v42
    v_fma_f32 v3, v202, v3, v43
    v_fma_f32 v4, v202, v4, v44
    v_fma_f32 v5, v202, v5, v45
    v_fma_f32 v6, v202, v6, v46
    v_fma_f32 v7, v202, v7, v47
    v_mul_f32_dpp v40, v8, v207 row_ror:8 row_mask:0xf bank_mask:0xf
    v_mul_f32_dpp v41, v9, v207 row_ror:8 row_mask:0xf bank_mask:0xf
    v_mul_f32_dpp v42, v10, v207 row_ror:8 row_mask:0xf bank_mask:0xf
    v_mul_f32_dpp v43, v11, v207 row_ror:8 row_mask:0xf bank_mask:0xf
    v_mul_f32_dpp v44, v12, v207 row_ror:8 row_mask:0xf bank_mask:0xf
    v_mul_f32_dpp v45, v13, v207 row_ror:8 row_mask:0xf bank_mask:0xf
    v_mul_f32_dpp v46, v14, v207 row_ror:8 row_mask:0xf bank_mask:0xf
    v_mul_f32_dpp v47, v15, v207 row_ror:8 row_mask:0xf bank_mask:0xf
    v_fma_f32 v8, v206, v8, v40
    v_fma_f32 v9, v206, v9, v41
    v_fma_f32 v10, v206, v10, v42
    v_fma_f32 v11, v206, v11, v43
    v_fma_f32 v12, v206, v12, v44
    v_fma_f32 v13, v206, v13, v45
    v_fma_f32 v14, v206, v14, v46
    v_fma_f32 v15, v206, v15, v47
    v_mul_f32_dpp v40, v16, v211 row_ror:8 row_mask:0xf bank_mask:0xf
    v_mul_f32_dpp v41, v17, v211 row_ror:8 row_mask:0xf bank_mask:0xf
    v_mul_f32_dpp v42, v18, v211 row_ror:8 row_mask:0xf bank_mask:0xf
    v_mul_f32_dpp v43, v19, v211 row_ror:8 row_mask:0xf bank_mask:0xf
    v_mul_f32_dpp v44, v20, v211 row_ror:8 row_mask:0xf bank_mask:0xf
    v_mul_f32_dpp v45, v21, v211 row_ror:8 row_mask:0xf bank_mask:0xf
    v_mul_f32_dpp v46, v22, v211 row_ror:8 row_mask:0xf bank_mask:0xf
    v_mul_f32_dpp v47, v23, v211 row_ror:8 row_mask:0xf bank_mask:0xf
    v_fma_f32 v16, v210, v16, v40
    v_fma_f32 v17, v210, v17, v41
    v_fma_f32 v18, v210, v18, v42
    v_fma_f32 v19, v210, v19, v43
    v_fma_f32 v20, v210, v20, v44
    v_fma_f32 v21, v210, v21, v45
    v_fma_f32 v22, v210, v22, v46
    v_fma_f32 v23, v210, v23, v47
    v_mul_f32_dpp v40, v24, v215 row_ror:8 row_mask:0xf bank_mask:0xf
    v_mul_f32_dpp v41, v25, v215 row_ror:8 row_mask:0xf bank_mask:0xf
    v_mul_f32_dpp v42, v26, v215 row_ror:8 row_mask:0xf bank_mask:0xf
    v_mul_f32_dpp v43, v27, v215 row_ror:8 row_mask:0xf bank_mask:0xf
    v_mul_f32_dpp v44, v28, v215 row_ror:8 row_mask:0xf bank_mask:0xf
    v_mul_f32_dpp v45, v29, v215 row_ror:8 row_mask:0xf bank_mask:0xf
    v_mul_f32_dpp v46, v30, v215 row_ror:8 row_mask:0xf bank_mask:0xf
    v_mul_f32_dpp v47, v31, v215 row_ror:8 row_mask:0xf bank_mask:0xf
    v_fma_f32 v24, v214, v24, v40
    v_fma_f32 v25, v214, v25, v41
    v_fma_f32 v26, v214, v26, v42
    v_fma_f32 v27, v214, v27, v43
    v_fma_f32 v28, v214, v28, v44
    v_fma_f32 v29, v214, v29, v45
    v_fma_f32 v30, v214, v30, v46
    v_fma_f32 v31, v214, v31, v47
    v_mul_f32_dpp v40, v32, v219 row_ror:8 row_mask:0xf bank_mask:0xf
    v_mul_f32_dpp v41, v33, v219 row_ror:8 row_mask:0xf bank_mask:0xf
    v_mul_f32_dpp v42, v34, v219 row_ror:8 row_mask:0xf bank_mask:0xf
    v_mul_f32_dpp v43, v35, v219 row_ror:8 row_mask:0xf bank_mask:0xf
    v_mul_f32_dpp v44, v36, v219 row_ror:8 row_mask:0xf bank_mask:0xf
    v_mul_f32_dpp v45, v37, v219 row_ror:8 row_mask:0xf bank_mask:0xf
    v_mul_f32_dpp v46, v38, v219 row_ror:8 row_mask:0xf bank_mask:0xf
    v_mul_f32_dpp v47, v39, v219 row_ror:8 row_mask:0xf bank_mask:0xf
    v_fma_f32 v32, v218, v32, v40
    v_fma_f32 v33, v218, v33, v41
    v_fma_f32 v34, v218, v34, v42
    v_fma_f32 v35, v218, v35, v43
    v_fma_f32 v36, v218, v36, v44
    v_fma_f32 v37, v218, v37, v45
    v_fma_f32 v38, v218, v38, v46
    v_fma_f32 v39, v218, v39, v47
    v_fma_f32 v56, v200, v0, v1
    v_fma_f32 v57, v204, v8, v9
    v_fma_f32 v58, v208, v16, v17
    v_fma_f32 v59, v212, v24, v25
    v_fma_f32 v60, v216, v32, v33
    v_fmac_f32_dpp v56, v0, v201 row_ror:8 row_mask:0xf bank_mask:0xf
    v_fmac_f32_dpp v57, v8, v205 row_ror:8 row_mask:0xf bank_mask:0xf
    v_fmac_f32_dpp v58, v16, v209 row_ror:8 row_mask:0xf bank_mask:0xf
    v_fmac_f32_dpp v59, v24, v213 row_ror:8 row_mask:0xf bank_mask:0xf
    v_fmac_f32_dpp v60, v32, v217 row_ror:8 row_mask:0xf bank_mask:0xf
    v_fma_f32 v50, v200, v56, v2
    v_fma_f32 v51, v204, v57, v10
    v_fma_f32 v52, v208, v58, v18
    v_fma_f32 v53, v212, v59, v26
    v_fma_f32 v54, v216, v60, v34
    v_fmac_f32_dpp v50, v56, v201 row_ror:8 row_mask:0xf bank_mask:0xf
    v_fmac_f32_dpp v51, v57, v205 row_ror:8 row_mask:0xf bank_mask:0xf
    v_fmac_f32_dpp v52, v58, v209 row_ror:8 row_mask:0xf bank_mask:0xf
    v_fmac_f32_dpp v53, v59, v213 row_ror:8 row_mask:0xf bank_mask:0xf
    v_fmac_f32_dpp v54, v60, v217 row_ror:8 row_mask:0xf bank_mask:0xf
    v_fma_f32 v56, v200, v50, v3
    v_fma_f32 v57, v204, v51, v11
    v_fma_f32 v58, v208, v52, v19
    v_fma_f32 v59, v212, v53, v27
    v_fma_f32 v60, v216, v54, v35
    v_fmac_f32_dpp v56, v50, v201 row_ror:8 row_mask:0xf bank_mask:0xf
    v_fmac_f32_dpp v57, v51, v205 row_ror:8 row_mask:0xf bank_mask:0xf
    v_fmac_f32_dpp v58, v52, v209 row_ror:8 row_mask:0xf bank_mask:0xf
    v_fmac_f32_dpp v59, v53, v213 row_ror:8 row_mask:0xf bank_mask:0xf
    v_fmac_f32_dpp v60, v54, v217 row_ror:8 row_mask:0xf bank_mask:0xf
    v_fma_f32 v50, v200, v56, v4
    v_fma_f32 v51, v204, v57, v12
    v_fma_f32 v52, v208, v58, v20
    v_fma_f32 v53, v212, v59, v28
    v_fma_f32 v54, v216, v60, v36
    v_fmac_f32_dpp v50, v56, v201 row_ror:8 row_mask:0xf bank_mask:0xf
    v_fmac_f32_dpp v51, v57, v205 row_ror:8 row_mask:0xf bank_mask:0xf
    v_fmac_f32_dpp v52, v58, v209 row_ror:8 row_mask:0xf bank_mask:0xf
    v_fmac_f32_dpp v53, v59, v213 row_ror:8 row_mask:0xf bank_mask:0xf
    v_fmac_f32_dpp v54, v60, v217 row_ror:8 row_mask:0xf bank_mask:0xf
    v_fma_f32 v56, v200, v50, v5
    v_fma_f32 v57, v204, v51, v13
    v_fma_f32 v58, v208, v52, v21
    v_fma_f32 v59, v212, v53, v29
    v_fma_f32 v60, v216, v54, v37
    v_fmac_f32_dpp v56, v50, v201 row_ror:8 row_mask:0xf bank_mask:0xf
    v_fmac_f32_dpp v57, v51, v205 row_ror:8 row_mask:0xf bank_mask:0xf
    v_fmac_f32_dpp v58, v52, v209 row_ror:8 row_mask:0xf bank_mask:0xf
    v_fmac_f32_dpp v59, v53, v213 row_ror:8 row_mask:0xf bank_mask:0xf
    v_fmac_f32_dpp v60, v54, v217 row_ror:8 row_mask:0xf bank_mask:0xf
    v_fma_f32 v50, v200, v56, v6
    v_fma_f32 v51, v204, v57, v14
    v_fma_f32 v52, v208, v58, v22
    v_fma_f32 v53, v212, v59, v30
    v_fma_f32 v54, v216, v60, v38
    v_fmac_f32_dpp v50, v56, v201 row_ror:8 row_mask:0xf bank_mask:0xf
    v_fmac_f32_dpp v51, v57, v205 row_ror:8 row_mask:0xf bank_mask:0xf
    v_fmac_f32_dpp v52, v58, v209 row_ror:8 row_mask:0xf bank_mask:0xf
    v_fmac_f32_dpp v53, v59, v213 row_ror:8 row_mask:0xf bank_mask:0xf
    v_fmac_f32_dpp v54, v60, v217 row_ror:8 row_mask:0xf bank_mask:0xf
    v_fma_f32 v56, v200, v50, v7
    v_fma_f32 v57, v204, v51, v15
    v_fma_f32 v58, v208, v52, v23
    v_fma_f32 v59, v212, v53, v31
    v_fma_f32 v60, v216, v54, v39
    v_fmac_f32_dpp v56, v50, v201 row_ror:8 row_mask:0xf bank_mask:0xf
    v_fmac_f32_dpp v57, v51, v205 row_ror:8 row_mask:0xf bank_mask:0xf
    v_fmac_f32_dpp v58, v52, v209 row_ror:8 row_mask:0xf bank_mask:0xf
    v_fmac_f32_dpp v59, v53, v213 row_ror:8 row_mask:0xf bank_mask:0xf
    v_fmac_f32_dpp v60, v54, v217 row_ror:8 row_mask:0xf bank_mask:0xf
    ds_write_b32 v150, v56 offset:0
    ds_write_b32 v150, v57 offset:64
    ds_write_b32 v150, v58 offset:128
    ds_write_b32 v150, v59 offset:192
    ds_write_b32 v150, v60 offset:256
    v_mov_b32 v104, 11
    ds_write_b32 v253, v104
    s_cmp_eq_u32 s34, 1
    s_cbranch_scc1 L_wave1
    s_cmp_eq_u32 s34, 0
    s_cbranch_scc0 L_wave23
L_pw_15:
    ds_read_b32 v105, v191
    s_waitcnt lgkmcnt(0)
    v_cmp_gt_u32 vcc, 11, v105
    s_cbranch_vccnz L_pwr_16
    s_mov_b32 exec_hi, 0xff
    ds_read_b64 v[110:111], v156 offset:512
    ds_read_b64 v[112:113], v156 offset:832
    ds_read_b64 v[114:115], v156 offset:1152
    ds_read_b64 v[116:117], v156 offset:1472
    ds_read_b64 v[118:119], v156 offset:1792
    ds_read_b64 v[120:121], v156 offset:2112
    ds_read_b64 v[122:123], v156 offset:2432
    ds_read_b64 v[124:125], v156 offset:2752
    ds_read_b64 v[126:127], v156 offset:3072
    ds_read_b64 v[128:129], v156 offset:3392
    ds_read_b64 v[130:131], v156 offset:3712
    ds_read_b64 v[132:133], v156 offset:4032
    ds_read_b64 v[134:135], v156 offset:4352
    ds_read_b64 v[136:137], v156 offset:4672
    ds_read_b64 v[138:139], v156 offset:4992
    ds_read_b64 v[140:141], v156 offset:5312
    v_mov_b32 v142, 0
    v_mov_b32 v143, 0
    s_waitcnt lgkmcnt(0)
    ds_write_b64 v156, v[142:143] offset:5632
    ds_write_b64 v156, v[110:111] offset:5952
    v_fma_f32 v112, v146, v110, v112
    v_fma_f32 v113, v146, v111, v113
    v_fma_f32 v112, -v147, v111, v112
    v_fmac_f32 v113, v147, v110
    ds_write_b64 v156, v[112:113] offset:6272
    v_fma_f32 v114, v146, v112, v114
    v_fma_f32 v115, v146, v113, v115
    v_fma_f32 v114, -v147, v113, v114
    v_fmac_f32 v115, v147, v112
    ds_write_b64 v156, v[114:115] offset:6592
    v_fma_f32 v116, v146, v114, v116
    v_fma_f32 v117, v146, v115, v117
    v_fma_f32 v116, -v147, v115, v116
    v_fmac_f32 v117, v147, v114
    ds_write_b64 v156, v[116:117] offset:6912
    v_fma_f32 v118, v146, v116, v118
    v_fma_f32 v119, v146, v117, v119
    v_fma_f32 v118, -v147, v117, v118
    v_fmac_f32 v119, v147, v116
    ds_write_b64 v156, v[118:119] offset:7232
    v_fma_f32 v120, v146, v118, v120
    v_fma_f32 v121, v146, v119, v121
    v_fma_f32 v120, -v147, v119, v120
    v_fmac_f32 v121, v147, v118
    ds_write_b64 v156, v[120:121] offset:7552
    v_fma_f32 v122, v146, v120, v122
    v_fma_f32 v123, v146, v121, v123
    v_fma_f32 v122, -v147, v121, v122
    v_fmac_f32 v123, v147, v120
    ds_write_b64 v156, v[122:123] offset:7872
    v_fma_f32 v124, v146, v122, v124
    v_fma_f32 v125, v146, v123, v125
    v_fma_f32 v124, -v147, v123, v124
    v_fmac_f32 v125, v147, v122
    ds_write_b64 v156, v[124:125] offset:8192
    v_fma_f32 v126, v146, v124, v126
    v_fma_f32 v127, v146, v125, v127
    v_fma_f32 v126, -v147, v125, v126
    v_fmac_f32 v127, v147, v124
    ds_write_b64 v156, v[126:127] offset:8512
    v_fma_f32 v128, v146, v126, v128
    v_fma_f32 v129, v146, v127, v129
    v_fma_f32 v128, -v147, v127, v128
    v_fmac_f32 v129, v147, v126
    ds_write_b64 v156, v[128:129] offset:8832
    v_fma_f32 v130, v146, v128, v130
    v_fma_f32 v131, v146, v129, v131
    v_fma_f32 v130, -v147, v129, v130
    v_fmac_f32 v131, v147, v128
    ds_write_b64 v156, v[130:131] offset:9152
    v_fma_f32 v132, v146, v130, v132
    v_fma_f32 v133, v146, v131, v133
    v_fma_f32 v132, -v147, v131, v132
    v_fmac_f32 v133, v147, v130
    ds_write_b64 v156, v[132:133] offset:9472
    v_fma_f32 v134, v146, v132, v134
    v_fma_f32 v135, v146, v133, v135
    v_fma_f32 v134, -v147, v133, v134
    v_fmac_f32 v135, v147, v132
    ds_write_b64 v156, v[134:135] offset:9792
    v_fma_f32 v136, v146, v134, v136
    v_fma_f32 v137, v146, v135, v137
    v_fma_f32 v136, -v147, v135, v136
    v_fmac_f32 v137, v147, v134
    ds_write_b64 v156, v[136:137] offset:10112
    v_fma_f32 v138, v146, v136, v138
    v_fma_f32 v139, v146, v137, v139
    v_fma_f32 v138, -v147, v137, v138
    v_fmac_f32 v139, v147, v136
    ds_write_b64 v156, v[138:139] offset:10432
    v_fma_f32 v140, v146, v138, v140
    v_fma_f32 v141, v146, v139, v141
    v_fma_f32 v140, -v147, v139, v140
    v_fmac_f32 v141, v147, v138
    v_min_u32 v140, -2, v140
    v_min_u32 v141, -2, v141
    buffer_store_dwordx2 v[140:141], v155, s[56:59], s70 offen sc1
    s_mov_b32 exec_hi, -1
    v_mov_b32 v104, 12
    ds_write_b32 v253, v104
    s_branch L_coldone
L_wave1:
L_hint:
    buffer_load_dword v105, v160, s[56:59], s70 offen offset:512 sc1
    s_waitcnt vmcnt(0)
    v_cmp_eq_u32 vcc, -1, v105
    s_cbranch_vccz L_hintok
    s_mov_b64 exec, vcc
    s_sleep 3
L_hint2:
    s_sub_u32 s96, s96, 1
    s_cbranch_scc0 L_hint
    s_endpgm
L_hintok:
    s_mov_b32 exec_lo, -1
    s_mov_b32 exec_hi, 0xff
    buffer_load_dwordx2 v[110:111], v155, s[56:59], s71 offen offset:3584 sc1
    buffer_load_dwordx2 v[112:113], v155, s[56:59], s71 offen offset:3072 sc1
    buffer_load_dwordx2 v[114:115], v155, s[56:59], s71 offen offset:2560 sc1
    buffer_load_dwordx2 v[116:117], v155, s[56:59], s71 offen offset:2048 sc1
    buffer_load_dwordx2 v[118:119], v155, s[56:59], s71 offen offset:1536 sc1
    buffer_load_dwordx2 v[120:121], v155, s[56:59], s71 offen offset:1024 sc1
    buffer_load_dwordx2 v[122:123], v155, s[56:59], s71 offen offset:512 sc1
    buffer_load_dwordx2 v[124:125], v155, s[56:59], s71 offen offset:0 sc1
    buffer_load_dwordx2 v[126:127], v155, s[56:59], s70 offen offset:3584 sc1
    buffer_load_dwordx2 v[128:129], v155, s[56:59], s70 offen offset:3072 sc1
    buffer_load_dwordx2 v[130:131], v155, s[56:59], s70 offen offset:2560 sc1
    buffer_load_dwordx2 v[132:133], v155, s[56:59], s70 offen offset:2048 sc1
    buffer_load_dwordx2 v[134:135], v155, s[56:59], s70 offen offset:1536 sc1
    buffer_load_dwordx2 v[136:137], v155, s[56:59], s70 offen offset:1024 sc1
    buffer_load_dwordx2 v[138:139], v155, s[56:59], s70 offen offset:512 sc1
    s_waitcnt vmcnt(0)
    v_max_u32 v105, v110, v111
    v_max3_u32 v105, v105, v112, v113
    v_max3_u32 v105, v105, v114, v115
    v_max3_u32 v105, v105, v116, v117
    v_max3_u32 v105, v105, v118, v119
    v_max3_u32 v105, v105, v120, v121
    v_max3_u32 v105, v105, v122, v123
    v_max3_u32 v105, v105, v124, v125
    v_max3_u32 v105, v105, v126, v127
    v_max3_u32 v105, v105, v128, v129
    v_max3_u32 v105, v105, v130, v131
    v_max3_u32 v105, v105, v132, v133
    v_max3_u32 v105, v105, v134, v135
    v_max3_u32 v105, v105, v136, v137
    v_max3_u32 v105, v105, v138, v139
    v_cmp_eq_u32 vcc, -1, v105
    s_cbranch_vccnz L_hint2
    v_fma_f32 v112, v146, v110, v112
    v_fma_f32 v113, v146, v111, v113
    v_fma_f32 v112, -v147, v111, v112
    v_fmac_f32 v113, v147, v110
    v_fma_f32 v114, v146, v112, v114
    v_fma_f32 v115, v146, v113, v115
    v_fma_f32 v114, -v147, v113, v114
    v_fmac_f32 v115, v147, v112
    v_fma_f32 v116, v146, v114, v116
    v_fma_f32 v117, v146, v115, v117
    v_fma_f32 v116, -v147, v115, v116
    v_fmac_f32 v117, v147, v114
    v_fma_f32 v118, v146, v116, v118
    v_fma_f32 v119, v146, v117, v119
    v_fma_f32 v118, -v147, v117, v118
    v_fmac_f32 v119, v147, v116
    v_fma_f32 v120, v146, v118, v120
    v_fma_f32 v121, v146, v119, v121
    v_fma_f32 v120, -v147, v119, v120
    v_fmac_f32 v121, v147, v118
    v_fma_f32 v122, v146, v120, v122
    v_fma_f32 v123, v146, v121, v123
    v_fma_f32 v122, -v147, v121, v122
    v_fmac_f32 v123, v147, v120
    v_fma_f32 v124, v146, v122, v124
    v_fma_f32 v125, v146, v123, v125
    v_fma_f32 v124, -v147, v123, v124
    v_fmac_f32 v125, v147, v122
    v_fma_f32 v126, v146, v124, v126
    v_fma_f32 v127, v146, v125, v127
    v_fma_f32 v126, -v147, v125, v126
    v_fmac_f32 v127, v147, v124
    v_fma_f32 v128, v146, v126, v128
    v_fma_f32 v129, v146, v127, v129
    v_fma_f32 v128, -v147, v127, v128
    v_fmac_f32 v129, v147, v126
    v_fma_f32 v130, v146, v128, v130
    v_fma_f32 v131, v146, v129, v131
    v_fma_f32 v130, -v147, v129, v130
    v_fmac_f32 v131, v147, v128
    v_fma_f32 v132, v146, v130, v132
    v_fma_f32 v133, v146, v131, v133
    v_fma_f32 v132, -v147, v131, v132
    v_fmac_f32 v133, v147, v130
    v_fma_f32 v134, v146, v132, v134
    v_fma_f32 v135, v146, v133, v135
    v_fma_f32 v134, -v147, v133, v134
    v_fmac_f32 v135, v147, v132
    v_fma_f32 v136, v146, v134, v136
    v_fma_f32 v137, v146, v135, v137
    v_fma_f32 v136, -v147, v135, v136
    v_fmac_f32 v137, v147, v134
    v_fma_f32 v138, v146, v136, v138
    v_fma_f32 v139, v146, v137, v139
    v_fma_f32 v138, -v147, v137, v138
    v_fmac_f32 v139, v147, v136
    ds_write_b64 v156, v[138:139]
    s_mov_b32 exec_hi, -1
    v_mov_b32 v104, 12
    ds_write_b32 v253, v104
    s_branch L_coldone
L_wave23:
L_coldone:
    s_lshl2_add_u32 s70, s64, s34
    s_mul_i32 s71, s70, 81920
    s_mul_i32 s78, s97, 1280
    s_add_u32 s71, s71, s78
    s_add_u32 s71, s71, 0x800000
    s_lshl4_add_u32 s70, s70, s97
    s_lshl_b32 s70, s70, 7
    s_add_u32 s70, s70, 0xfa8000
L_pw_17:
    ds_read_b32 v105, v158
    s_waitcnt lgkmcnt(0)
    v_cmp_gt_u32 vcc, 12, v105
    s_cbranch_vccnz L_pwr_18
    s_cmp_eq_u32 s34, 1
    s_cselect_b32 s78, s20, s22
    s_cselect_b32 s79, s21, s23
    s_cmp_eq_u32 s34, 2
    s_cselect_b32 s78, s8, s78
    s_cselect_b32 s79, s9, s79
    s_mul_i32 s80, s2, 3200
    s_add_u32 s78, s78, s80
    s_addc_u32 s79, s79, 0
    s_cmp_eq_u32 s34, 0
    s_cbranch_scc1 L_notouch
    s_mov_b64 exec, 0x1ffffff
    global_load_dword v109, v192, s[78:79]
    s_mov_b64 exec, -1
L_notouch:
    ds_read_b32 v50, v150 offset:5120
    ds_read_b32 v56, v157 offset:0
    ds_read_b32 v51, v150 offset:5184
    ds_read_b32 v57, v157 offset:64
    ds_read_b32 v52, v150 offset:5248
    ds_read_b32 v58, v157 offset:128
    ds_read_b32 v53, v150 offset:5312
    ds_read_b32 v59, v157 offset:192
    ds_read_b32 v54, v150 offset:5376
    ds_read_b32 v60, v157 offset:256
    s_waitcnt lgkmcnt(0)
    v_fmac_f32 v50, v176, v56
    v_fmac_f32 v51, v178, v57
    v_fmac_f32 v52, v180, v58
    v_fmac_f32 v53, v182, v59
    v_fmac_f32 v54, v184, v60
    v_fmac_f32_dpp v50, v56, v177 row_ror:8 row_mask:0xf bank_mask:0xf
    v_fmac_f32_dpp v51, v57, v179 row_ror:8 row_mask:0xf bank_mask:0xf
    v_fmac_f32_dpp v52, v58, v181 row_ror:8 row_mask:0xf bank_mask:0xf
    v_fmac_f32_dpp v53, v59, v183 row_ror:8 row_mask:0xf bank_mask:0xf
    v_fmac_f32_dpp v54, v60, v185 row_ror:8 row_mask:0xf bank_mask:0xf
    v_fmac_f32 v0, v200, v50
    v_fmac_f32 v8, v204, v51
    v_fmac_f32 v16, v208, v52
    v_fmac_f32 v24, v212, v53
    v_fmac_f32 v32, v216, v54
    v_fmac_f32_dpp v0, v50, v201 row_ror:8 row_mask:0xf bank_mask:0xf
    v_fmac_f32_dpp v8, v51, v205 row_ror:8 row_mask:0xf bank_mask:0xf
    v_fmac_f32_dpp v16, v52, v209 row_ror:8 row_mask:0xf bank_mask:0xf
    v_fmac_f32_dpp v24, v53, v213 row_ror:8 row_mask:0xf bank_mask:0xf
    v_fmac_f32_dpp v32, v54, v217 row_ror:8 row_mask:0xf bank_mask:0xf
    v_fmac_f32 v1, v200, v0
    v_fmac_f32 v9, v204, v8
    v_fmac_f32 v17, v208, v16
    v_fmac_f32 v25, v212, v24
    v_fmac_f32 v33, v216, v32
    v_fmac_f32_dpp v1, v0, v201 row_ror:8 row_mask:0xf bank_mask:0xf
    v_fmac_f32_dpp v9, v8, v205 row_ror:8 row_mask:0xf bank_mask:0xf
    v_fmac_f32_dpp v17, v16, v209 row_ror:8 row_mask:0xf bank_mask:0xf
    v_fmac_f32_dpp v25, v24, v213 row_ror:8 row_mask:0xf bank_mask:0xf
    v_fmac_f32_dpp v33, v32, v217 row_ror:8 row_mask:0xf bank_mask:0xf
    v_fmac_f32 v2, v200, v1
    v_fmac_f32 v10, v204, v9
    v_fmac_f32 v18, v208, v17
    v_fmac_f32 v26, v212, v25
    v_fmac_f32 v34, v216, v33
    v_fmac_f32_dpp v2, v1, v201 row_ror:8 row_mask:0xf bank_mask:0xf
    v_fmac_f32_dpp v10, v9, v205 row_ror:8 row_mask:0xf bank_mask:0xf
    v_fmac_f32_dpp v18, v17, v209 row_ror:8 row_mask:0xf bank_mask:0xf
    v_fmac_f32_dpp v26, v25, v213 row_ror:8 row_mask:0xf bank_mask:0xf
    v_fmac_f32_dpp v34, v33, v217 row_ror:8 row_mask:0xf bank_mask:0xf
    v_fmac_f32 v3, v200, v2
    v_fmac_f32 v11, v204, v10
    v_fmac_f32 v19, v208, v18
    v_fmac_f32 v27, v212, v26
    v_fmac_f32 v35, v216, v34
    v_fmac_f32_dpp v3, v2, v201 row_ror:8 row_mask:0xf bank_mask:0xf
    v_fmac_f32_dpp v11, v10, v205 row_ror:8 row_mask:0xf bank_mask:0xf
    v_fmac_f32_dpp v19, v18, v209 row_ror:8 row_mask:0xf bank_mask:0xf
    v_fmac_f32_dpp v27, v26, v213 row_ror:8 row_mask:0xf bank_mask:0xf
    v_fmac_f32_dpp v35, v34, v217 row_ror:8 row_mask:0xf bank_mask:0xf
    v_fmac_f32 v4, v200, v3
    v_fmac_f32 v12, v204, v11
    v_fmac_f32 v20, v208, v19
    v_fmac_f32 v28, v212, v27
    v_fmac_f32 v36, v216, v35
    v_fmac_f32_dpp v4, v3, v201 row_ror:8 row_mask:0xf bank_mask:0xf
    v_fmac_f32_dpp v12, v11, v205 row_ror:8 row_mask:0xf bank_mask:0xf
    v_fmac_f32_dpp v20, v19, v209 row_ror:8 row_mask:0xf bank_mask:0xf
    v_fmac_f32_dpp v28, v27, v213 row_ror:8 row_mask:0xf bank_mask:0xf
    v_fmac_f32_dpp v36, v35, v217 row_ror:8 row_mask:0xf bank_mask:0xf
    v_fmac_f32 v5, v200, v4
    v_fmac_f32 v13, v204, v12
    v_fmac_f32 v21, v208, v20
    v_fmac_f32 v29, v212, v28
    v_fmac_f32 v37, v216, v36
    v_fmac_f32_dpp v5, v4, v201 row_ror:8 row_mask:0xf bank_mask:0xf
    v_fmac_f32_dpp v13, v12, v205 row_ror:8 row_mask:0xf bank_mask:0xf
    v_fmac_f32_dpp v21, v20, v209 row_ror:8 row_mask:0xf bank_mask:0xf
    v_fmac_f32_dpp v29, v28, v213 row_ror:8 row_mask:0xf bank_mask:0xf
    v_fmac_f32_dpp v37, v36, v217 row_ror:8 row_mask:0xf bank_mask:0xf
    v_fmac_f32 v6, v200, v5
    v_fmac_f32 v14, v204, v13
    v_fmac_f32 v22, v208, v21
    v_fmac_f32 v30, v212, v29
    v_fmac_f32 v38, v216, v37
    v_fmac_f32_dpp v6, v5, v201 row_ror:8 row_mask:0xf bank_mask:0xf
    v_fmac_f32_dpp v14, v13, v205 row_ror:8 row_mask:0xf bank_mask:0xf
    v_fmac_f32_dpp v22, v21, v209 row_ror:8 row_mask:0xf bank_mask:0xf
    v_fmac_f32_dpp v30, v29, v213 row_ror:8 row_mask:0xf bank_mask:0xf
    v_fmac_f32_dpp v38, v37, v217 row_ror:8 row_mask:0xf bank_mask:0xf
    v_fmac_f32 v7, v200, v6
    v_fmac_f32 v15, v204, v14
    v_fmac_f32 v23, v208, v22
    v_fmac_f32 v31, v212, v30
    v_fmac_f32 v39, v216, v38
    v_fmac_f32_dpp v7, v6, v201 row_ror:8 row_mask:0xf bank_mask:0xf
    v_fmac_f32_dpp v15, v14, v205 row_ror:8 row_mask:0xf bank_mask:0xf
    v_fmac_f32_dpp v23, v22, v209 row_ror:8 row_mask:0xf bank_mask:0xf
    v_fmac_f32_dpp v31, v30, v213 row_ror:8 row_mask:0xf bank_mask:0xf
    v_fmac_f32_dpp v39, v38, v217 row_ror:8 row_mask:0xf bank_mask:0xf
    v_cvt_pk_bf16_f32 v64, v0, v1
    v_cvt_pk_bf16_f32 v65, v2, v3
    v_cvt_pk_bf16_f32 v66, v4, v5
    v_cvt_pk_bf16_f32 v67, v6, v7
    ds_write_b128 v151, v[64:67] offset:0
    ds_read_b64_tr_b16 v[110:111], v152 offset:0
    ds_read_b64_tr_b16 v[112:113], v153 offset:256
    v_cvt_pk_bf16_f32 v68, v8, v9
    v_cvt_pk_bf16_f32 v69, v10, v11
    v_cvt_pk_bf16_f32 v70, v12, v13
    v_cvt_pk_bf16_f32 v71, v14, v15
    ds_write_b128 v151, v[68:71] offset:1024
    ds_read_b64_tr_b16 v[114:115], v152 offset:1024
    ds_read_b64_tr_b16 v[116:117], v153 offset:1280
    v_cvt_pk_bf16_f32 v72, v16, v17
    v_cvt_pk_bf16_f32 v73, v18, v19
    v_cvt_pk_bf16_f32 v74, v20, v21
    v_cvt_pk_bf16_f32 v75, v22, v23
    ds_write_b128 v151, v[72:75] offset:2048
    ds_read_b64_tr_b16 v[118:119], v152 offset:2048
    ds_read_b64_tr_b16 v[120:121], v153 offset:2304
    v_cvt_pk_bf16_f32 v76, v24, v25
    v_cvt_pk_bf16_f32 v77, v26, v27
    v_cvt_pk_bf16_f32 v78, v28, v29
    v_cvt_pk_bf16_f32 v79, v30, v31
    ds_write_b128 v151, v[76:79] offset:3072
    ds_read_b64_tr_b16 v[122:123], v152 offset:3072
    ds_read_b64_tr_b16 v[124:125], v153 offset:3328
    v_cvt_pk_bf16_f32 v80, v32, v33
    v_cvt_pk_bf16_f32 v81, v34, v35
    v_cvt_pk_bf16_f32 v82, v36, v37
    v_cvt_pk_bf16_f32 v83, v38, v39
    ds_write_b128 v151, v[80:83] offset:4096
    ds_read_b64_tr_b16 v[126:127], v152 offset:4096
    ds_read_b64_tr_b16 v[128:129], v153 offset:4352
    s_waitcnt lgkmcnt(12)
    buffer_store_dwordx4 v[110:113], v154, s[44:47], s71 offen offset:0 sc1
    s_waitcnt lgkmcnt(9)
    buffer_store_dwordx4 v[114:117], v154, s[44:47], s71 offen offset:256 sc1
    s_waitcnt lgkmcnt(0)
    v_mov_b32 v104, 13
    ds_write_b32 v253, v104
    s_waitcnt vmcnt(1)
    buffer_store_dwordx4 v[118:121], v154, s[44:47], s71 offen offset:512 sc1
    s_waitcnt vmcnt(1)
    buffer_store_dwordx4 v[122:125], v154, s[44:47], s71 offen offset:768 sc1
    s_waitcnt vmcnt(1)
    buffer_store_dwordx4 v[126:129], v154, s[44:47], s71 offen offset:1024 sc1
    s_cmp_ge_u32 s34, 2
    s_cselect_b32 s78, s22, s20
    s_cselect_b32 s79, s23, s21
    s_mov_b32 s40, s78
    s_mov_b32 s41, s79
    s_mov_b32 s42, 0xc8000
    s_mov_b32 s43, 0x20000
    s_mov_b32 s60, s28
    s_mov_b32 s61, s29
    s_mov_b32 s62, 0xa00000
    s_mov_b32 s63, 0x20000
    s_mul_i32 s74, s34, 14848
    s_add_u32 s74, s74, 102400
    s_and_b32 s78, s34, 1
    s_mul_i32 s72, s69, 102400
    s_mul_i32 s73, s78, 640
    s_add_u32 s72, s72, s73
    s_mul_i32 s79, s34, 10240
    s_add_u32 s79, s79, 0x800000
    s_lshr_b32 s80, s34, 1
    s_lshl1_add_u32 s78, s78, s80
    s_xor_b32 s80, s78, 0
    s_lshl2_add_u32 s80, s68, s80
    s_mul_i32 s80, s80, 40960
    s_add_u32 s84, s80, s79
    s_xor_b32 s80, s78, 1
    s_lshl2_add_u32 s80, s68, s80
    s_mul_i32 s80, s80, 40960
    s_add_u32 s85, s80, s79
    s_xor_b32 s80, s78, 2
    s_lshl2_add_u32 s80, s68, s80
    s_mul_i32 s80, s80, 40960
    s_add_u32 s86, s80, s79
    s_xor_b32 s80, s78, 3
    s_lshl2_add_u32 s80, s68, s80
    s_mul_i32 s80, s80, 40960
    s_add_u32 s87, s80, s79
    s_lshl_b32 s88, s68, 12
    s_add_u32 s88, s88, 0xfa8000
    s_lshl2_add_u32 s78, s68, s78
    s_mul_i32 s80, s78, 20480
    s_mul_i32 s81, s69, 160
    s_add_u32 s80, s80, s81
    s_mul_i32 s82, s78, 81920
    s_lshl1_add_u32 s82, s81, s82
    s_add_u32 s82, s82, 2560
    s_add_u32 s90, s26, s81
    s_addc_u32 s91, s27, 0
    s_lshl2_add_u32 s89, s69, s34
    s_mul_i32 s89, s89, 5120
    s_mul_i32 s79, s68, 163840
    s_add_u32 s89, s89, s79
    s_add_u32 s89, s89, 0x800000
    s_waitcnt vmcnt(0)
    v_mov_b32 v40, 1
    s_mov_b64 exec, 1
    buffer_store_dword v40, off, s[44:47], s70 sc1
    s_mov_b64 exec, -1
    s_mov_b32 s36, s8
    s_mov_b32 s37, s9
    s_mov_b32 s38, 0xc8000
    s_mov_b32 s39, 0x20000
    s_and_b32 s83, s35, 3
    s_add_u32 s83, s83, s3
    s_cmp_ge_u32 s83, 5
    s_cselect_b32 s73, 5, 0
    s_sub_u32 s83, s83, s73
    s_cmp_ge_u32 s83, 5
    s_cselect_b32 s73, 5, 0
    s_sub_u32 s83, s83, s73
    s_lshl_b32 s73, s83, 7
    s_add_u32 s4, s72, s73
    s_lshl_b32 s12, s83, 11
    s_lshl2_add_u32 s17, s83, s34
    s_add_u32 s83, s83, 1
    s_cmp_eq_u32 s83, 5
    s_cselect_b32 s83, 0, s83
    s_lshl_b32 s73, s83, 7
    s_add_u32 s5, s72, s73
    s_lshl_b32 s13, s83, 11
    s_lshl2_add_u32 s18, s83, s34
    s_add_u32 s83, s83, 1
    s_cmp_eq_u32 s83, 5
    s_cselect_b32 s83, 0, s83
    s_lshl_b32 s73, s83, 7
    s_add_u32 s6, s72, s73
    s_lshl_b32 s14, s83, 11
    s_lshl2_add_u32 s19, s83, s34
    s_add_u32 s83, s83, 1
    s_cmp_eq_u32 s83, 5
    s_cselect_b32 s83, 0, s83
    s_lshl_b32 s73, s83, 7
    s_add_u32 s7, s72, s73
    s_lshl_b32 s15, s83, 11
    s_lshl2_add_u32 s20, s83, s34
    s_add_u32 s83, s83, 1
    s_cmp_eq_u32 s83, 5
    s_cselect_b32 s83, 0, s83
    s_lshl_b32 s73, s83, 7
    s_add_u32 s8, s72, s73
    s_lshl_b32 s16, s83, 11
    s_lshl2_add_u32 s21, s83, s34
    s_add_u32 s83, s83, 1
    s_cmp_eq_u32 s83, 5
    s_cselect_b32 s83, 0, s83
    s_mul_i32 s75, s69, 160
L_pw_19:
    ds_read_b32 v41, v191
    s_waitcnt lgkmcnt(0)
    v_cmp_gt_u32 vcc, 13, v41
    s_cbranch_vccnz L_pwr_20
    s_add_u32 m0, s74, 0
    s_add_u32 s76, s4, 0
    s_waitcnt vmcnt(3)
    buffer_load_dwordx4 v248, s[40:43], s76 offen offset:0 lds
    s_waitcnt vmcnt(3)
    buffer_load_dwordx4 v249, s[40:43], s76 offen offset:1024 lds
    s_add_u32 m0, s74, 2048
    s_add_u32 s76, s4, 20480
    s_waitcnt vmcnt(3)
    buffer_load_dwordx4 v248, s[40:43], s76 offen offset:0 lds
    s_waitcnt vmcnt(3)
    buffer_load_dwordx4 v249, s[40:43], s76 offen offset:1024 lds
    s_add_u32 m0, s74, 4096
    s_add_u32 s76, s4, 40960
    s_waitcnt vmcnt(3)
    buffer_load_dwordx4 v248, s[40:43], s76 offen offset:0 lds
    s_waitcnt vmcnt(3)
    buffer_load_dwordx4 v249, s[40:43], s76 offen offset:1024 lds
    s_add_u32 m0, s74, 6144
    s_add_u32 s76, s4, 61440
    s_waitcnt vmcnt(3)
    buffer_load_dwordx4 v248, s[40:43], s76 offen offset:0 lds
    s_waitcnt vmcnt(3)
    buffer_load_dwordx4 v249, s[40:43], s76 offen offset:1024 lds
    s_mul_i32 s79, s17, 40960
    s_add_u32 s79, s79, s75
    s_mul_i32 s78, s17, 5120
    s_mov_b32 m0, s78
    s_waitcnt vmcnt(2)
    buffer_load_dwordx4 v186, s[36:39], s79 offen offset:0 lds
    s_waitcnt vmcnt(2)
    buffer_load_dwordx4 v187, s[36:39], s79 offen offset:1024 lds
    s_waitcnt vmcnt(2)
    buffer_load_dwordx4 v188, s[36:39], s79 offen offset:2048 lds
    s_waitcnt vmcnt(2)
    buffer_load_dwordx4 v189, s[36:39], s79 offen offset:3072 lds
    s_add_u32 m0, s78, 4096
    s_waitcnt vmcnt(2)
    buffer_load_dwordx4 v190, s[36:39], s79 offen offset:0 lds
    s_mul_i32 s79, s18, 40960
    s_add_u32 s79, s79, s75
    s_mul_i32 s78, s18, 5120
    s_mov_b32 m0, s78
    s_waitcnt vmcnt(2)
    buffer_load_dwordx4 v186, s[36:39], s79 offen offset:0 lds
    s_waitcnt vmcnt(2)
    buffer_load_dwordx4 v187, s[36:39], s79 offen offset:1024 lds
    s_waitcnt vmcnt(2)
    buffer_load_dwordx4 v188, s[36:39], s79 offen offset:2048 lds
    s_waitcnt vmcnt(2)
    buffer_load_dwordx4 v189, s[36:39], s79 offen offset:3072 lds
    s_add_u32 m0, s78, 4096
    s_waitcnt vmcnt(2)
    buffer_load_dwordx4 v190, s[36:39], s79 offen offset:0 lds
    s_mov_b32 exec_hi, 0
    buffer_load_dword v41, v192, s[44:47], s88 offen sc1
    s_mov_b32 exec_hi, -1
    s_mul_i32 s79, s19, 40960
    s_add_u32 s79, s79, s75
    s_mul_i32 s78, s19, 5120
    s_mov_b32 m0, s78
    s_waitcnt vmcnt(2)
    buffer_load_dwordx4 v186, s[36:39], s79 offen offset:0 lds
    s_waitcnt vmcnt(2)
    buffer_load_dwordx4 v187, s[36:39], s79 offen offset:1024 lds
    s_waitcnt vmcnt(2)
    buffer_load_dwordx4 v188, s[36:39], s79 offen offset:2048 lds
    s_waitcnt vmcnt(2)
    buffer_load_dwordx4 v189, s[36:39], s79 offen offset:3072 lds
    s_add_u32 m0, s78, 4096
    s_waitcnt vmcnt(2)
    buffer_load_dwordx4 v190, s[36:39], s79 offen offset:0 lds
    s_mov_b32 exec_hi, 0
    s_waitcnt vmcnt(5)
    v_cmp_eq_u32 vcc, 0, v41
    s_cbranch_vccz L_f3seen
    s_mov_b64 exec, vcc
L_pf_21:
    buffer_load_dword v41, v192, s[44:47], s88 offen sc1
    s_waitcnt vmcnt(0)
    v_cmp_eq_u32 vcc, 0, v41
    s_cbranch_vccnz L_pfr_22
    s_mov_b64 exec, -1
L_f3seen:
    s_mov_b64 exec, -1
    buffer_load_dword v41, v193, s[44:47], s89 offen sc1
    s_mul_i32 s79, s20, 40960
    s_add_u32 s79, s79, s75
    s_mul_i32 s78, s20, 5120
    s_mov_b32 m0, s78
    s_waitcnt vmcnt(2)
    buffer_load_dwordx4 v186, s[36:39], s79 offen offset:0 lds
    s_waitcnt vmcnt(2)
    buffer_load_dwordx4 v187, s[36:39], s79 offen offset:1024 lds
    s_waitcnt vmcnt(2)
    buffer_load_dwordx4 v188, s[36:39], s79 offen offset:2048 lds
    s_waitcnt vmcnt(2)
    buffer_load_dwordx4 v189, s[36:39], s79 offen offset:3072 lds
    s_add_u32 m0, s78, 4096
    s_waitcnt vmcnt(2)
    buffer_load_dwordx4 v190, s[36:39], s79 offen offset:0 lds
    s_mul_i32 s79, s21, 40960
    s_add_u32 s79, s79, s75
    s_mul_i32 s78, s21, 5120
    s_mov_b32 m0, s78
    s_waitcnt vmcnt(3)
    buffer_load_dwordx4 v186, s[36:39], s79 offen offset:0 lds
    s_add_u32 s9, s84, s12
    buffer_load_dwordx4 v[80:83], v252, s[44:47], s9 offen offset:0 sc1
    s_add_u32 s9, s84, s12
    buffer_load_dwordx4 v[96:99], v252, s[44:47], s9 offen offset:1024 sc1
    s_waitcnt vmcnt(3)
    buffer_load_dwordx4 v187, s[36:39], s79 offen offset:1024 lds
    s_add_u32 s9, s85, s12
    buffer_load_dwordx4 v[84:87], v252, s[44:47], s9 offen offset:0 sc1
    s_add_u32 s9, s85, s12
    buffer_load_dwordx4 v[100:103], v252, s[44:47], s9 offen offset:1024 sc1
    s_waitcnt vmcnt(3)
    buffer_load_dwordx4 v188, s[36:39], s79 offen offset:2048 lds
    s_add_u32 s9, s86, s12
    buffer_load_dwordx4 v[88:91], v252, s[44:47], s9 offen offset:0 sc1
    s_add_u32 s9, s86, s12
    buffer_load_dwordx4 v[104:107], v252, s[44:47], s9 offen offset:1024 sc1
    s_waitcnt vmcnt(3)
    buffer_load_dwordx4 v189, s[36:39], s79 offen offset:3072 lds
    s_add_u32 s9, s87, s12
    buffer_load_dwordx4 v[92:95], v252, s[44:47], s9 offen offset:0 sc1
    s_add_u32 s9, s87, s12
    buffer_load_dwordx4 v[108:111], v252, s[44:47], s9 offen offset:1024 sc1
    s_add_u32 m0, s78, 4096
    s_waitcnt vmcnt(3)
    buffer_load_dwordx4 v190, s[36:39], s79 offen offset:0 lds
    v_mov_b32 v42, 14
    s_waitcnt vmcnt(0)
    ds_write_b32 v253, v42
    s_setprio 0
    ds_read_b128 v[208:211], v250 offset:0
    ds_read_b128 v[212:215], v251 offset:0
    s_waitcnt vmcnt(0) lgkmcnt(0)
    s_add_u32 m0, s74, 0
    s_add_u32 s76, s4, 81920
    buffer_load_dwordx4 v248, s[40:43], s76 offen offset:0 lds
    buffer_load_dwordx4 v249, s[40:43], s76 offen offset:1024 lds
    s_and_b32 s22, s69, 1
    s_xor_b32 s23, s22, 1
    s_lshl_b32 s22, s22, 2
    s_lshl_b32 s23, s23, 4
    s_add_u32 s24, s80, 10240
    s_add_u32 s25, s82, 40960
    ds_read_b128 v[216:219], v250 offset:2048
    ds_read_b128 v[220:223], v251 offset:2048
    v_mfma_f32_16x16x32_bf16 v[0:3], v[208:211], v[80:83], 0
    s_add_u32 s9, s84, s13
    buffer_load_dwordx4 v[112:115], v252, s[44:47], s9 offen offset:0 sc1
    v_mfma_f32_16x16x32_bf16 v[20:23], v[208:211], v[84:87], 0
    v_mfma_f32_16x16x32_bf16 v[40:43], v[208:211], v[88:91], 0
    s_waitcnt lgkmcnt(0)
    s_add_u32 m0, s74, 2048
    s_add_u32 s76, s5, 0
    buffer_load_dwordx4 v248, s[40:43], s76 offen offset:0 lds
    v_mfma_f32_16x16x32_bf16 v[60:63], v[208:211], v[92:95], 0
    v_mfma_f32_16x16x32_bf16 v[0:3], v[212:215], v[96:99], v[0:3]
    s_add_u32 s9, s85, s13
    buffer_load_dwordx4 v[116:119], v252, s[44:47], s9 offen offset:0 sc1
    v_mfma_f32_16x16x32_bf16 v[20:23], v[212:215], v[100:103], v[20:23]
    v_mfma_f32_16x16x32_bf16 v[40:43], v[212:215], v[104:107], v[40:43]
    buffer_load_dwordx4 v249, s[40:43], s76 offen offset:1024 lds
    v_mfma_f32_16x16x32_bf16 v[60:63], v[212:215], v[108:111], v[60:63]
    ds_read_b128 v[224:227], v250 offset:4096
    ds_read_b128 v[228:231], v251 offset:4096
    v_mfma_f32_16x16x32_bf16 v[4:7], v[216:219], v[80:83], 0
    s_add_u32 s9, s86, s13
    buffer_load_dwordx4 v[120:123], v252, s[44:47], s9 offen offset:0 sc1
    v_mfma_f32_16x16x32_bf16 v[24:27], v[216:219], v[84:87], 0
    v_mfma_f32_16x16x32_bf16 v[44:47], v[216:219], v[88:91], 0
    s_waitcnt lgkmcnt(0)
    s_add_u32 m0, s74, 4096
    s_add_u32 s76, s5, 20480
    buffer_load_dwordx4 v248, s[40:43], s76 offen offset:0 lds
    v_mfma_f32_16x16x32_bf16 v[64:67], v[216:219], v[92:95], 0
    v_mfma_f32_16x16x32_bf16 v[4:7], v[220:223], v[96:99], v[4:7]
    s_add_u32 s9, s87, s13
    buffer_load_dwordx4 v[124:127], v252, s[44:47], s9 offen offset:0 sc1
    v_mfma_f32_16x16x32_bf16 v[24:27], v[220:223], v[100:103], v[24:27]
    v_mfma_f32_16x16x32_bf16 v[44:47], v[220:223], v[104:107], v[44:47]
    buffer_load_dwordx4 v249, s[40:43], s76 offen offset:1024 lds
    v_mfma_f32_16x16x32_bf16 v[64:67], v[220:223], v[108:111], v[64:67]
    ds_read_b128 v[232:235], v250 offset:6144
    ds_read_b128 v[236:239], v251 offset:6144
    v_mfma_f32_16x16x32_bf16 v[8:11], v[224:227], v[80:83], 0
    s_add_u32 s9, s84, s13
    buffer_load_dwordx4 v[128:131], v252, s[44:47], s9 offen offset:1024 sc1
    v_mfma_f32_16x16x32_bf16 v[28:31], v[224:227], v[84:87], 0
    v_mfma_f32_16x16x32_bf16 v[48:51], v[224:227], v[88:91], 0
    s_waitcnt lgkmcnt(0)
    s_add_u32 m0, s74, 6144
    s_add_u32 s76, s5, 40960
    buffer_load_dwordx4 v248, s[40:43], s76 offen offset:0 lds
    v_mfma_f32_16x16x32_bf16 v[68:71], v[224:227], v[92:95], 0
    v_mfma_f32_16x16x32_bf16 v[8:11], v[228:231], v[96:99], v[8:11]
    s_add_u32 s9, s85, s13
    buffer_load_dwordx4 v[132:135], v252, s[44:47], s9 offen offset:1024 sc1
    v_mfma_f32_16x16x32_bf16 v[28:31], v[228:231], v[100:103], v[28:31]
    v_mfma_f32_16x16x32_bf16 v[48:51], v[228:231], v[104:107], v[48:51]
    buffer_load_dwordx4 v249, s[40:43], s76 offen offset:1024 lds
    v_mfma_f32_16x16x32_bf16 v[68:71], v[228:231], v[108:111], v[68:71]
    s_waitcnt vmcnt(12)
    ds_read_b128 v[240:243], v250 offset:0
    ds_read_b128 v[244:247], v251 offset:0
    v_mfma_f32_16x16x32_bf16 v[12:15], v[232:235], v[80:83], 0
    s_add_u32 s9, s86, s13
    buffer_load_dwordx4 v[136:139], v252, s[44:47], s9 offen offset:1024 sc1
    v_mfma_f32_16x16x32_bf16 v[32:35], v[232:235], v[84:87], 0
    v_mfma_f32_16x16x32_bf16 v[52:55], v[232:235], v[88:91], 0
    s_waitcnt lgkmcnt(0)
    s_add_u32 m0, s74, 0
    s_add_u32 s76, s5, 61440
    buffer_load_dwordx4 v248, s[40:43], s76 offen offset:0 lds
    v_mfma_f32_16x16x32_bf16 v[72:75], v[232:235], v[92:95], 0
    v_mfma_f32_16x16x32_bf16 v[12:15], v[236:239], v[96:99], v[12:15]
    s_add_u32 s9, s87, s13
    buffer_load_dwordx4 v[140:143], v252, s[44:47], s9 offen offset:1024 sc1
    v_mfma_f32_16x16x32_bf16 v[32:35], v[236:239], v[100:103], v[32:35]
    v_mfma_f32_16x16x32_bf16 v[52:55], v[236:239], v[104:107], v[52:55]
    buffer_load_dwordx4 v249, s[40:43], s76 offen offset:1024 lds
    v_mfma_f32_16x16x32_bf16 v[72:75], v[236:239], v[108:111], v[72:75]
    s_waitcnt vmcnt(12)
    ds_read_b128 v[208:211], v250 offset:2048
    ds_read_b128 v[212:215], v251 offset:2048
    v_mfma_f32_16x16x32_bf16 v[16:19], v[240:243], v[80:83], 0
    s_add_u32 s9, s84, s14
    buffer_load_dwordx4 v[144:147], v252, s[44:47], s9 offen offset:0 sc1
    v_mfma_f32_16x16x32_bf16 v[36:39], v[240:243], v[84:87], 0
    v_mfma_f32_16x16x32_bf16 v[56:59], v[240:243], v[88:91], 0
    s_waitcnt lgkmcnt(0)
    s_add_u32 m0, s74, 2048
    s_add_u32 s76, s5, 81920
    buffer_load_dwordx4 v248, s[40:43], s76 offen offset:0 lds
    v_mfma_f32_16x16x32_bf16 v[76:79], v[240:243], v[92:95], 0
    v_mfma_f32_16x16x32_bf16 v[16:19], v[244:247], v[96:99], v[16:19]
    s_add_u32 s9, s85, s14
    buffer_load_dwordx4 v[148:151], v252, s[44:47], s9 offen offset:0 sc1
    v_mfma_f32_16x16x32_bf16 v[36:39], v[244:247], v[100:103], v[36:39]
    v_mfma_f32_16x16x32_bf16 v[56:59], v[244:247], v[104:107], v[56:59]
    buffer_load_dwordx4 v249, s[40:43], s76 offen offset:1024 lds
    v_mfma_f32_16x16x32_bf16 v[76:79], v[244:247], v[108:111], v[76:79]
    s_waitcnt vmcnt(12)
    ds_read_b128 v[216:219], v250 offset:4096
    ds_read_b128 v[220:223], v251 offset:4096
    s_waitcnt vmcnt(5)
    v_mfma_f32_16x16x32_bf16 v[0:3], v[208:211], v[112:115], v[0:3]
    s_add_u32 s9, s86, s14
    buffer_load_dwordx4 v[152:155], v252, s[44:47], s9 offen offset:0 sc1
    v_mfma_f32_16x16x32_bf16 v[20:23], v[208:211], v[116:119], v[20:23]
    v_mfma_f32_16x16x32_bf16 v[40:43], v[208:211], v[120:123], v[40:43]
    s_waitcnt lgkmcnt(0)
    s_add_u32 m0, s74, 4096
    s_add_u32 s76, s6, 0
    buffer_load_dwordx4 v248, s[40:43], s76 offen offset:0 lds
    v_mfma_f32_16x16x32_bf16 v[60:63], v[208:211], v[124:127], v[60:63]
    v_mfma_f32_16x16x32_bf16 v[0:3], v[212:215], v[128:131], v[0:3]
    s_add_u32 s9, s87, s14
    buffer_load_dwordx4 v[156:159], v252, s[44:47], s9 offen offset:0 sc1
    v_mfma_f32_16x16x32_bf16 v[20:23], v[212:215], v[132:135], v[20:23]
    v_mfma_f32_16x16x32_bf16 v[40:43], v[212:215], v[136:139], v[40:43]
    buffer_load_dwordx4 v249, s[40:43], s76 offen offset:1024 lds
    v_mfma_f32_16x16x32_bf16 v[60:63], v[212:215], v[140:143], v[60:63]
    ds_read_b128 v[224:227], v250 offset:6144
    ds_read_b128 v[228:231], v251 offset:6144
    v_mfma_f32_16x16x32_bf16 v[4:7], v[216:219], v[112:115], v[4:7]
    s_add_u32 s9, s84, s14
    buffer_load_dwordx4 v[160:163], v252, s[44:47], s9 offen offset:1024 sc1
    v_mfma_f32_16x16x32_bf16 v[24:27], v[216:219], v[116:119], v[24:27]
    v_mfma_f32_16x16x32_bf16 v[44:47], v[216:219], v[120:123], v[44:47]
    s_waitcnt lgkmcnt(0)
    s_add_u32 m0, s74, 6144
    s_add_u32 s76, s6, 20480
    buffer_load_dwordx4 v248, s[40:43], s76 offen offset:0 lds
    v_mfma_f32_16x16x32_bf16 v[64:67], v[216:219], v[124:127], v[64:67]
    v_mfma_f32_16x16x32_bf16 v[4:7], v[220:223], v[128:131], v[4:7]
    s_add_u32 s9, s85, s14
    buffer_load_dwordx4 v[164:167], v252, s[44:47], s9 offen offset:1024 sc1
    v_mfma_f32_16x16x32_bf16 v[24:27], v[220:223], v[132:135], v[24:27]
    v_mfma_f32_16x16x32_bf16 v[44:47], v[220:223], v[136:139], v[44:47]
    buffer_load_dwordx4 v249, s[40:43], s76 offen offset:1024 lds
    v_mfma_f32_16x16x32_bf16 v[64:67], v[220:223], v[140:143], v[64:67]
    s_waitcnt vmcnt(12)
    ds_read_b128 v[232:235], v250 offset:0
    ds_read_b128 v[236:239], v251 offset:0
    v_mfma_f32_16x16x32_bf16 v[8:11], v[224:227], v[112:115], v[8:11]
    s_add_u32 s9, s86, s14
    buffer_load_dwordx4 v[168:171], v252, s[44:47], s9 offen offset:1024 sc1
    v_mfma_f32_16x16x32_bf16 v[28:31], v[224:227], v[116:119], v[28:31]
    v_mfma_f32_16x16x32_bf16 v[48:51], v[224:227], v[120:123], v[48:51]
    s_waitcnt lgkmcnt(0)
    s_add_u32 m0, s74, 0
    s_add_u32 s76, s6, 40960
    buffer_load_dwordx4 v248, s[40:43], s76 offen offset:0 lds
    v_mfma_f32_16x16x32_bf16 v[68:71], v[224:227], v[124:127], v[68:71]
    v_mfma_f32_16x16x32_bf16 v[8:11], v[228:231], v[128:131], v[8:11]
    s_add_u32 s9, s87, s14
    buffer_load_dwordx4 v[172:175], v252, s[44:47], s9 offen offset:1024 sc1
    v_mfma_f32_16x16x32_bf16 v[28:31], v[228:231], v[132:135], v[28:31]
    v_mfma_f32_16x16x32_bf16 v[48:51], v[228:231], v[136:139], v[48:51]
    buffer_load_dwordx4 v249, s[40:43], s76 offen offset:1024 lds
    v_mfma_f32_16x16x32_bf16 v[68:71], v[228:231], v[140:143], v[68:71]
    s_waitcnt vmcnt(12)
    ds_read_b128 v[240:243], v250 offset:2048
    ds_read_b128 v[244:247], v251 offset:2048
    v_mfma_f32_16x16x32_bf16 v[12:15], v[232:235], v[112:115], v[12:15]
    s_add_u32 s9, s84, s15
    buffer_load_dwordx4 v[176:179], v252, s[44:47], s9 offen offset:0 sc1
    v_mfma_f32_16x16x32_bf16 v[32:35], v[232:235], v[116:119], v[32:35]
    v_mfma_f32_16x16x32_bf16 v[52:55], v[232:235], v[120:123], v[52:55]
    s_waitcnt lgkmcnt(0)
    s_add_u32 m0, s74, 2048
    s_add_u32 s76, s6, 61440
    buffer_load_dwordx4 v248, s[40:43], s76 offen offset:0 lds
    v_mfma_f32_16x16x32_bf16 v[72:75], v[232:235], v[124:127], v[72:75]
    v_mfma_f32_16x16x32_bf16 v[12:15], v[236:239], v[128:131], v[12:15]
    s_add_u32 s9, s85, s15
    buffer_load_dwordx4 v[180:183], v252, s[44:47], s9 offen offset:0 sc1
    v_mfma_f32_16x16x32_bf16 v[32:35], v[236:239], v[132:135], v[32:35]
    v_mfma_f32_16x16x32_bf16 v[52:55], v[236:239], v[136:139], v[52:55]
    buffer_load_dwordx4 v249, s[40:43], s76 offen offset:1024 lds
    v_mfma_f32_16x16x32_bf16 v[72:75], v[236:239], v[140:143], v[72:75]
    s_waitcnt vmcnt(12)
    ds_read_b128 v[208:211], v250 offset:4096
    ds_read_b128 v[212:215], v251 offset:4096
    v_mfma_f32_16x16x32_bf16 v[16:19], v[240:243], v[112:115], v[16:19]
    s_add_u32 s9, s86, s15
    buffer_load_dwordx4 v[184:187], v252, s[44:47], s9 offen offset:0 sc1
    v_mfma_f32_16x16x32_bf16 v[36:39], v[240:243], v[116:119], v[36:39]
    v_mfma_f32_16x16x32_bf16 v[56:59], v[240:243], v[120:123], v[56:59]
    s_waitcnt lgkmcnt(0)
    s_add_u32 m0, s74, 4096
    s_add_u32 s76, s6, 81920
    buffer_load_dwordx4 v248, s[40:43], s76 offen offset:0 lds
    v_mfma_f32_16x16x32_bf16 v[76:79], v[240:243], v[124:127], v[76:79]
    v_mfma_f32_16x16x32_bf16 v[16:19], v[244:247], v[128:131], v[16:19]
    s_add_u32 s9, s87, s15
    buffer_load_dwordx4 v[188:191], v252, s[44:47], s9 offen offset:0 sc1
    v_mfma_f32_16x16x32_bf16 v[36:39], v[244:247], v[132:135], v[36:39]
    v_mfma_f32_16x16x32_bf16 v[56:59], v[244:247], v[136:139], v[56:59]
    buffer_load_dwordx4 v249, s[40:43], s76 offen offset:1024 lds
    v_mfma_f32_16x16x32_bf16 v[76:79], v[244:247], v[140:143], v[76:79]
    s_waitcnt vmcnt(12)
    ds_read_b128 v[216:219], v250 offset:6144
    ds_read_b128 v[220:223], v251 offset:6144
    s_waitcnt vmcnt(9)
    v_mfma_f32_16x16x32_bf16 v[0:3], v[208:211], v[144:147], v[0:3]
    s_add_u32 s9, s84, s15
    buffer_load_dwordx4 v[192:195], v252, s[44:47], s9 offen offset:1024 sc1
    v_mfma_f32_16x16x32_bf16 v[20:23], v[208:211], v[148:151], v[20:23]
    v_mfma_f32_16x16x32_bf16 v[40:43], v[208:211], v[152:155], v[40:43]
    s_waitcnt lgkmcnt(0)
    s_add_u32 m0, s74, 6144
    s_add_u32 s76, s7, 0
    buffer_load_dwordx4 v248, s[40:43], s76 offen offset:0 lds
    v_mfma_f32_16x16x32_bf16 v[60:63], v[208:211], v[156:159], v[60:63]
    v_mfma_f32_16x16x32_bf16 v[0:3], v[212:215], v[160:163], v[0:3]
    s_add_u32 s9, s85, s15
    buffer_load_dwordx4 v[196:199], v252, s[44:47], s9 offen offset:1024 sc1
    v_mfma_f32_16x16x32_bf16 v[20:23], v[212:215], v[164:167], v[20:23]
    v_mfma_f32_16x16x32_bf16 v[40:43], v[212:215], v[168:171], v[40:43]
    buffer_load_dwordx4 v249, s[40:43], s76 offen offset:1024 lds
    v_mfma_f32_16x16x32_bf16 v[60:63], v[212:215], v[172:175], v[60:63]
    s_waitcnt vmcnt(12)
    ds_read_b128 v[224:227], v250 offset:0
    ds_read_b128 v[228:231], v251 offset:0
    v_mfma_f32_16x16x32_bf16 v[4:7], v[216:219], v[144:147], v[4:7]
    s_add_u32 s9, s86, s15
    buffer_load_dwordx4 v[200:203], v252, s[44:47], s9 offen offset:1024 sc1
    v_mfma_f32_16x16x32_bf16 v[24:27], v[216:219], v[148:151], v[24:27]
    s_add_u32 s9, s87, s15
    buffer_load_dwordx4 v[204:207], v252, s[44:47], s9 offen offset:1024 sc1
    v_mfma_f32_16x16x32_bf16 v[44:47], v[216:219], v[152:155], v[44:47]
    v_mfma_f32_16x16x32_bf16 v[64:67], v[216:219], v[156:159], v[64:67]
    s_waitcnt lgkmcnt(0)
    s_add_u32 m0, s74, 0
    s_add_u32 s76, s7, 20480
    buffer_load_dwordx4 v248, s[40:43], s76 offen offset:0 lds
    buffer_load_dwordx4 v249, s[40:43], s76 offen offset:1024 lds
    s_waitcnt vmcnt(12)
    ds_read_b128 v[232:235], v250 offset:2048
    ds_read_b128 v[236:239], v251 offset:2048
    v_mfma_f32_16x16x32_bf16 v[4:7], v[220:223], v[160:163], v[4:7]
    v_mfma_f32_16x16x32_bf16 v[24:27], v[220:223], v[164:167], v[24:27]
    v_mfma_f32_16x16x32_bf16 v[44:47], v[220:223], v[168:171], v[44:47]
    v_mfma_f32_16x16x32_bf16 v[64:67], v[220:223], v[172:175], v[64:67]
    s_waitcnt lgkmcnt(0)
    s_add_u32 m0, s74, 2048
    s_add_u32 s76, s7, 40960
    buffer_load_dwordx4 v248, s[40:43], s76 offen offset:0 lds
    buffer_load_dwordx4 v249, s[40:43], s76 offen offset:1024 lds
    s_add_u32 s9, s84, s16
    buffer_load_dwordx4 v[80:83], v252, s[44:47], s9 offen offset:0 sc1
    s_waitcnt vmcnt(11)
    ds_read_b128 v[240:243], v250 offset:4096
    ds_read_b128 v[244:247], v251 offset:4096
    s_waitcnt lgkmcnt(0)
    s_add_u32 m0, s74, 4096
    s_add_u32 s76, s7, 61440
    buffer_load_dwordx4 v248, s[40:43], s76 offen offset:0 lds
    buffer_load_dwordx4 v249, s[40:43], s76 offen offset:1024 lds
    s_add_u32 s9, s85, s16
    buffer_load_dwordx4 v[84:87], v252, s[44:47], s9 offen offset:0 sc1
    s_waitcnt vmcnt(10)
    ds_read_b128 v[112:115], v250 offset:6144
    ds_read_b128 v[116:119], v251 offset:6144
    s_waitcnt lgkmcnt(0)
    s_add_u32 m0, s74, 6144
    s_add_u32 s76, s7, 81920
    buffer_load_dwordx4 v248, s[40:43], s76 offen offset:0 lds
    buffer_load_dwordx4 v249, s[40:43], s76 offen offset:1024 lds
    s_add_u32 s9, s86, s16
    buffer_load_dwordx4 v[88:91], v252, s[44:47], s9 offen offset:0 sc1
    s_waitcnt vmcnt(9)
    ds_read_b128 v[120:123], v250 offset:0
    ds_read_b128 v[124:127], v251 offset:0
    s_waitcnt lgkmcnt(0)
    s_add_u32 m0, s74, 0
    s_add_u32 s76, s8, 0
    buffer_load_dwordx4 v248, s[40:43], s76 offen offset:0 lds
    buffer_load_dwordx4 v249, s[40:43], s76 offen offset:1024 lds
    s_add_u32 s9, s87, s16
    buffer_load_dwordx4 v[92:95], v252, s[44:47], s9 offen offset:0 sc1
    s_waitcnt vmcnt(10)
    ds_read_b128 v[128:131], v250 offset:2048
    ds_read_b128 v[132:135], v251 offset:2048
    s_waitcnt lgkmcnt(0)
    s_add_u32 m0, s74, 2048
    s_add_u32 s76, s8, 20480
    buffer_load_dwordx4 v248, s[40:43], s76 offen offset:0 lds
    buffer_load_dwordx4 v249, s[40:43], s76 offen offset:1024 lds
    s_add_u32 s9, s84, s16
    buffer_load_dwordx4 v[96:99], v252, s[44:47], s9 offen offset:1024 sc1
    s_waitcnt vmcnt(10)
    ds_read_b128 v[136:139], v250 offset:4096
    ds_read_b128 v[140:143], v251 offset:4096
    s_waitcnt lgkmcnt(0)
    s_add_u32 m0, s74, 4096
    s_add_u32 s76, s8, 40960
    buffer_load_dwordx4 v248, s[40:43], s76 offen offset:0 lds
    buffer_load_dwordx4 v249, s[40:43], s76 offen offset:1024 lds
    s_add_u32 s9, s85, s16
    buffer_load_dwordx4 v[100:103], v252, s[44:47], s9 offen offset:1024 sc1
    s_waitcnt vmcnt(10)
    ds_read_b128 v[208:211], v250 offset:6144
    ds_read_b128 v[212:215], v251 offset:6144
    s_waitcnt lgkmcnt(0)
    s_add_u32 m0, s74, 6144
    s_add_u32 s76, s8, 61440
    buffer_load_dwordx4 v248, s[40:43], s76 offen offset:0 lds
    buffer_load_dwordx4 v249, s[40:43], s76 offen offset:1024 lds
    s_add_u32 s9, s86, s16
    buffer_load_dwordx4 v[104:107], v252, s[44:47], s9 offen offset:1024 sc1
    s_waitcnt vmcnt(10)
    ds_read_b128 v[216:219], v250 offset:0
    ds_read_b128 v[220:223], v251 offset:0
    s_waitcnt lgkmcnt(0)
    s_add_u32 m0, s74, 0
    s_add_u32 s76, s8, 81920
    buffer_load_dwordx4 v248, s[40:43], s76 offen offset:0 lds
    buffer_load_dwordx4 v249, s[40:43], s76 offen offset:1024 lds
    s_add_u32 s9, s87, s16
    buffer_load_dwordx4 v[108:111], v252, s[44:47], s9 offen offset:1024 sc1
    s_setprio 1
    v_and_b32 v248, 1, v254
    v_lshlrev_b32 v248, 9, v248
    v_xor_b32 v248, v248, v253
    v_subrev_u32 v248, 1024, v248
    s_waitcnt vmcnt(0)
L_pw_23:
    ds_read_b32 v249, v248
    s_waitcnt lgkmcnt(0)
    v_cmp_gt_u32 vcc, 8, v249
    s_cbranch_vccnz L_pwr_24
    v_mfma_f32_16x16x32_bf16 v[8:11], v[224:227], v[144:147], v[8:11]
    v_mfma_f32_16x16x32_bf16 v[28:31], v[224:227], v[148:151], v[28:31]
    v_mfma_f32_16x16x32_bf16 v[48:51], v[224:227], v[152:155], v[48:51]
    v_mfma_f32_16x16x32_bf16 v[68:71], v[224:227], v[156:159], v[68:71]
    v_mfma_f32_16x16x32_bf16 v[8:11], v[228:231], v[160:163], v[8:11]
    v_mfma_f32_16x16x32_bf16 v[28:31], v[228:231], v[164:167], v[28:31]
    v_mfma_f32_16x16x32_bf16 v[48:51], v[228:231], v[168:171], v[48:51]
    v_mfma_f32_16x16x32_bf16 v[68:71], v[228:231], v[172:175], v[68:71]
    v_mfma_f32_16x16x32_bf16 v[12:15], v[232:235], v[144:147], v[12:15]
    v_mfma_f32_16x16x32_bf16 v[32:35], v[232:235], v[148:151], v[32:35]
    v_mfma_f32_16x16x32_bf16 v[52:55], v[232:235], v[152:155], v[52:55]
    v_mfma_f32_16x16x32_bf16 v[72:75], v[232:235], v[156:159], v[72:75]
    v_mfma_f32_16x16x32_bf16 v[12:15], v[236:239], v[160:163], v[12:15]
    v_mfma_f32_16x16x32_bf16 v[32:35], v[236:239], v[164:167], v[32:35]
    v_mfma_f32_16x16x32_bf16 v[52:55], v[236:239], v[168:171], v[52:55]
    v_mfma_f32_16x16x32_bf16 v[72:75], v[236:239], v[172:175], v[72:75]
    v_mfma_f32_16x16x32_bf16 v[16:19], v[240:243], v[144:147], v[16:19]
    v_mfma_f32_16x16x32_bf16 v[36:39], v[240:243], v[148:151], v[36:39]
    v_mfma_f32_16x16x32_bf16 v[56:59], v[240:243], v[152:155], v[56:59]
    v_mfma_f32_16x16x32_bf16 v[76:79], v[240:243], v[156:159], v[76:79]
    v_mfma_f32_16x16x32_bf16 v[16:19], v[244:247], v[160:163], v[16:19]
    v_mfma_f32_16x16x32_bf16 v[36:39], v[244:247], v[164:167], v[36:39]
    v_mfma_f32_16x16x32_bf16 v[56:59], v[244:247], v[168:171], v[56:59]
    v_mfma_f32_16x16x32_bf16 v[76:79], v[244:247], v[172:175], v[76:79]
    v_mfma_f32_16x16x32_bf16 v[0:3], v[112:115], v[176:179], v[0:3]
    v_and_b32 v249, 7, v254
    v_mfma_f32_16x16x32_bf16 v[20:23], v[112:115], v[180:183], v[20:23]
    v_add_lshl_u32 v161, v249, s22, 3
    v_mfma_f32_16x16x32_bf16 v[40:43], v[112:115], v[184:187], v[40:43]
    v_lshrrev_b32 v249, 3, v254
    v_mfma_f32_16x16x32_bf16 v[60:63], v[112:115], v[188:191], v[60:63]
    v_mul_u32_u24 v174, 1280, v249
    v_mfma_f32_16x16x32_bf16 v[0:3], v[116:119], v[192:195], v[0:3]
    v_add_u32 v160, v174, v161
    v_mfma_f32_16x16x32_bf16 v[20:23], v[116:119], v[196:199], v[20:23]
    v_add_lshl_u32 v162, v174, v160, 1
    v_mfma_f32_16x16x32_bf16 v[40:43], v[116:119], v[200:203], v[40:43]
    v_mul_u32_u24 v174, 168, v249
    v_mfma_f32_16x16x32_bf16 v[60:63], v[116:119], v[204:207], v[60:63]
    v_add_lshl_u32 v174, v174, v161, 1
    v_mfma_f32_16x16x32_bf16 v[4:7], v[120:123], v[176:179], v[4:7]
    global_load_dwordx2 v[154:155], v161, s[90:91] offset:0
    v_mfma_f32_16x16x32_bf16 v[24:27], v[120:123], v[180:183], v[24:27]
    buffer_load_dwordx2 v[144:145], v160, s[48:51], s80 offen offset:0
    v_mfma_f32_16x16x32_bf16 v[44:47], v[120:123], v[184:187], v[44:47]
    v_add_u32 v163, s92, v174
    v_mfma_f32_16x16x32_bf16 v[64:67], v[120:123], v[188:191], v[64:67]
    v_add_u32 v175, s93, v174
    v_mfma_f32_16x16x32_bf16 v[4:7], v[124:127], v[192:195], v[4:7]
    v_and_b32 v249, 3, v254
    v_mfma_f32_16x16x32_bf16 v[24:27], v[124:127], v[196:199], v[24:27]
    v_add_lshl_u32 v165, v249, s23, 3
    v_mfma_f32_16x16x32_bf16 v[44:47], v[124:127], v[200:203], v[44:47]
    v_lshrrev_b32 v249, 2, v254
    v_mfma_f32_16x16x32_bf16 v[64:67], v[124:127], v[204:207], v[64:67]
    v_mul_u32_u24 v174, 1280, v249
    v_mfma_f32_16x16x32_bf16 v[8:11], v[128:131], v[176:179], v[8:11]
    global_load_dwordx2 v[156:157], v161, s[90:91] offset:64
    v_mfma_f32_16x16x32_bf16 v[28:31], v[128:131], v[180:183], v[28:31]
    buffer_load_dwordx2 v[146:147], v160, s[48:51], s80 offen offset:64
    v_mfma_f32_16x16x32_bf16 v[48:51], v[128:131], v[184:187], v[48:51]
    v_add_u32 v164, v174, v165
    v_mfma_f32_16x16x32_bf16 v[68:71], v[128:131], v[188:191], v[68:71]
    v_add_lshl_u32 v166, v174, v164, 1
    v_mfma_f32_16x16x32_bf16 v[8:11], v[132:135], v[192:195], v[8:11]
    v_mul_u32_u24 v174, 168, v249
    v_mfma_f32_16x16x32_bf16 v[28:31], v[132:135], v[196:199], v[28:31]
    v_add_lshl_u32 v174, v174, v165, 1
    v_mfma_f32_16x16x32_bf16 v[48:51], v[132:135], v[200:203], v[48:51]
    v_add_u32 v167, s92, v174
    v_mfma_f32_16x16x32_bf16 v[68:71], v[132:135], v[204:207], v[68:71]
    v_add_u32 v168, s93, v174
    v_mfma_f32_16x16x32_bf16 v[12:15], v[136:139], v[176:179], v[12:15]
    buffer_load_dwordx2 v[148:149], v160, s[48:51], s24 offen offset:0
    v_mfma_f32_16x16x32_bf16 v[32:35], v[136:139], v[180:183], v[32:35]
    v_add_u32 v169, s74, v252
    v_mfma_f32_16x16x32_bf16 v[52:55], v[136:139], v[184:187], v[52:55]
    v_add_u32 v170, s92, v252
    v_mfma_f32_16x16x32_bf16 v[72:75], v[136:139], v[188:191], v[72:75]
    v_and_b32 v174, 15, v254
    v_mfma_f32_16x16x32_bf16 v[12:15], v[140:143], v[192:195], v[12:15]
    v_mul_u32_u24 v174, 336, v174
    v_mfma_f32_16x16x32_bf16 v[32:35], v[140:143], v[196:199], v[32:35]
    v_and_b32 v249, 48, v254
    v_mfma_f32_16x16x32_bf16 v[52:55], v[140:143], v[200:203], v[52:55]
    v_add3_u32 v171, v174, v249, s92
    v_mfma_f32_16x16x32_bf16 v[72:75], v[140:143], v[204:207], v[72:75]
    v_xor_b32 v172, 256, v253
    v_mfma_f32_16x16x32_bf16 v[16:19], v[208:211], v[176:179], v[16:19]
    buffer_load_dwordx2 v[150:151], v160, s[48:51], s24 offen offset:64
    v_mfma_f32_16x16x32_bf16 v[36:39], v[208:211], v[180:183], v[36:39]
    v_xor_b32 v173, 512, v253
    v_mfma_f32_16x16x32_bf16 v[56:59], v[208:211], v[184:187], v[56:59]
    v_and_b32 v249, 3, v254
    v_mfma_f32_16x16x32_bf16 v[76:79], v[208:211], v[188:191], v[76:79]
    v_lshlrev_b32 v249, 8, v249
    v_mfma_f32_16x16x32_bf16 v[16:19], v[212:215], v[192:195], v[16:19]
    v_lshl_add_u32 v249, v254, 2, v249
    v_mfma_f32_16x16x32_bf16 v[36:39], v[212:215], v[196:199], v[36:39]
    v_add_u32 v174, 161792, v249
    v_mfma_f32_16x16x32_bf16 v[56:59], v[212:215], v[200:203], v[56:59]
    v_mfma_f32_16x16x32_bf16 v[76:79], v[212:215], v[204:207], v[76:79]
    ds_read_b128 v[224:227], v250 offset:2048
    ds_read_b128 v[228:231], v251 offset:2048
    v_mfma_f32_16x16x32_bf16 v[0:3], v[216:219], v[80:83], v[0:3]
    global_load_dwordx2 v[158:159], v165, s[90:91] offset:0
    v_mfma_f32_16x16x32_bf16 v[20:23], v[216:219], v[84:87], v[20:23]
    buffer_load_dwordx2 v[152:153], v164, s[48:51], s80 offen offset:0
    v_mfma_f32_16x16x32_bf16 v[40:43], v[216:219], v[88:91], v[40:43]
    v_mfma_f32_16x16x32_bf16 v[60:63], v[216:219], v[92:95], v[60:63]
    v_mfma_f32_16x16x32_bf16 v[0:3], v[220:223], v[96:99], v[0:3]
    v_mfma_f32_16x16x32_bf16 v[20:23], v[220:223], v[100:103], v[20:23]
    s_waitcnt lgkmcnt(0)
    v_mfma_f32_16x16x32_bf16 v[40:43], v[220:223], v[104:107], v[40:43]
    v_mfma_f32_16x16x32_bf16 v[60:63], v[220:223], v[108:111], v[60:63]
    ds_read_b128 v[232:235], v250 offset:4096
    ds_read_b128 v[236:239], v251 offset:4096
    v_mfma_f32_16x16x32_bf16 v[4:7], v[224:227], v[80:83], v[4:7]
    v_mfma_f32_16x16x32_bf16 v[24:27], v[224:227], v[84:87], v[24:27]
    v_mfma_f32_16x16x32_bf16 v[44:47], v[224:227], v[88:91], v[44:47]
    v_mfma_f32_16x16x32_bf16 v[64:67], v[224:227], v[92:95], v[64:67]
    v_mfma_f32_16x16x32_bf16 v[4:7], v[228:231], v[96:99], v[4:7]
    v_mfma_f32_16x16x32_bf16 v[24:27], v[228:231], v[100:103], v[24:27]
    s_waitcnt lgkmcnt(0)
    v_mfma_f32_16x16x32_bf16 v[44:47], v[228:231], v[104:107], v[44:47]
    v_mfma_f32_16x16x32_bf16 v[64:67], v[228:231], v[108:111], v[64:67]
    ds_read_b128 v[240:243], v250 offset:6144
    ds_read_b128 v[244:247], v251 offset:6144
    v_mfma_f32_16x16x32_bf16 v[8:11], v[232:235], v[80:83], v[8:11]
    v_mfma_f32_16x16x32_bf16 v[28:31], v[232:235], v[84:87], v[28:31]
    v_mfma_f32_16x16x32_bf16 v[48:51], v[232:235], v[88:91], v[48:51]
    v_mfma_f32_16x16x32_bf16 v[68:71], v[232:235], v[92:95], v[68:71]
    v_mfma_f32_16x16x32_bf16 v[8:11], v[236:239], v[96:99], v[8:11]
    v_mfma_f32_16x16x32_bf16 v[28:31], v[236:239], v[100:103], v[28:31]
    s_waitcnt lgkmcnt(0)
    v_mfma_f32_16x16x32_bf16 v[48:51], v[236:239], v[104:107], v[48:51]
    v_mfma_f32_16x16x32_bf16 v[68:71], v[236:239], v[108:111], v[68:71]
    ds_read_b128 v[112:115], v250 offset:0
    ds_read_b128 v[116:119], v251 offset:0
    v_mfma_f32_16x16x32_bf16 v[12:15], v[240:243], v[80:83], v[12:15]
    v_mfma_f32_16x16x32_bf16 v[32:35], v[240:243], v[84:87], v[32:35]
    v_mfma_f32_16x16x32_bf16 v[52:55], v[240:243], v[88:91], v[52:55]
    v_mfma_f32_16x16x32_bf16 v[72:75], v[240:243], v[92:95], v[72:75]
    v_mfma_f32_16x16x32_bf16 v[12:15], v[244:247], v[96:99], v[12:15]
    v_mfma_f32_16x16x32_bf16 v[32:35], v[244:247], v[100:103], v[32:35]
    s_waitcnt lgkmcnt(0)
    v_mfma_f32_16x16x32_bf16 v[52:55], v[244:247], v[104:107], v[52:55]
    v_mfma_f32_16x16x32_bf16 v[72:75], v[244:247], v[108:111], v[72:75]
    v_mfma_f32_16x16x32_bf16 v[16:19], v[112:115], v[80:83], v[16:19]
    v_mfma_f32_16x16x32_bf16 v[36:39], v[112:115], v[84:87], v[36:39]
    v_mfma_f32_16x16x32_bf16 v[56:59], v[112:115], v[88:91], v[56:59]
    v_mfma_f32_16x16x32_bf16 v[76:79], v[112:115], v[92:95], v[76:79]
    v_mfma_f32_16x16x32_bf16 v[16:19], v[116:119], v[96:99], v[16:19]
    v_mfma_f32_16x16x32_bf16 v[36:39], v[116:119], v[100:103], v[36:39]
    v_mfma_f32_16x16x32_bf16 v[56:59], v[116:119], v[104:107], v[56:59]
    v_mfma_f32_16x16x32_bf16 v[76:79], v[116:119], v[108:111], v[76:79]
    s_nop 3
    ds_write_b128 v169, v[40:43] offset:0
    ds_write_b128 v169, v[44:47] offset:1024
    ds_write_b128 v169, v[48:51] offset:2048
    ds_write_b128 v169, v[52:55] offset:3072
    ds_write_b128 v169, v[56:59] offset:4096
    ds_write_b128 v169, v[60:63] offset:5120
    ds_write_b128 v169, v[64:67] offset:6144
    ds_write_b128 v169, v[68:71] offset:7168
    ds_write_b128 v169, v[72:75] offset:8192
    ds_write_b128 v169, v[76:79] offset:9216
    v_mov_b32 v113, 17
    ds_write_b32 v253, v113
    s_waitcnt vmcnt(0)
    v_lshlrev_b32 v116, 16, v144
    v_lshlrev_b32 v117, 16, v154
    v_and_b32 v118, 0xffff0000, v144
    v_and_b32 v119, 0xffff0000, v154
    v_mul_f32 v180, v116, v117
    v_mul_f32 v181, v118, v119
    v_lshlrev_b32 v116, 16, v145
    v_lshlrev_b32 v117, 16, v155
    v_and_b32 v118, 0xffff0000, v145
    v_and_b32 v119, 0xffff0000, v155
    v_mul_f32 v182, v116, v117
    v_mul_f32 v183, v118, v119
    v_lshlrev_b32 v116, 16, v146
    v_lshlrev_b32 v117, 16, v156
    v_and_b32 v118, 0xffff0000, v146
    v_and_b32 v119, 0xffff0000, v156
    v_mul_f32 v184, v116, v117
    v_mul_f32 v185, v118, v119
    v_lshlrev_b32 v116, 16, v147
    v_lshlrev_b32 v117, 16, v157
    v_and_b32 v118, 0xffff0000, v147
    v_and_b32 v119, 0xffff0000, v157
    v_mul_f32 v186, v116, v117
    v_mul_f32 v187, v118, v119
L_pw_25:
    ds_read_b32 v113, v172
    s_sub_u32 s96, s96, 1
    s_cbranch_scc1 L_exit
    s_waitcnt lgkmcnt(0)
    v_cmp_gt_u32 vcc, 17, v113
    s_cbranch_vccnz L_pw_25
    ds_read_b128 v[60:63], v170 offset:5120
    ds_read_b128 v[64:67], v170 offset:6144
    ds_read_b128 v[68:71], v170 offset:7168
    ds_read_b128 v[72:75], v170 offset:8192
    ds_read_b128 v[76:79], v170 offset:9216
    ds_read_b128 v[40:43], v170 offset:0
    ds_read_b128 v[44:47], v170 offset:1024
    ds_read_b128 v[48:51], v170 offset:2048
    ds_read_b128 v[52:55], v170 offset:3072
    ds_read_b128 v[56:59], v170 offset:4096
    v_lshlrev_b32 v116, 16, v148
    v_lshlrev_b32 v117, 16, v154
    v_and_b32 v118, 0xffff0000, v148
    v_and_b32 v119, 0xffff0000, v154
    v_mul_f32 v188, v116, v117
    v_mul_f32 v189, v118, v119
    v_lshlrev_b32 v116, 16, v149
    v_lshlrev_b32 v117, 16, v155
    v_and_b32 v118, 0xffff0000, v149
    v_and_b32 v119, 0xffff0000, v155
    v_mul_f32 v190, v116, v117
    v_mul_f32 v191, v118, v119
    s_waitcnt lgkmcnt(0)
    v_add_f32 v20, v20, v60
    v_add_f32 v21, v21, v61
    v_add_f32 v22, v22, v62
    v_add_f32 v23, v23, v63
    ds_write_b128 v171, v[20:23] offset:5376
    v_add_f32 v24, v24, v64
    v_add_f32 v25, v25, v65
    v_add_f32 v26, v26, v66
    v_add_f32 v27, v27, v67
    ds_write_b128 v171, v[24:27] offset:5440
    v_add_f32 v28, v28, v68
    v_add_f32 v29, v29, v69
    v_add_f32 v30, v30, v70
    v_add_f32 v31, v31, v71
    ds_write_b128 v171, v[28:31] offset:5504
    v_add_f32 v32, v32, v72
    v_add_f32 v33, v33, v73
    v_add_f32 v34, v34, v74
    v_add_f32 v35, v35, v75
    ds_write_b128 v171, v[32:35] offset:5568
    v_add_f32 v36, v36, v76
    v_add_f32 v37, v37, v77
    v_add_f32 v38, v38, v78
    v_add_f32 v39, v39, v79
    ds_write_b128 v171, v[36:39] offset:5632
    v_mov_b32 v113, 18
    ds_write_b32 v253, v113
    v_add_f32 v0, v0, v40
    v_add_f32 v1, v1, v41
    v_add_f32 v2, v2, v42
    v_add_f32 v3, v3, v43
    ds_write_b128 v171, v[0:3] offset:0
    v_add_f32 v4, v4, v44
    v_add_f32 v5, v5, v45
    v_add_f32 v6, v6, v46
    v_add_f32 v7, v7, v47
    ds_write_b128 v171, v[4:7] offset:64
    v_add_f32 v8, v8, v48
    v_add_f32 v9, v9, v49
    v_add_f32 v10, v10, v50
    v_add_f32 v11, v11, v51
    ds_write_b128 v171, v[8:11] offset:128
    v_add_f32 v12, v12, v52
    v_add_f32 v13, v13, v53
    v_add_f32 v14, v14, v54
    v_add_f32 v15, v15, v55
    ds_write_b128 v171, v[12:15] offset:192
    v_add_f32 v16, v16, v56
    v_add_f32 v17, v17, v57
    v_add_f32 v18, v18, v58
    v_add_f32 v19, v19, v59
    ds_write_b128 v171, v[16:19] offset:256
    ds_read_b128 v[40:43], v163 offset:0
    ds_read_b128 v[48:51], v163 offset:128
    ds_read_b128 v[56:59], v163 offset:2688
    ds_read_b128 v[64:67], v163 offset:2816
    ds_read_b128 v[72:75], v167 offset:0
    v_lshlrev_b32 v116, 16, v150
    v_lshlrev_b32 v117, 16, v156
    v_and_b32 v118, 0xffff0000, v150
    v_and_b32 v119, 0xffff0000, v156
    v_mul_f32 v192, v116, v117
    v_mul_f32 v193, v118, v119
    v_lshlrev_b32 v116, 16, v151
    v_lshlrev_b32 v117, 16, v157
    v_and_b32 v118, 0xffff0000, v151
    v_and_b32 v119, 0xffff0000, v157
    v_mul_f32 v194, v116, v117
    v_mul_f32 v195, v118, v119
    v_lshlrev_b32 v116, 16, v152
    v_lshlrev_b32 v117, 16, v158
    v_and_b32 v118, 0xffff0000, v152
    v_and_b32 v119, 0xffff0000, v158
    v_mul_f32 v196, v116, v117
    v_mul_f32 v197, v118, v119
    v_lshlrev_b32 v116, 16, v153
    v_lshlrev_b32 v117, 16, v159
    v_and_b32 v118, 0xffff0000, v153
    v_and_b32 v119, 0xffff0000, v159
    v_mul_f32 v198, v116, v117
    v_mul_f32 v199, v118, v119
L_pw_27:
    ds_read_b32 v113, v173
    s_sub_u32 s96, s96, 1
    s_cbranch_scc1 L_exit
    s_waitcnt lgkmcnt(0)
    v_cmp_gt_u32 vcc, 18, v113
    s_cbranch_vccnz L_pw_27
    ds_read_b128 v[44:47], v175 offset:0
    ds_read_b128 v[52:55], v175 offset:128
    ds_read_b128 v[60:63], v175 offset:2688
    ds_read_b128 v[68:71], v175 offset:2816
    ds_read_b128 v[76:79], v168 offset:0
    v_add_f32 v180, v180, v40
    v_add_f32 v181, v181, v41
    v_add_f32 v182, v182, v42
    v_add_f32 v183, v183, v43
    v_add_f32 v184, v184, v48
    v_add_f32 v185, v185, v49
    v_add_f32 v186, v186, v50
    v_add_f32 v187, v187, v51
    v_add_f32 v188, v188, v56
    v_add_f32 v189, v189, v57
    v_add_f32 v190, v190, v58
    v_add_f32 v191, v191, v59
    v_add_f32 v192, v192, v64
    v_add_f32 v193, v193, v65
    v_add_f32 v194, v194, v66
    v_add_f32 v195, v195, v67
    v_add_f32 v196, v196, v72
    v_add_f32 v197, v197, v73
    v_add_f32 v198, v198, v74
    v_add_f32 v199, v199, v75
    s_waitcnt lgkmcnt(4)
    v_add_f32 v180, v180, v44
    v_add_f32 v181, v181, v45
    v_add_f32 v182, v182, v46
    v_add_f32 v183, v183, v47
    s_waitcnt lgkmcnt(3)
    v_add_f32 v184, v184, v52
    v_add_f32 v185, v185, v53
    v_add_f32 v186, v186, v54
    v_add_f32 v187, v187, v55
    s_waitcnt lgkmcnt(2)
    v_add_f32 v188, v188, v60
    v_add_f32 v189, v189, v61
    v_add_f32 v190, v190, v62
    v_add_f32 v191, v191, v63
    s_waitcnt lgkmcnt(1)
    v_add_f32 v192, v192, v68
    v_add_f32 v193, v193, v69
    v_add_f32 v194, v194, v70
    v_add_f32 v195, v195, v71
    s_waitcnt lgkmcnt(0)
    v_add_f32 v196, v196, v76
    v_add_f32 v197, v197, v77
    v_add_f32 v198, v198, v78
    v_add_f32 v199, v199, v79
L_pw_29:
    ds_read_b32 v113, v174
    s_waitcnt lgkmcnt(0)
    v_cmp_gt_u32 vcc, 9, v113
    s_cbranch_vccnz L_pwr_30
    buffer_store_dwordx4 v[180:183], v162, s[60:63], s82 offen offset:0 sc1
    buffer_store_dwordx4 v[184:187], v162, s[60:63], s82 offen offset:128 sc1
    buffer_store_dwordx4 v[188:191], v162, s[60:63], s25 offen offset:0 sc1
    buffer_store_dwordx4 v[192:195], v162, s[60:63], s25 offen offset:128 sc1
    buffer_store_dwordx4 v[196:199], v166, s[60:63], s82 offen offset:0 sc1
    s_endpgm
L_exit:
    s_endpgm
L_pfr_14:
    s_mov_b64 exec, vcc
    s_sleep 8
    s_sub_u32 s96, s96, 1
    s_cbranch_scc0 L_pf_13
    s_endpgm
L_pwr_16:
    s_sleep 1
    s_sub_u32 s96, s96, 1
    s_cbranch_scc0 L_pw_15
    s_endpgm
L_pwr_18:
    s_sleep 4
    s_sub_u32 s96, s96, 1
    s_cbranch_scc0 L_pw_17
    s_endpgm
L_pwr_20:
    s_sleep 2
    s_sub_u32 s96, s96, 1
    s_cbranch_scc0 L_pw_19
    s_endpgm
L_pfr_22:
    s_mov_b64 exec, vcc
    s_sleep 4
    s_sub_u32 s96, s96, 1
    s_cbranch_scc0 L_pf_21
    s_endpgm
L_pwr_24:
    s_sleep 2
    s_sub_u32 s96, s96, 1
    s_cbranch_scc0 L_pw_23
    s_endpgm
L_pwr_30:
    s_sleep 2
    s_sub_u32 s96, s96, 1
    s_cbranch_scc0 L_pw_29
    s_endpgm
.p2align 12
.fill 112, 4, 0xbf810000
L_roleA:
    v_lshlrev_b32 v253, 2, v0
    v_add_u32 v253, 161792, v253
    v_mov_b32 v0, 0
    ds_write_b32 v253, v0
    s_lshr_b32 s71, s35, 3
    s_lshl2_add_u32 s66, s3, s71
    s_and_b32 s67, s35, 7
    s_and_b32 s70, s35, 3
    s_lshl2_add_u32 s68, s3, s70
    s_mov_b32 s96, 0x200000
    s_mov_b32 s94, 0
    s_mov_b32 s95, -1
    s_waitcnt lgkmcnt(0)
    s_mov_b32 s44, s32
    s_mov_b32 s45, s33
    s_mov_b32 s46, 0x10c8000
    s_mov_b32 s47, 0x20000
    s_lshr_b32 s72, s34, 1
    s_and_b32 s73, s34, 1
    s_lshl1_add_u32 s75, s64, s72
    s_mul_i32 s74, s75, 247808
    s_cmp_eq_u32 s65, 15
    s_cbranch_scc0 L_noconst
    s_lshl2_add_u32 s77, s64, s34
    v_min_u32 v1, 35, v254
    v_lshlrev_b32 v1, 7, v1
    v_mov_b32 v4, 0
    s_mul_i32 s76, s77, 4608
    s_add_u32 s76, s76, 0xfa0000
    buffer_store_dword v4, v1, s[44:47], s76 offen sc1
    v_lshlrev_b32 v2, 4, v254
    v_mov_b32 v20, -1
    v_mov_b32 v21, -1
    v_mov_b32 v22, -1
    v_mov_b32 v23, -1
    s_lshl_b32 s76, s77, 11
    s_add_u32 s76, s76, 0xf80000
    buffer_store_dwordx4 v[20:23], v2, s[44:47], s76 offen offset:0 sc1
    buffer_store_dwordx4 v[20:23], v2, s[44:47], s76 offen offset:1024 sc1
    v_lshrrev_b32 v1, 3, v254
    v_mul_u32_u24 v1, 10240, v1
    v_add_u32 v1, 11264, v1
    v_mul_lo_u32 v1, v1, s73
    v_add_u32 v1, v1, v2
    s_mul_i32 s76, s73, 0x3f803f80
    v_mov_b32 v8, 0x3f803f80
    v_mov_b32 v9, s76
    v_mov_b32 v10, v8
    v_mov_b32 v11, s76
    s_add_u32 s76, s74, 163840
    buffer_store_dwordx4 v[8:11], v1, s[44:47], s76 offen sc1
L_noconst:
    v_and_b32 v1, 15, v254
    v_lshrrev_b32 v2, 4, v254
    v_lshrrev_b32 v3, 1, v1
    v_xor_b32 v3, v3, v2
    v_lshlrev_b32 v3, 4, v3
    v_lshl_add_u32 v3, v1, 7, v3
    s_lshl_b32 s76, s72, 13
    v_add_u32 v128, s76, v3
    v_xor_b32 v129, 64, v128
    v_add_u32 v130, 0x10000, v128
    v_add_u32 v131, 0x10000, v129
    v_bfe_u32 v4, v254, 2, 2
    v_lshl_add_u32 v5, v2, 3, v4
    v_lshlrev_b32 v5, 8, v5
    v_and_b32 v6, 1, v2
    v_mul_u32_u24 v6, 3, v6
    v_lshl_or_b32 v6, v4, 2, v6
    s_lshl_b32 s76, s73, 3
    v_xor_b32 v6, s76, v6
    v_lshl_add_u32 v5, v6, 4, v5
    v_and_b32 v6, 1, v254
    v_lshl_add_u32 v5, v6, 3, v5
    v_add_u32 v132, 16384, v5
    s_mov_b64 s[14:15], s[8:9]
    s_mov_b32 s56, s10
    s_mov_b32 s57, s11
    s_mov_b32 s58, 0x280000
    s_mov_b32 s59, 0x20000
    s_cmp_ge_u32 s34, 2
    s_cselect_b32 s12, s18, s16
    s_cselect_b32 s13, s19, s17
    s_mov_b32 s60, s12
    s_mov_b32 s61, s13
    s_mov_b32 s62, 0xc8000
    s_mov_b32 s63, 0x20000
    v_lshrrev_b32 v1, 3, v254
    v_and_b32 v2, 7, v254
    v_lshrrev_b32 v3, 4, v254
    v_xor_b32 v4, v2, v3
    v_and_b32 v5, 3, v1
    v_lshrrev_b32 v6, 2, v1
    v_lshl_add_u32 v5, v6, 3, v5
    v_mul_u32_u24 v5, 1280, v5
    v_lshl_add_u32 v141, v4, 4, v5
    v_xor_b32 v6, 64, v141
    v_add_u32 v142, 19456, v6
    v_add_u32 v143, 3072, v141
    v_add_u32 v144, 22528, v6
    s_lshr_b32 s12, s34, 1
    s_lshl_b32 s13, s12, 6
    v_mul_u32_u24 v5, 1280, v1
    v_lshl_add_u32 v5, v4, 4, v5
    v_xor_b32 v145, s13, v5
    v_add_u32 v146, 9216, v145
    v_add_u32 v147, 18432, v145
    s_and_b32 s13, s34, 1
    s_mul_i32 s7, s12, 5120
    s_mul_i32 s5, s13, 3072
    s_add_u32 s7, s7, s5
    s_mul_i32 s5, s97, 51200
    s_mul_i32 s13, s13, 30720
    s_add_u32 s5, s5, s13
    s_lshl2_add_u32 s4, s64, s34
    s_mul_i32 s4, s4, 40960
    s_lshl_b32 s6, s34, 12
    s_and_b32 s8, s35, 3
    s_xor_b32 s8, s8, 1
    s_mul_i32 s8, s8, 5
    s_lshr_b32 s8, s8, 1
    s_mul_i32 s9, s69, 5
    s_lshr_b32 s9, s9, 2
    s_add_u32 s8, s8, s9
    s_add_u32 s9, s3, 7
    s_lshr_b32 s9, s9, 1
    s_add_u32 s8, s8, s9
    s_cmp_ge_u32 s8, 10
    s_cselect_b32 s9, 10, 0
    s_sub_u32 s8, s8, s9
    s_cmp_ge_u32 s8, 10
    s_cselect_b32 s9, 10, 0
    s_sub_u32 s8, s8, s9
    s_and_b32 s76, s34, 1
    s_lshr_b32 s77, s34, 1
    s_and_b32 s78, s66, 1
    s_lshr_b32 s85, s66, 1
    s_mul_i32 s79, s85, 5
    s_mul_i32 s70, s77, 3964928
    s_add_u32 s71, s70, 3964928
    s_and_b32 s86, s67, 7
    s_mul_i32 s86, s86, 495616
    s_add_u32 s93, s70, s86
    s_mov_b32 s48, s32
    s_mov_b32 s49, s33
    s_mov_b32 s50, s71
    s_mov_b32 s51, 0x20000
    s_mov_b32 s52, s28
    s_mov_b32 s53, s29
    s_mov_b32 s54, 0xa00000
    s_mov_b32 s55, 0x20000
    s_mov_b32 s82, 0
    s_mov_b32 s84, 0
    v_and_b32 v224, 31, v254
    v_lshrrev_b32 v225, 5, v254
    v_and_b32 v226, 0x13, v224
    v_and_b32 v227, 4, v224
    v_lshl_or_b32 v226, v227, 1, v226
    v_and_b32 v227, 8, v224
    v_lshrrev_b32 v227, 1, v227
    v_or_b32 v226, v227, v226
    s_mul_i32 s86, s78, 3
    s_add_u32 s86, s86, s79
    s_lshl_b32 s87, s86, 10
    v_lshl_add_u32 v227, v225, 10, s87
    v_lshl_add_u32 v228, v224, 4, v227
    v_lshl_add_u32 v208, v224, 4, v227
    v_add_u32 v208, 81920, v208
    s_add_u32 s87, s79, 2
    s_xor_b32 s88, s87, s78
    s_and_b32 s88, s88, 1
    s_lshl1_add_u32 s87, s87, s88
    s_lshl_b32 s87, s87, 9
    v_lshl_add_u32 v229, v224, 4, s87
    v_mov_b32 v227, 0x7f000000
    v_cndmask_b32 v229, v229, v227, s[94:95]
    s_add_u32 s87, s87, 81920
    v_lshl_add_u32 v209, v224, 4, s87
    v_mov_b32 v227, 163840
    v_cndmask_b32 v209, v209, v227, s[94:95]
    s_mul_i32 s86, s66, 20
    s_lshl2_add_u32 s87, s78, s86
    s_lshl_b32 s88, s78, 4
    s_sub_u32 s88, s86, s88
    v_add_u32 v210, s87, v226
    v_add_u32 v227, s88, v224
    v_cmp_le_u32 vcc, 16, v224
    v_mov_b32 v230, 175104
    s_nop 0
    v_cndmask_b32 v210, v210, v227, vcc
    v_cmp_le_u32 vcc, 20, v224
    v_mul_u32_u24 v227, 10368, v225
    v_add_u32 v227, 164864, v227
    v_lshl_add_u32 v210, v210, 4, v227
    v_cndmask_b32 v210, v210, v230, vcc
    v_cmp_le_u32 vcc, 21, v224
    v_mov_b32 v227, 0x7f000000
    v_mov_b32 v214, 0xdddd
    v_cndmask_b32 v210, v210, v227, vcc
    v_add_u32 v211, 20736, v210
    v_add_u32 v212, 41472, v210
    v_add_u32 v213, 62208, v210
    s_mul_i32 s87, s85, 40
    s_lshl4_add_u32 s87, s78, s87
    s_add_u32 s88, s87, 23
    s_lshr_b32 s87, s87, 7
    s_lshr_b32 s88, s88, 7
    s_add_u32 s89, s86, 19
    s_lshr_b32 s86, s86, 7
    s_lshr_b32 s89, s89, 7
    v_lshrrev_b32 v227, 4, v254
    s_add_u32 s90, s87, 5
    v_mov_b32 v252, s90
    s_add_u32 s90, s88, 5
    v_cmp_eq_u32 vcc, 1, v227
    v_mov_b32 v230, s90
    s_nop 0
    v_cndmask_b32 v252, v252, v230, vcc
    s_add_u32 s90, s86, 10
    v_cmp_eq_u32 vcc, 2, v227
    v_mov_b32 v230, s90
    s_nop 0
    v_cndmask_b32 v252, v252, v230, vcc
    s_add_u32 s90, s89, 10
    v_cmp_eq_u32 vcc, 3, v227
    v_mov_b32 v230, s90
    s_nop 0
    v_cndmask_b32 v252, v252, v230, vcc
    v_and_b32 v230, 15, v254
    v_lshl_add_u32 v252, v252, 4, v230
    v_lshlrev_b32 v252, 7, v252
    v_mov_b32 v251, s87
    v_mov_b32 v230, s88
    v_cndmask_b32 v251, v251, v230, s[94:95]
    v_bfe_u32 v230, v254, 4, 1
    v_lshl_add_u32 v251, v251, 4, v230
    s_lshl_b32 s90, s67, 1
    v_add_lshl_u32 v251, v251, s90, 7
    v_and_b32 v249, 3, v254
    v_lshlrev_b32 v249, 8, v249
    v_lshlrev_b32 v250, 2, v254
    v_add_u32 v250, 161792, v250
    v_add_u32 v249, v249, v250
    s_cmp_ge_u32 s65, 10
    s_cbranch_scc1 L_qV
    v_and_b32 v1, 3, v254
    v_lshlrev_b32 v1, 4, v1
    v_xor_b32 v132, v1, v132
    v_xor_b32 v133, 8, v132
    v_xor_b32 v134, 64, v132
    v_xor_b32 v135, 72, v132
    v_add_u32 v136, 0x10000, v132
    v_add_u32 v137, 0x10000, v133
    v_add_u32 v138, 0x10000, v134
    v_add_u32 v139, 0x10000, v135
    v_and_b32 v1, 15, v254
    v_lshrrev_b32 v2, 4, v254
    v_lshlrev_b32 v1, 4, v1
    v_lshl_add_u32 v140, v2, 10, v1
    s_lshl1_add_u32 s76, s65, s73
    s_lshl_b32 s77, s76, 13
    s_add_u32 s77, s77, s74
    s_add_u32 s78, s77, 4096
    s_mul_i32 s79, s73, 3
    s_add_u32 s79, s79, s65
    s_sub_u32 s80, 17, s79
    s_mul_i32 s81, s80, 52
    s_lshr_b32 s81, s81, 8
    s_mul_i32 s81, s81, 5
    s_sub_u32 s80, s80, s81
    s_lshl_b32 s81, s80, 4
    s_bfm_b64 s[20:21], 16, s81
    s_cmp_lt_u32 s80, 4
    s_cselect_b64 s[20:21], s[20:21], 0
    s_sub_u32 s80, 18, s79
    s_mul_i32 s81, s80, 52
    s_lshr_b32 s81, s81, 8
    s_mul_i32 s81, s81, 5
    s_sub_u32 s80, s80, s81
    s_lshl_b32 s81, s80, 4
    s_bfm_b64 s[22:23], 16, s81
    s_cmp_lt_u32 s80, 4
    s_cselect_b64 s[22:23], s[22:23], 0
    s_mov_b32 s80, 0x3ea52b5c
    s_barrier
    ds_read_b128 v[64:67], v128 offset:32768
    ds_read_b64_tr_b16 v[80:81], v132 offset:32768
    ds_read_b64_tr_b16 v[82:83], v132 offset:33792
    ds_read_b128 v[68:71], v128 offset:34816
    ds_read_b64_tr_b16 v[84:85], v133 offset:32768
    ds_read_b64_tr_b16 v[86:87], v133 offset:33792
    ds_read_b128 v[72:75], v128 offset:36864
    ds_read_b64_tr_b16 v[88:89], v134 offset:32768
    ds_read_b64_tr_b16 v[90:91], v134 offset:33792
    ds_read_b128 v[76:79], v128 offset:38912
    ds_read_b64_tr_b16 v[92:93], v135 offset:32768
    ds_read_b64_tr_b16 v[94:95], v135 offset:33792
    s_waitcnt lgkmcnt(0)
    v_mfma_f32_16x16x32_bf16 v[0:3], v[80:83], v[64:67], 0
    ds_read_b128 v[96:99], v129 offset:32768
    v_mfma_f32_16x16x32_bf16 v[4:7], v[80:83], v[68:71], 0
    ds_read_b64_tr_b16 v[112:113], v132 offset:40960
    ds_read_b64_tr_b16 v[114:115], v132 offset:41984
    v_mfma_f32_16x16x32_bf16 v[8:11], v[80:83], v[72:75], 0
    ds_read_b128 v[100:103], v129 offset:34816
    v_mfma_f32_16x16x32_bf16 v[12:15], v[80:83], v[76:79], 0
    ds_read_b64_tr_b16 v[116:117], v133 offset:40960
    ds_read_b64_tr_b16 v[118:119], v133 offset:41984
    v_mfma_f32_16x16x32_bf16 v[28:31], v[84:87], v[76:79], 0
    ds_read_b128 v[104:107], v129 offset:36864
    v_mfma_f32_16x16x32_bf16 v[24:27], v[84:87], v[72:75], 0
    ds_read_b64_tr_b16 v[120:121], v134 offset:40960
    ds_read_b64_tr_b16 v[122:123], v134 offset:41984
    v_mfma_f32_16x16x32_bf16 v[20:23], v[84:87], v[68:71], 0
    ds_read_b128 v[108:111], v129 offset:38912
    v_mfma_f32_16x16x32_bf16 v[16:19], v[84:87], v[64:67], 0
    ds_read_b64_tr_b16 v[124:125], v135 offset:40960
    ds_read_b64_tr_b16 v[126:127], v135 offset:41984
    v_mfma_f32_16x16x32_bf16 v[32:35], v[88:91], v[64:67], 0
    v_mfma_f32_16x16x32_bf16 v[36:39], v[88:91], v[68:71], 0
    v_mfma_f32_16x16x32_bf16 v[40:43], v[88:91], v[72:75], 0
    v_mfma_f32_16x16x32_bf16 v[44:47], v[88:91], v[76:79], 0
    v_mfma_f32_16x16x32_bf16 v[60:63], v[92:95], v[76:79], 0
    v_mfma_f32_16x16x32_bf16 v[56:59], v[92:95], v[72:75], 0
    v_mfma_f32_16x16x32_bf16 v[52:55], v[92:95], v[68:71], 0
    v_mfma_f32_16x16x32_bf16 v[48:51], v[92:95], v[64:67], 0
    s_waitcnt lgkmcnt(0)
    s_barrier
    v_mfma_f32_16x16x32_bf16 v[0:3], v[112:115], v[96:99], v[0:3]
    ds_read_b128 v[64:67], v130 offset:0
    v_mfma_f32_16x16x32_bf16 v[4:7], v[112:115], v[100:103], v[4:7]
    ds_read_b64_tr_b16 v[80:81], v136 offset:0
    ds_read_b64_tr_b16 v[82:83], v136 offset:1024
    v_mfma_f32_16x16x32_bf16 v[8:11], v[112:115], v[104:107], v[8:11]
    ds_read_b128 v[68:71], v130 offset:2048
    v_mfma_f32_16x16x32_bf16 v[12:15], v[112:115], v[108:111], v[12:15]
    ds_read_b64_tr_b16 v[84:85], v137 offset:0
    ds_read_b64_tr_b16 v[86:87], v137 offset:1024
    v_mfma_f32_16x16x32_bf16 v[28:31], v[116:119], v[108:111], v[28:31]
    ds_read_b128 v[72:75], v130 offset:4096
    v_mfma_f32_16x16x32_bf16 v[24:27], v[116:119], v[104:107], v[24:27]
    ds_read_b64_tr_b16 v[88:89], v138 offset:0
    ds_read_b64_tr_b16 v[90:91], v138 offset:1024
    v_mfma_f32_16x16x32_bf16 v[20:23], v[116:119], v[100:103], v[20:23]
    ds_read_b128 v[76:79], v130 offset:6144
    v_mfma_f32_16x16x32_bf16 v[16:19], v[116:119], v[96:99], v[16:19]
    ds_read_b64_tr_b16 v[92:93], v139 offset:0
    ds_read_b64_tr_b16 v[94:95], v139 offset:1024
    v_mfma_f32_16x16x32_bf16 v[32:35], v[120:123], v[96:99], v[32:35]
    v_mfma_f32_16x16x32_bf16 v[36:39], v[120:123], v[100:103], v[36:39]
    v_mfma_f32_16x16x32_bf16 v[40:43], v[120:123], v[104:107], v[40:43]
    v_mfma_f32_16x16x32_bf16 v[44:47], v[120:123], v[108:111], v[44:47]
    v_mfma_f32_16x16x32_bf16 v[60:63], v[124:127], v[108:111], v[60:63]
    v_mfma_f32_16x16x32_bf16 v[56:59], v[124:127], v[104:107], v[56:59]
    v_mfma_f32_16x16x32_bf16 v[52:55], v[124:127], v[100:103], v[52:55]
    v_mfma_f32_16x16x32_bf16 v[48:51], v[124:127], v[96:99], v[48:51]
    s_waitcnt lgkmcnt(0)
    v_mfma_f32_16x16x32_bf16 v[0:3], v[80:83], v[64:67], v[0:3]
    ds_read_b128 v[96:99], v131 offset:0
    v_mfma_f32_16x16x32_bf16 v[4:7], v[80:83], v[68:71], v[4:7]
    ds_read_b64_tr_b16 v[112:113], v136 offset:8192
    ds_read_b64_tr_b16 v[114:115], v136 offset:9216
    v_mfma_f32_16x16x32_bf16 v[8:11], v[80:83], v[72:75], v[8:11]
    ds_read_b128 v[100:103], v131 offset:2048
    v_mfma_f32_16x16x32_bf16 v[12:15], v[80:83], v[76:79], v[12:15]
    ds_read_b64_tr_b16 v[116:117], v137 offset:8192
    ds_read_b64_tr_b16 v[118:119], v137 offset:9216
    v_mfma_f32_16x16x32_bf16 v[28:31], v[84:87], v[76:79], v[28:31]
    ds_read_b128 v[104:107], v131 offset:4096
    v_mfma_f32_16x16x32_bf16 v[24:27], v[84:87], v[72:75], v[24:27]
    ds_read_b64_tr_b16 v[120:121], v138 offset:8192
    ds_read_b64_tr_b16 v[122:123], v138 offset:9216
    v_mfma_f32_16x16x32_bf16 v[20:23], v[84:87], v[68:71], v[20:23]
    ds_read_b128 v[108:111], v131 offset:6144
    v_mfma_f32_16x16x32_bf16 v[16:19], v[84:87], v[64:67], v[16:19]
    ds_read_b64_tr_b16 v[124:125], v139 offset:8192
    ds_read_b64_tr_b16 v[126:127], v139 offset:9216
    v_mfma_f32_16x16x32_bf16 v[32:35], v[88:91], v[64:67], v[32:35]
    v_mfma_f32_16x16x32_bf16 v[36:39], v[88:91], v[68:71], v[36:39]
    v_mfma_f32_16x16x32_bf16 v[40:43], v[88:91], v[72:75], v[40:43]
    v_mfma_f32_16x16x32_bf16 v[44:47], v[88:91], v[76:79], v[44:47]
    v_mfma_f32_16x16x32_bf16 v[60:63], v[92:95], v[76:79], v[60:63]
    v_mfma_f32_16x16x32_bf16 v[56:59], v[92:95], v[72:75], v[56:59]
    v_mfma_f32_16x16x32_bf16 v[52:55], v[92:95], v[68:71], v[52:55]
    v_mfma_f32_16x16x32_bf16 v[48:51], v[92:95], v[64:67], v[48:51]
    s_waitcnt lgkmcnt(0)
    s_barrier
    v_mfma_f32_16x16x32_bf16 v[0:3], v[112:115], v[96:99], v[0:3]
    ds_read_b128 v[64:67], v130 offset:32768
    v_mfma_f32_16x16x32_bf16 v[4:7], v[112:115], v[100:103], v[4:7]
    ds_read_b64_tr_b16 v[80:81], v136 offset:32768
    ds_read_b64_tr_b16 v[82:83], v136 offset:33792
    v_mfma_f32_16x16x32_bf16 v[8:11], v[112:115], v[104:107], v[8:11]
    ds_read_b128 v[68:71], v130 offset:34816
    v_mfma_f32_16x16x32_bf16 v[12:15], v[112:115], v[108:111], v[12:15]
    ds_read_b64_tr_b16 v[84:85], v137 offset:32768
    ds_read_b64_tr_b16 v[86:87], v137 offset:33792
    v_mfma_f32_16x16x32_bf16 v[28:31], v[116:119], v[108:111], v[28:31]
    ds_read_b128 v[72:75], v130 offset:36864
    v_mfma_f32_16x16x32_bf16 v[24:27], v[116:119], v[104:107], v[24:27]
    ds_read_b64_tr_b16 v[88:89], v138 offset:32768
    ds_read_b64_tr_b16 v[90:91], v138 offset:33792
    v_mfma_f32_16x16x32_bf16 v[20:23], v[116:119], v[100:103], v[20:23]
    ds_read_b128 v[76:79], v130 offset:38912
    v_mfma_f32_16x16x32_bf16 v[16:19], v[116:119], v[96:99], v[16:19]
    ds_read_b64_tr_b16 v[92:93], v139 offset:32768
    ds_read_b64_tr_b16 v[94:95], v139 offset:33792
    v_mfma_f32_16x16x32_bf16 v[32:35], v[120:123], v[96:99], v[32:35]
    v_mfma_f32_16x16x32_bf16 v[36:39], v[120:123], v[100:103], v[36:39]
    v_mfma_f32_16x16x32_bf16 v[40:43], v[120:123], v[104:107], v[40:43]
    v_mfma_f32_16x16x32_bf16 v[44:47], v[120:123], v[108:111], v[44:47]
    v_mfma_f32_16x16x32_bf16 v[60:63], v[124:127], v[108:111], v[60:63]
    v_mfma_f32_16x16x32_bf16 v[56:59], v[124:127], v[104:107], v[56:59]
    v_mfma_f32_16x16x32_bf16 v[52:55], v[124:127], v[100:103], v[52:55]
    v_mfma_f32_16x16x32_bf16 v[48:51], v[124:127], v[96:99], v[48:51]
    s_waitcnt lgkmcnt(0)
    v_mfma_f32_16x16x32_bf16 v[0:3], v[80:83], v[64:67], v[0:3]
    ds_read_b128 v[96:99], v131 offset:32768
    v_mfma_f32_16x16x32_bf16 v[4:7], v[80:83], v[68:71], v[4:7]
    ds_read_b64_tr_b16 v[112:113], v136 offset:40960
    ds_read_b64_tr_b16 v[114:115], v136 offset:41984
    v_mfma_f32_16x16x32_bf16 v[8:11], v[80:83], v[72:75], v[8:11]
    ds_read_b128 v[100:103], v131 offset:34816
    v_mfma_f32_16x16x32_bf16 v[12:15], v[80:83], v[76:79], v[12:15]
    ds_read_b64_tr_b16 v[116:117], v137 offset:40960
    ds_read_b64_tr_b16 v[118:119], v137 offset:41984
    v_mfma_f32_16x16x32_bf16 v[28:31], v[84:87], v[76:79], v[28:31]
    ds_read_b128 v[104:107], v131 offset:36864
    v_mfma_f32_16x16x32_bf16 v[24:27], v[84:87], v[72:75], v[24:27]
    ds_read_b64_tr_b16 v[120:121], v138 offset:40960
    ds_read_b64_tr_b16 v[122:123], v138 offset:41984
    v_mfma_f32_16x16x32_bf16 v[20:23], v[84:87], v[68:71], v[20:23]
    ds_read_b128 v[108:111], v131 offset:38912
    v_mfma_f32_16x16x32_bf16 v[16:19], v[84:87], v[64:67], v[16:19]
    ds_read_b64_tr_b16 v[124:125], v139 offset:40960
    ds_read_b64_tr_b16 v[126:127], v139 offset:41984
    v_mfma_f32_16x16x32_bf16 v[32:35], v[88:91], v[64:67], v[32:35]
    v_mfma_f32_16x16x32_bf16 v[36:39], v[88:91], v[68:71], v[36:39]
    v_mfma_f32_16x16x32_bf16 v[40:43], v[88:91], v[72:75], v[40:43]
    v_mfma_f32_16x16x32_bf16 v[44:47], v[88:91], v[76:79], v[44:47]
    v_mfma_f32_16x16x32_bf16 v[60:63], v[92:95], v[76:79], v[60:63]
    v_mfma_f32_16x16x32_bf16 v[56:59], v[92:95], v[72:75], v[56:59]
    v_mfma_f32_16x16x32_bf16 v[52:55], v[92:95], v[68:71], v[52:55]
    v_mfma_f32_16x16x32_bf16 v[48:51], v[92:95], v[64:67], v[48:51]
    s_waitcnt lgkmcnt(0)
    s_barrier
    v_mfma_f32_16x16x32_bf16 v[0:3], v[112:115], v[96:99], v[0:3]
    ds_read_b128 v[64:67], v128 offset:0
    v_mfma_f32_16x16x32_bf16 v[4:7], v[112:115], v[100:103], v[4:7]
    ds_read_b64_tr_b16 v[80:81], v132 offset:0
    ds_read_b64_tr_b16 v[82:83], v132 offset:1024
    v_mfma_f32_16x16x32_bf16 v[8:11], v[112:115], v[104:107], v[8:11]
    ds_read_b128 v[68:71], v128 offset:2048
    v_mfma_f32_16x16x32_bf16 v[12:15], v[112:115], v[108:111], v[12:15]
    ds_read_b64_tr_b16 v[84:85], v133 offset:0
    ds_read_b64_tr_b16 v[86:87], v133 offset:1024
    v_mfma_f32_16x16x32_bf16 v[28:31], v[116:119], v[108:111], v[28:31]
    ds_read_b128 v[72:75], v128 offset:4096
    v_mfma_f32_16x16x32_bf16 v[24:27], v[116:119], v[104:107], v[24:27]
    ds_read_b64_tr_b16 v[88:89], v134 offset:0
    ds_read_b64_tr_b16 v[90:91], v134 offset:1024
    v_mfma_f32_16x16x32_bf16 v[20:23], v[116:119], v[100:103], v[20:23]
    ds_read_b128 v[76:79], v128 offset:6144
    v_mfma_f32_16x16x32_bf16 v[16:19], v[116:119], v[96:99], v[16:19]
    ds_read_b64_tr_b16 v[92:93], v135 offset:0
    ds_read_b64_tr_b16 v[94:95], v135 offset:1024
    v_mfma_f32_16x16x32_bf16 v[32:35], v[120:123], v[96:99], v[32:35]
    v_mfma_f32_16x16x32_bf16 v[36:39], v[120:123], v[100:103], v[36:39]
    v_mfma_f32_16x16x32_bf16 v[40:43], v[120:123], v[104:107], v[40:43]
    v_mfma_f32_16x16x32_bf16 v[44:47], v[120:123], v[108:111], v[44:47]
    v_mfma_f32_16x16x32_bf16 v[60:63], v[124:127], v[108:111], v[60:63]
    v_mfma_f32_16x16x32_bf16 v[56:59], v[124:127], v[104:107], v[56:59]
    v_mfma_f32_16x16x32_bf16 v[52:55], v[124:127], v[100:103], v[52:55]
    v_mfma_f32_16x16x32_bf16 v[48:51], v[124:127], v[96:99], v[48:51]
    s_waitcnt lgkmcnt(0)
    v_mfma_f32_16x16x32_bf16 v[0:3], v[80:83], v[64:67], v[0:3]
    ds_read_b128 v[96:99], v129 offset:0
    v_mfma_f32_16x16x32_bf16 v[4:7], v[80:83], v[68:71], v[4:7]
    ds_read_b64_tr_b16 v[112:113], v132 offset:8192
    ds_read_b64_tr_b16 v[114:115], v132 offset:9216
    v_mfma_f32_16x16x32_bf16 v[8:11], v[80:83], v[72:75], v[8:11]
    ds_read_b128 v[100:103], v129 offset:2048
    v_mfma_f32_16x16x32_bf16 v[12:15], v[80:83], v[76:79], v[12:15]
    ds_read_b64_tr_b16 v[116:117], v133 offset:8192
    ds_read_b64_tr_b16 v[118:119], v133 offset:9216
    v_mfma_f32_16x16x32_bf16 v[28:31], v[84:87], v[76:79], v[28:31]
    ds_read_b128 v[104:107], v129 offset:4096
    v_mfma_f32_16x16x32_bf16 v[24:27], v[84:87], v[72:75], v[24:27]
    ds_read_b64_tr_b16 v[120:121], v134 offset:8192
    ds_read_b64_tr_b16 v[122:123], v134 offset:9216
    v_mfma_f32_16x16x32_bf16 v[20:23], v[84:87], v[68:71], v[20:23]
    ds_read_b128 v[108:111], v129 offset:6144
    v_mfma_f32_16x16x32_bf16 v[16:19], v[84:87], v[64:67], v[16:19]
    ds_read_b64_tr_b16 v[124:125], v135 offset:8192
    ds_read_b64_tr_b16 v[126:127], v135 offset:9216
    v_mfma_f32_16x16x32_bf16 v[32:35], v[88:91], v[64:67], v[32:35]
    v_mfma_f32_16x16x32_bf16 v[36:39], v[88:91], v[68:71], v[36:39]
    v_mfma_f32_16x16x32_bf16 v[40:43], v[88:91], v[72:75], v[40:43]
    v_mfma_f32_16x16x32_bf16 v[44:47], v[88:91], v[76:79], v[44:47]
    v_mfma_f32_16x16x32_bf16 v[60:63], v[92:95], v[76:79], v[60:63]
    v_mfma_f32_16x16x32_bf16 v[56:59], v[92:95], v[72:75], v[56:59]
    v_mfma_f32_16x16x32_bf16 v[52:55], v[92:95], v[68:71], v[52:55]
    v_mfma_f32_16x16x32_bf16 v[48:51], v[92:95], v[64:67], v[48:51]
    s_waitcnt lgkmcnt(0)
    s_barrier
    v_mfma_f32_16x16x32_bf16 v[0:3], v[112:115], v[96:99], v[0:3]
    ds_read_b128 v[64:67], v128 offset:32768
    v_mfma_f32_16x16x32_bf16 v[4:7], v[112:115], v[100:103], v[4:7]
    ds_read_b64_tr_b16 v[80:81], v132 offset:32768
    ds_read_b64_tr_b16 v[82:83], v132 offset:33792
    v_mfma_f32_16x16x32_bf16 v[8:11], v[112:115], v[104:107], v[8:11]
    ds_read_b128 v[68:71], v128 offset:34816
    v_mfma_f32_16x16x32_bf16 v[12:15], v[112:115], v[108:111], v[12:15]
    ds_read_b64_tr_b16 v[84:85], v133 offset:32768
    ds_read_b64_tr_b16 v[86:87], v133 offset:33792
    v_mfma_f32_16x16x32_bf16 v[28:31], v[116:119], v[108:111], v[28:31]
    ds_read_b128 v[72:75], v128 offset:36864
    v_mfma_f32_16x16x32_bf16 v[24:27], v[116:119], v[104:107], v[24:27]
    ds_read_b64_tr_b16 v[88:89], v134 offset:32768
    ds_read_b64_tr_b16 v[90:91], v134 offset:33792
    v_mfma_f32_16x16x32_bf16 v[20:23], v[116:119], v[100:103], v[20:23]
    ds_read_b128 v[76:79], v128 offset:38912
    v_mfma_f32_16x16x32_bf16 v[16:19], v[116:119], v[96:99], v[16:19]
    ds_read_b64_tr_b16 v[92:93], v135 offset:32768
    ds_read_b64_tr_b16 v[94:95], v135 offset:33792
    v_mfma_f32_16x16x32_bf16 v[32:35], v[120:123], v[96:99], v[32:35]
    v_mfma_f32_16x16x32_bf16 v[36:39], v[120:123], v[100:103], v[36:39]
    v_mfma_f32_16x16x32_bf16 v[40:43], v[120:123], v[104:107], v[40:43]
    v_mfma_f32_16x16x32_bf16 v[44:47], v[120:123], v[108:111], v[44:47]
    v_mfma_f32_16x16x32_bf16 v[60:63], v[124:127], v[108:111], v[60:63]
    v_mfma_f32_16x16x32_bf16 v[56:59], v[124:127], v[104:107], v[56:59]
    v_mfma_f32_16x16x32_bf16 v[52:55], v[124:127], v[100:103], v[52:55]
    v_mfma_f32_16x16x32_bf16 v[48:51], v[124:127], v[96:99], v[48:51]
    s_waitcnt lgkmcnt(0)
    v_mfma_f32_16x16x32_bf16 v[0:3], v[80:83], v[64:67], v[0:3]
    ds_read_b128 v[96:99], v129 offset:32768
    v_mfma_f32_16x16x32_bf16 v[4:7], v[80:83], v[68:71], v[4:7]
    ds_read_b64_tr_b16 v[112:113], v132 offset:40960
    ds_read_b64_tr_b16 v[114:115], v132 offset:41984
    v_mfma_f32_16x16x32_bf16 v[8:11], v[80:83], v[72:75], v[8:11]
    ds_read_b128 v[100:103], v129 offset:34816
    v_mfma_f32_16x16x32_bf16 v[12:15], v[80:83], v[76:79], v[12:15]
    ds_read_b64_tr_b16 v[116:117], v133 offset:40960
    ds_read_b64_tr_b16 v[118:119], v133 offset:41984
    v_mfma_f32_16x16x32_bf16 v[28:31], v[84:87], v[76:79], v[28:31]
    ds_read_b128 v[104:107], v129 offset:36864
    v_mfma_f32_16x16x32_bf16 v[24:27], v[84:87], v[72:75], v[24:27]
    ds_read_b64_tr_b16 v[120:121], v134 offset:40960
    ds_read_b64_tr_b16 v[122:123], v134 offset:41984
    v_mfma_f32_16x16x32_bf16 v[20:23], v[84:87], v[68:71], v[20:23]
    ds_read_b128 v[108:111], v129 offset:38912
    v_mfma_f32_16x16x32_bf16 v[16:19], v[84:87], v[64:67], v[16:19]
    ds_read_b64_tr_b16 v[124:125], v135 offset:40960
    ds_read_b64_tr_b16 v[126:127], v135 offset:41984
    v_mfma_f32_16x16x32_bf16 v[32:35], v[88:91], v[64:67], v[32:35]
    v_mfma_f32_16x16x32_bf16 v[36:39], v[88:91], v[68:71], v[36:39]
    v_mfma_f32_16x16x32_bf16 v[40:43], v[88:91], v[72:75], v[40:43]
    v_mfma_f32_16x16x32_bf16 v[44:47], v[88:91], v[76:79], v[44:47]
    v_mfma_f32_16x16x32_bf16 v[60:63], v[92:95], v[76:79], v[60:63]
    v_mfma_f32_16x16x32_bf16 v[56:59], v[92:95], v[72:75], v[56:59]
    v_mfma_f32_16x16x32_bf16 v[52:55], v[92:95], v[68:71], v[52:55]
    v_mfma_f32_16x16x32_bf16 v[48:51], v[92:95], v[64:67], v[48:51]
L_pgQ:
    s_waitcnt lgkmcnt(0)
    s_barrier
    v_mfma_f32_16x16x32_bf16 v[0:3], v[112:115], v[96:99], v[0:3]
    ds_read_b128 v[64:67], v130 offset:0
    v_mfma_f32_16x16x32_bf16 v[4:7], v[112:115], v[100:103], v[4:7]
    ds_read_b64_tr_b16 v[80:81], v136 offset:0
    ds_read_b64_tr_b16 v[82:83], v136 offset:1024
    v_mfma_f32_16x16x32_bf16 v[8:11], v[112:115], v[104:107], v[8:11]
    ds_read_b128 v[68:71], v130 offset:2048
    v_mfma_f32_16x16x32_bf16 v[12:15], v[112:115], v[108:111], v[12:15]
    ds_read_b64_tr_b16 v[84:85], v137 offset:0
    ds_read_b64_tr_b16 v[86:87], v137 offset:1024
    v_mfma_f32_16x16x32_bf16 v[28:31], v[116:119], v[108:111], v[28:31]
    ds_read_b128 v[72:75], v130 offset:4096
    v_mfma_f32_16x16x32_bf16 v[24:27], v[116:119], v[104:107], v[24:27]
    ds_read_b64_tr_b16 v[88:89], v138 offset:0
    ds_read_b64_tr_b16 v[90:91], v138 offset:1024
    v_mfma_f32_16x16x32_bf16 v[20:23], v[116:119], v[100:103], v[20:23]
    ds_read_b128 v[76:79], v130 offset:6144
    v_mfma_f32_16x16x32_bf16 v[16:19], v[116:119], v[96:99], v[16:19]
    ds_read_b64_tr_b16 v[92:93], v139 offset:0
    ds_read_b64_tr_b16 v[94:95], v139 offset:1024
    v_mfma_f32_16x16x32_bf16 v[32:35], v[120:123], v[96:99], v[32:35]
    v_mfma_f32_16x16x32_bf16 v[36:39], v[120:123], v[100:103], v[36:39]
    v_mfma_f32_16x16x32_bf16 v[40:43], v[120:123], v[104:107], v[40:43]
    v_mfma_f32_16x16x32_bf16 v[44:47], v[120:123], v[108:111], v[44:47]
    v_mfma_f32_16x16x32_bf16 v[60:63], v[124:127], v[108:111], v[60:63]
    v_mfma_f32_16x16x32_bf16 v[56:59], v[124:127], v[104:107], v[56:59]
    v_mfma_f32_16x16x32_bf16 v[52:55], v[124:127], v[100:103], v[52:55]
    v_mfma_f32_16x16x32_bf16 v[48:51], v[124:127], v[96:99], v[48:51]
    s_waitcnt lgkmcnt(0)
    v_mfma_f32_16x16x32_bf16 v[0:3], v[80:83], v[64:67], v[0:3]
    ds_read_b128 v[96:99], v131 offset:0
    v_mfma_f32_16x16x32_bf16 v[4:7], v[80:83], v[68:71], v[4:7]
    ds_read_b64_tr_b16 v[112:113], v136 offset:8192
    ds_read_b64_tr_b16 v[114:115], v136 offset:9216
    v_mfma_f32_16x16x32_bf16 v[8:11], v[80:83], v[72:75], v[8:11]
    ds_read_b128 v[100:103], v131 offset:2048
    v_mfma_f32_16x16x32_bf16 v[12:15], v[80:83], v[76:79], v[12:15]
    ds_read_b64_tr_b16 v[116:117], v137 offset:8192
    ds_read_b64_tr_b16 v[118:119], v137 offset:9216
    v_mfma_f32_16x16x32_bf16 v[28:31], v[84:87], v[76:79], v[28:31]
    ds_read_b128 v[104:107], v131 offset:4096
    v_mfma_f32_16x16x32_bf16 v[24:27], v[84:87], v[72:75], v[24:27]
    ds_read_b64_tr_b16 v[120:121], v138 offset:8192
    ds_read_b64_tr_b16 v[122:123], v138 offset:9216
    v_mfma_f32_16x16x32_bf16 v[20:23], v[84:87], v[68:71], v[20:23]
    ds_read_b128 v[108:111], v131 offset:6144
    v_mfma_f32_16x16x32_bf16 v[16:19], v[84:87], v[64:67], v[16:19]
    ds_read_b64_tr_b16 v[124:125], v139 offset:8192
    ds_read_b64_tr_b16 v[126:127], v139 offset:9216
    v_mfma_f32_16x16x32_bf16 v[32:35], v[88:91], v[64:67], v[32:35]
    v_mfma_f32_16x16x32_bf16 v[36:39], v[88:91], v[68:71], v[36:39]
    v_mfma_f32_16x16x32_bf16 v[40:43], v[88:91], v[72:75], v[40:43]
    v_mfma_f32_16x16x32_bf16 v[44:47], v[88:91], v[76:79], v[44:47]
    v_mfma_f32_16x16x32_bf16 v[60:63], v[92:95], v[76:79], v[60:63]
    v_mfma_f32_16x16x32_bf16 v[56:59], v[92:95], v[72:75], v[56:59]
    v_mfma_f32_16x16x32_bf16 v[52:55], v[92:95], v[68:71], v[52:55]
    v_mfma_f32_16x16x32_bf16 v[48:51], v[92:95], v[64:67], v[48:51]
    s_waitcnt lgkmcnt(0)
    s_barrier
    v_mfma_f32_16x16x32_bf16 v[0:3], v[112:115], v[96:99], v[0:3]
    ds_read_b128 v[64:67], v130 offset:32768
    v_mfma_f32_16x16x32_bf16 v[4:7], v[112:115], v[100:103], v[4:7]
    ds_read_b64_tr_b16 v[80:81], v136 offset:32768
    ds_read_b64_tr_b16 v[82:83], v136 offset:33792
    v_mfma_f32_16x16x32_bf16 v[8:11], v[112:115], v[104:107], v[8:11]
    ds_read_b128 v[68:71], v130 offset:34816
    v_mfma_f32_16x16x32_bf16 v[12:15], v[112:115], v[108:111], v[12:15]
    ds_read_b64_tr_b16 v[84:85], v137 offset:32768
    ds_read_b64_tr_b16 v[86:87], v137 offset:33792
    v_mfma_f32_16x16x32_bf16 v[28:31], v[116:119], v[108:111], v[28:31]
    ds_read_b128 v[72:75], v130 offset:36864
    v_mfma_f32_16x16x32_bf16 v[24:27], v[116:119], v[104:107], v[24:27]
    ds_read_b64_tr_b16 v[88:89], v138 offset:32768
    ds_read_b64_tr_b16 v[90:91], v138 offset:33792
    v_mfma_f32_16x16x32_bf16 v[20:23], v[116:119], v[100:103], v[20:23]
    ds_read_b128 v[76:79], v130 offset:38912
    v_mfma_f32_16x16x32_bf16 v[16:19], v[116:119], v[96:99], v[16:19]
    ds_read_b64_tr_b16 v[92:93], v139 offset:32768
    ds_read_b64_tr_b16 v[94:95], v139 offset:33792
    v_mfma_f32_16x16x32_bf16 v[32:35], v[120:123], v[96:99], v[32:35]
    v_mfma_f32_16x16x32_bf16 v[36:39], v[120:123], v[100:103], v[36:39]
    v_mfma_f32_16x16x32_bf16 v[40:43], v[120:123], v[104:107], v[40:43]
    v_mfma_f32_16x16x32_bf16 v[44:47], v[120:123], v[108:111], v[44:47]
    v_mfma_f32_16x16x32_bf16 v[60:63], v[124:127], v[108:111], v[60:63]
    v_mfma_f32_16x16x32_bf16 v[56:59], v[124:127], v[104:107], v[56:59]
    v_mfma_f32_16x16x32_bf16 v[52:55], v[124:127], v[100:103], v[52:55]
    v_mfma_f32_16x16x32_bf16 v[48:51], v[124:127], v[96:99], v[48:51]
    s_waitcnt lgkmcnt(0)
    v_mfma_f32_16x16x32_bf16 v[0:3], v[80:83], v[64:67], v[0:3]
    ds_read_b128 v[96:99], v131 offset:32768
    v_mfma_f32_16x16x32_bf16 v[4:7], v[80:83], v[68:71], v[4:7]
    ds_read_b64_tr_b16 v[112:113], v136 offset:40960
    ds_read_b64_tr_b16 v[114:115], v136 offset:41984
    v_mfma_f32_16x16x32_bf16 v[8:11], v[80:83], v[72:75], v[8:11]
    ds_read_b128 v[100:103], v131 offset:34816
    v_mfma_f32_16x16x32_bf16 v[12:15], v[80:83], v[76:79], v[12:15]
    ds_read_b64_tr_b16 v[116:117], v137 offset:40960
    ds_read_b64_tr_b16 v[118:119], v137 offset:41984
    v_mfma_f32_16x16x32_bf16 v[28:31], v[84:87], v[76:79], v[28:31]
    ds_read_b128 v[104:107], v131 offset:36864
    v_mfma_f32_16x16x32_bf16 v[24:27], v[84:87], v[72:75], v[24:27]
    ds_read_b64_tr_b16 v[120:121], v138 offset:40960
    ds_read_b64_tr_b16 v[122:123], v138 offset:41984
    v_mfma_f32_16x16x32_bf16 v[20:23], v[84:87], v[68:71], v[20:23]
    ds_read_b128 v[108:111], v131 offset:38912
    v_mfma_f32_16x16x32_bf16 v[16:19], v[84:87], v[64:67], v[16:19]
    ds_read_b64_tr_b16 v[124:125], v139 offset:40960
    ds_read_b64_tr_b16 v[126:127], v139 offset:41984
    v_mfma_f32_16x16x32_bf16 v[32:35], v[88:91], v[64:67], v[32:35]
    v_mfma_f32_16x16x32_bf16 v[36:39], v[88:91], v[68:71], v[36:39]
    v_mfma_f32_16x16x32_bf16 v[40:43], v[88:91], v[72:75], v[40:43]
    v_mfma_f32_16x16x32_bf16 v[44:47], v[88:91], v[76:79], v[44:47]
    v_mfma_f32_16x16x32_bf16 v[60:63], v[92:95], v[76:79], v[60:63]
    v_mfma_f32_16x16x32_bf16 v[56:59], v[92:95], v[72:75], v[56:59]
    v_mfma_f32_16x16x32_bf16 v[52:55], v[92:95], v[68:71], v[52:55]
    v_mfma_f32_16x16x32_bf16 v[48:51], v[92:95], v[64:67], v[48:51]
    s_waitcnt lgkmcnt(0)
    s_barrier
    v_mfma_f32_16x16x32_bf16 v[0:3], v[112:115], v[96:99], v[0:3]
    ds_read_b128 v[64:67], v128 offset:0
    v_mfma_f32_16x16x32_bf16 v[4:7], v[112:115], v[100:103], v[4:7]
    ds_read_b64_tr_b16 v[80:81], v132 offset:0
    ds_read_b64_tr_b16 v[82:83], v132 offset:1024
    v_mfma_f32_16x16x32_bf16 v[8:11], v[112:115], v[104:107], v[8:11]
    ds_read_b128 v[68:71], v128 offset:2048
    v_mfma_f32_16x16x32_bf16 v[12:15], v[112:115], v[108:111], v[12:15]
    ds_read_b64_tr_b16 v[84:85], v133 offset:0
    ds_read_b64_tr_b16 v[86:87], v133 offset:1024
    v_mfma_f32_16x16x32_bf16 v[28:31], v[116:119], v[108:111], v[28:31]
    ds_read_b128 v[72:75], v128 offset:4096
    v_mfma_f32_16x16x32_bf16 v[24:27], v[116:119], v[104:107], v[24:27]
    ds_read_b64_tr_b16 v[88:89], v134 offset:0
    ds_read_b64_tr_b16 v[90:91], v134 offset:1024
    v_mfma_f32_16x16x32_bf16 v[20:23], v[116:119], v[100:103], v[20:23]
    ds_read_b128 v[76:79], v128 offset:6144
    v_mfma_f32_16x16x32_bf16 v[16:19], v[116:119], v[96:99], v[16:19]
    ds_read_b64_tr_b16 v[92:93], v135 offset:0
    ds_read_b64_tr_b16 v[94:95], v135 offset:1024
    v_mfma_f32_16x16x32_bf16 v[32:35], v[120:123], v[96:99], v[32:35]
    v_mfma_f32_16x16x32_bf16 v[36:39], v[120:123], v[100:103], v[36:39]
    v_mfma_f32_16x16x32_bf16 v[40:43], v[120:123], v[104:107], v[40:43]
    v_mfma_f32_16x16x32_bf16 v[44:47], v[120:123], v[108:111], v[44:47]
    v_mfma_f32_16x16x32_bf16 v[60:63], v[124:127], v[108:111], v[60:63]
    v_mfma_f32_16x16x32_bf16 v[56:59], v[124:127], v[104:107], v[56:59]
    v_mfma_f32_16x16x32_bf16 v[52:55], v[124:127], v[100:103], v[52:55]
    v_mfma_f32_16x16x32_bf16 v[48:51], v[124:127], v[96:99], v[48:51]
    s_waitcnt lgkmcnt(0)
    v_mfma_f32_16x16x32_bf16 v[0:3], v[80:83], v[64:67], v[0:3]
    ds_read_b128 v[96:99], v129 offset:0
    v_mfma_f32_16x16x32_bf16 v[4:7], v[80:83], v[68:71], v[4:7]
    ds_read_b64_tr_b16 v[112:113], v132 offset:8192
    ds_read_b64_tr_b16 v[114:115], v132 offset:9216
    v_mfma_f32_16x16x32_bf16 v[8:11], v[80:83], v[72:75], v[8:11]
    ds_read_b128 v[100:103], v129 offset:2048
    v_mfma_f32_16x16x32_bf16 v[12:15], v[80:83], v[76:79], v[12:15]
    ds_read_b64_tr_b16 v[116:117], v133 offset:8192
    ds_read_b64_tr_b16 v[118:119], v133 offset:9216
    v_mfma_f32_16x16x32_bf16 v[28:31], v[84:87], v[76:79], v[28:31]
    ds_read_b128 v[104:107], v129 offset:4096
    v_mfma_f32_16x16x32_bf16 v[24:27], v[84:87], v[72:75], v[24:27]
    ds_read_b64_tr_b16 v[120:121], v134 offset:8192
    ds_read_b64_tr_b16 v[122:123], v134 offset:9216
    v_mfma_f32_16x16x32_bf16 v[20:23], v[84:87], v[68:71], v[20:23]
    ds_read_b128 v[108:111], v129 offset:6144
    v_mfma_f32_16x16x32_bf16 v[16:19], v[84:87], v[64:67], v[16:19]
    ds_read_b64_tr_b16 v[124:125], v135 offset:8192
    ds_read_b64_tr_b16 v[126:127], v135 offset:9216
    v_mfma_f32_16x16x32_bf16 v[32:35], v[88:91], v[64:67], v[32:35]
    v_mfma_f32_16x16x32_bf16 v[36:39], v[88:91], v[68:71], v[36:39]
    v_mfma_f32_16x16x32_bf16 v[40:43], v[88:91], v[72:75], v[40:43]
    v_mfma_f32_16x16x32_bf16 v[44:47], v[88:91], v[76:79], v[44:47]
    v_mfma_f32_16x16x32_bf16 v[60:63], v[92:95], v[76:79], v[60:63]
    v_mfma_f32_16x16x32_bf16 v[56:59], v[92:95], v[72:75], v[56:59]
    v_mfma_f32_16x16x32_bf16 v[52:55], v[92:95], v[68:71], v[52:55]
    v_mfma_f32_16x16x32_bf16 v[48:51], v[92:95], v[64:67], v[48:51]
    s_waitcnt lgkmcnt(0)
    s_barrier
    v_mfma_f32_16x16x32_bf16 v[0:3], v[112:115], v[96:99], v[0:3]
    ds_read_b128 v[64:67], v128 offset:32768
    v_mfma_f32_16x16x32_bf16 v[4:7], v[112:115], v[100:103], v[4:7]
    ds_read_b64_tr_b16 v[80:81], v132 offset:32768
    ds_read_b64_tr_b16 v[82:83], v132 offset:33792
    v_mfma_f32_16x16x32_bf16 v[8:11], v[112:115], v[104:107], v[8:11]
    ds_read_b128 v[68:71], v128 offset:34816
    v_mfma_f32_16x16x32_bf16 v[12:15], v[112:115], v[108:111], v[12:15]
    ds_read_b64_tr_b16 v[84:85], v133 offset:32768
    ds_read_b64_tr_b16 v[86:87], v133 offset:33792
    v_mfma_f32_16x16x32_bf16 v[28:31], v[116:119], v[108:111], v[28:31]
    ds_read_b128 v[72:75], v128 offset:36864
    v_mfma_f32_16x16x32_bf16 v[24:27], v[116:119], v[104:107], v[24:27]
    ds_read_b64_tr_b16 v[88:89], v134 offset:32768
    ds_read_b64_tr_b16 v[90:91], v134 offset:33792
    v_mfma_f32_16x16x32_bf16 v[20:23], v[116:119], v[100:103], v[20:23]
    ds_read_b128 v[76:79], v128 offset:38912
    v_mfma_f32_16x16x32_bf16 v[16:19], v[116:119], v[96:99], v[16:19]
    ds_read_b64_tr_b16 v[92:93], v135 offset:32768
    ds_read_b64_tr_b16 v[94:95], v135 offset:33792
    v_mfma_f32_16x16x32_bf16 v[32:35], v[120:123], v[96:99], v[32:35]
    v_mfma_f32_16x16x32_bf16 v[36:39], v[120:123], v[100:103], v[36:39]
    v_mfma_f32_16x16x32_bf16 v[40:43], v[120:123], v[104:107], v[40:43]
    v_mfma_f32_16x16x32_bf16 v[44:47], v[120:123], v[108:111], v[44:47]
    v_mfma_f32_16x16x32_bf16 v[60:63], v[124:127], v[108:111], v[60:63]
    v_mfma_f32_16x16x32_bf16 v[56:59], v[124:127], v[104:107], v[56:59]
    v_mfma_f32_16x16x32_bf16 v[52:55], v[124:127], v[100:103], v[52:55]
    v_mfma_f32_16x16x32_bf16 v[48:51], v[124:127], v[96:99], v[48:51]
    s_waitcnt lgkmcnt(0)
    v_mfma_f32_16x16x32_bf16 v[0:3], v[80:83], v[64:67], v[0:3]
    ds_read_b128 v[96:99], v129 offset:32768
    v_mfma_f32_16x16x32_bf16 v[4:7], v[80:83], v[68:71], v[4:7]
    ds_read_b64_tr_b16 v[112:113], v132 offset:40960
    ds_read_b64_tr_b16 v[114:115], v132 offset:41984
    v_mfma_f32_16x16x32_bf16 v[8:11], v[80:83], v[72:75], v[8:11]
    ds_read_b128 v[100:103], v129 offset:34816
    v_mfma_f32_16x16x32_bf16 v[12:15], v[80:83], v[76:79], v[12:15]
    ds_read_b64_tr_b16 v[116:117], v133 offset:40960
    ds_read_b64_tr_b16 v[118:119], v133 offset:41984
    v_mfma_f32_16x16x32_bf16 v[28:31], v[84:87], v[76:79], v[28:31]
    ds_read_b128 v[104:107], v129 offset:36864
    v_mfma_f32_16x16x32_bf16 v[24:27], v[84:87], v[72:75], v[24:27]
    ds_read_b64_tr_b16 v[120:121], v134 offset:40960
    ds_read_b64_tr_b16 v[122:123], v134 offset:41984
    v_mfma_f32_16x16x32_bf16 v[20:23], v[84:87], v[68:71], v[20:23]
    ds_read_b128 v[108:111], v129 offset:38912
    v_mfma_f32_16x16x32_bf16 v[16:19], v[84:87], v[64:67], v[16:19]
    ds_read_b64_tr_b16 v[124:125], v135 offset:40960
    ds_read_b64_tr_b16 v[126:127], v135 offset:41984
    v_mfma_f32_16x16x32_bf16 v[32:35], v[88:91], v[64:67], v[32:35]
    v_mfma_f32_16x16x32_bf16 v[36:39], v[88:91], v[68:71], v[36:39]
    v_mfma_f32_16x16x32_bf16 v[40:43], v[88:91], v[72:75], v[40:43]
    v_mfma_f32_16x16x32_bf16 v[44:47], v[88:91], v[76:79], v[44:47]
    v_mfma_f32_16x16x32_bf16 v[60:63], v[92:95], v[76:79], v[60:63]
    v_mfma_f32_16x16x32_bf16 v[56:59], v[92:95], v[72:75], v[56:59]
    v_mfma_f32_16x16x32_bf16 v[52:55], v[92:95], v[68:71], v[52:55]
    v_mfma_f32_16x16x32_bf16 v[48:51], v[92:95], v[64:67], v[48:51]
    s_waitcnt lgkmcnt(0)
    s_barrier
    v_mfma_f32_16x16x32_bf16 v[0:3], v[112:115], v[96:99], v[0:3]
    ds_read_b128 v[64:67], v130 offset:0
    v_mfma_f32_16x16x32_bf16 v[4:7], v[112:115], v[100:103], v[4:7]
    ds_read_b64_tr_b16 v[80:81], v136 offset:0
    ds_read_b64_tr_b16 v[82:83], v136 offset:1024
    v_mfma_f32_16x16x32_bf16 v[8:11], v[112:115], v[104:107], v[8:11]
    ds_read_b128 v[68:71], v130 offset:2048
    v_mfma_f32_16x16x32_bf16 v[12:15], v[112:115], v[108:111], v[12:15]
    ds_read_b64_tr_b16 v[84:85], v137 offset:0
    ds_read_b64_tr_b16 v[86:87], v137 offset:1024
    v_mfma_f32_16x16x32_bf16 v[28:31], v[116:119], v[108:111], v[28:31]
    ds_read_b128 v[72:75], v130 offset:4096
    v_mfma_f32_16x16x32_bf16 v[24:27], v[116:119], v[104:107], v[24:27]
    ds_read_b64_tr_b16 v[88:89], v138 offset:0
    ds_read_b64_tr_b16 v[90:91], v138 offset:1024
    v_mfma_f32_16x16x32_bf16 v[20:23], v[116:119], v[100:103], v[20:23]
    ds_read_b128 v[76:79], v130 offset:6144
    v_mfma_f32_16x16x32_bf16 v[16:19], v[116:119], v[96:99], v[16:19]
    ds_read_b64_tr_b16 v[92:93], v139 offset:0
    ds_read_b64_tr_b16 v[94:95], v139 offset:1024
    v_mfma_f32_16x16x32_bf16 v[32:35], v[120:123], v[96:99], v[32:35]
    v_mfma_f32_16x16x32_bf16 v[36:39], v[120:123], v[100:103], v[36:39]
    v_mfma_f32_16x16x32_bf16 v[40:43], v[120:123], v[104:107], v[40:43]
    v_mfma_f32_16x16x32_bf16 v[44:47], v[120:123], v[108:111], v[44:47]
    v_mfma_f32_16x16x32_bf16 v[60:63], v[124:127], v[108:111], v[60:63]
    v_mfma_f32_16x16x32_bf16 v[56:59], v[124:127], v[104:107], v[56:59]
    v_mfma_f32_16x16x32_bf16 v[52:55], v[124:127], v[100:103], v[52:55]
    v_mfma_f32_16x16x32_bf16 v[48:51], v[124:127], v[96:99], v[48:51]
    s_waitcnt lgkmcnt(0)
    v_mfma_f32_16x16x32_bf16 v[0:3], v[80:83], v[64:67], v[0:3]
    ds_read_b128 v[96:99], v131 offset:0
    v_mfma_f32_16x16x32_bf16 v[4:7], v[80:83], v[68:71], v[4:7]
    ds_read_b64_tr_b16 v[112:113], v136 offset:8192
    ds_read_b64_tr_b16 v[114:115], v136 offset:9216
    v_mfma_f32_16x16x32_bf16 v[8:11], v[80:83], v[72:75], v[8:11]
    ds_read_b128 v[100:103], v131 offset:2048
    v_mfma_f32_16x16x32_bf16 v[12:15], v[80:83], v[76:79], v[12:15]
    ds_read_b64_tr_b16 v[116:117], v137 offset:8192
    ds_read_b64_tr_b16 v[118:119], v137 offset:9216
    v_mfma_f32_16x16x32_bf16 v[28:31], v[84:87], v[76:79], v[28:31]
    ds_read_b128 v[104:107], v131 offset:4096
    v_mfma_f32_16x16x32_bf16 v[24:27], v[84:87], v[72:75], v[24:27]
    ds_read_b64_tr_b16 v[120:121], v138 offset:8192
    ds_read_b64_tr_b16 v[122:123], v138 offset:9216
    v_mfma_f32_16x16x32_bf16 v[20:23], v[84:87], v[68:71], v[20:23]
    ds_read_b128 v[108:111], v131 offset:6144
    v_mfma_f32_16x16x32_bf16 v[16:19], v[84:87], v[64:67], v[16:19]
    ds_read_b64_tr_b16 v[124:125], v139 offset:8192
    ds_read_b64_tr_b16 v[126:127], v139 offset:9216
    v_mfma_f32_16x16x32_bf16 v[32:35], v[88:91], v[64:67], v[32:35]
    v_mfma_f32_16x16x32_bf16 v[36:39], v[88:91], v[68:71], v[36:39]
    v_mfma_f32_16x16x32_bf16 v[40:43], v[88:91], v[72:75], v[40:43]
    v_mfma_f32_16x16x32_bf16 v[44:47], v[88:91], v[76:79], v[44:47]
    v_mfma_f32_16x16x32_bf16 v[60:63], v[92:95], v[76:79], v[60:63]
    v_mfma_f32_16x16x32_bf16 v[56:59], v[92:95], v[72:75], v[56:59]
    v_mfma_f32_16x16x32_bf16 v[52:55], v[92:95], v[68:71], v[52:55]
    v_mfma_f32_16x16x32_bf16 v[48:51], v[92:95], v[64:67], v[48:51]
    s_waitcnt lgkmcnt(0)
    s_barrier
    v_mfma_f32_16x16x32_bf16 v[0:3], v[112:115], v[96:99], v[0:3]
    v_mfma_f32_16x16x32_bf16 v[4:7], v[112:115], v[100:103], v[4:7]
    v_mfma_f32_16x16x32_bf16 v[8:11], v[112:115], v[104:107], v[8:11]
    v_mfma_f32_16x16x32_bf16 v[12:15], v[112:115], v[108:111], v[12:15]
    v_mfma_f32_16x16x32_bf16 v[28:31], v[116:119], v[108:111], v[28:31]
    v_mfma_f32_16x16x32_bf16 v[24:27], v[116:119], v[104:107], v[24:27]
    v_mfma_f32_16x16x32_bf16 v[20:23], v[116:119], v[100:103], v[20:23]
    v_mfma_f32_16x16x32_bf16 v[16:19], v[116:119], v[96:99], v[16:19]
    s_cmp_ge_u32 s65, 5
    s_cbranch_scc1 L_noscale
    v_mfma_f32_16x16x32_bf16 v[32:35], v[120:123], v[96:99], v[32:35]
    s_nop 1
    v_mfma_f32_16x16x32_bf16 v[36:39], v[120:123], v[100:103], v[36:39]
    s_nop 1
    v_mfma_f32_16x16x32_bf16 v[40:43], v[120:123], v[104:107], v[40:43]
    s_nop 1
    v_mfma_f32_16x16x32_bf16 v[44:47], v[120:123], v[108:111], v[44:47]
    v_mul_f32 v0, s80, v0
    v_mul_f32 v1, s80, v1
    v_mfma_f32_16x16x32_bf16 v[60:63], v[124:127], v[108:111], v[60:63]
    v_mul_f32 v2, s80, v2
    v_mul_f32 v3, s80, v3
    v_mfma_f32_16x16x32_bf16 v[56:59], v[124:127], v[104:107], v[56:59]
    v_cvt_pk_bf16_f32 v152, v0, v1
    v_cvt_pk_bf16_f32 v153, v2, v3
    v_mfma_f32_16x16x32_bf16 v[52:55], v[124:127], v[100:103], v[52:55]
    v_mul_f32 v16, s80, v16
    v_mul_f32 v17, s80, v17
    v_mfma_f32_16x16x32_bf16 v[48:51], v[124:127], v[96:99], v[48:51]
    v_mul_f32 v18, s80, v18
    v_mul_f32 v19, s80, v19
    v_cvt_pk_bf16_f32 v154, v16, v17
    v_cvt_pk_bf16_f32 v155, v18, v19
    v_mul_f32 v8, s80, v8
    v_mul_f32 v9, s80, v9
    v_mul_f32 v10, s80, v10
    v_mul_f32 v11, s80, v11
    v_cvt_pk_bf16_f32 v156, v8, v9
    v_cvt_pk_bf16_f32 v157, v10, v11
    v_mul_f32 v24, s80, v24
    v_mul_f32 v25, s80, v25
    v_mul_f32 v26, s80, v26
    v_mul_f32 v27, s80, v27
    v_cvt_pk_bf16_f32 v158, v24, v25
    v_cvt_pk_bf16_f32 v159, v26, v27
    s_mov_b64 exec, s[20:21]
    v_swap_b32 v154, v156
    v_swap_b32 v155, v157
    s_mov_b64 exec, -1
    buffer_store_dwordx4 v[152:155], v140, s[44:47], s77 offen offset:0 sc1
    buffer_store_dwordx4 v[156:159], v140, s[44:47], s77 offen offset:512 sc1
    v_mul_f32 v4, s80, v4
    v_mul_f32 v5, s80, v5
    v_mul_f32 v6, s80, v6
    v_mul_f32 v7, s80, v7
    v_cvt_pk_bf16_f32 v160, v4, v5
    v_cvt_pk_bf16_f32 v161, v6, v7
    v_mul_f32 v20, s80, v20
    v_mul_f32 v21, s80, v21
    v_mul_f32 v22, s80, v22
    v_mul_f32 v23, s80, v23
    v_cvt_pk_bf16_f32 v162, v20, v21
    v_cvt_pk_bf16_f32 v163, v22, v23
    v_mul_f32 v12, s80, v12
    v_mul_f32 v13, s80, v13
    v_mul_f32 v14, s80, v14
    v_mul_f32 v15, s80, v15
    v_cvt_pk_bf16_f32 v164, v12, v13
    v_cvt_pk_bf16_f32 v165, v14, v15
    v_mul_f32 v28, s80, v28
    v_mul_f32 v29, s80, v29
    v_mul_f32 v30, s80, v30
    v_mul_f32 v31, s80, v31
    v_cvt_pk_bf16_f32 v166, v28, v29
    v_cvt_pk_bf16_f32 v167, v30, v31
    s_mov_b64 exec, s[20:21]
    v_swap_b32 v162, v164
    v_swap_b32 v163, v165
    s_mov_b64 exec, -1
    buffer_store_dwordx4 v[160:163], v140, s[44:47], s77 offen offset:256 sc1
    buffer_store_dwordx4 v[164:167], v140, s[44:47], s77 offen offset:768 sc1
    s_mov_b32 s81, s80
    v_pk_mul_f32 v[32:33], v[32:33], s[80:81]
    v_pk_mul_f32 v[34:35], v[34:35], s[80:81]
    v_pk_mul_f32 v[36:37], v[36:37], s[80:81]
    v_pk_mul_f32 v[38:39], v[38:39], s[80:81]
    v_pk_mul_f32 v[40:41], v[40:41], s[80:81]
    v_pk_mul_f32 v[42:43], v[42:43], s[80:81]
    v_pk_mul_f32 v[44:45], v[44:45], s[80:81]
    v_pk_mul_f32 v[46:47], v[46:47], s[80:81]
    v_pk_mul_f32 v[48:49], v[48:49], s[80:81]
    v_pk_mul_f32 v[50:51], v[50:51], s[80:81]
    v_pk_mul_f32 v[52:53], v[52:53], s[80:81]
    v_pk_mul_f32 v[54:55], v[54:55], s[80:81]
    v_pk_mul_f32 v[56:57], v[56:57], s[80:81]
    v_pk_mul_f32 v[58:59], v[58:59], s[80:81]
    v_pk_mul_f32 v[60:61], v[60:61], s[80:81]
    v_pk_mul_f32 v[62:63], v[62:63], s[80:81]
    s_branch L_qk2
L_noscale:
    v_mfma_f32_16x16x32_bf16 v[32:35], v[120:123], v[96:99], v[32:35]
    s_nop 1
    v_mfma_f32_16x16x32_bf16 v[36:39], v[120:123], v[100:103], v[36:39]
    s_nop 1
    v_mfma_f32_16x16x32_bf16 v[40:43], v[120:123], v[104:107], v[40:43]
    s_nop 1
    v_mfma_f32_16x16x32_bf16 v[44:47], v[120:123], v[108:111], v[44:47]
    v_cvt_pk_bf16_f32 v152, v0, v1
    v_cvt_pk_bf16_f32 v153, v2, v3
    v_mfma_f32_16x16x32_bf16 v[60:63], v[124:127], v[108:111], v[60:63]
    v_cvt_pk_bf16_f32 v154, v16, v17
    v_cvt_pk_bf16_f32 v155, v18, v19
    v_mfma_f32_16x16x32_bf16 v[56:59], v[124:127], v[104:107], v[56:59]
    v_cvt_pk_bf16_f32 v156, v8, v9
    v_cvt_pk_bf16_f32 v157, v10, v11
    v_mfma_f32_16x16x32_bf16 v[52:55], v[124:127], v[100:103], v[52:55]
    v_cvt_pk_bf16_f32 v158, v24, v25
    v_cvt_pk_bf16_f32 v159, v26, v27
    v_mfma_f32_16x16x32_bf16 v[48:51], v[124:127], v[96:99], v[48:51]
    s_mov_b64 exec, s[20:21]
    v_swap_b32 v154, v156
    v_swap_b32 v155, v157
    s_mov_b64 exec, -1
    buffer_store_dwordx4 v[152:155], v140, s[44:47], s77 offen offset:0 sc1
    buffer_store_dwordx4 v[156:159], v140, s[44:47], s77 offen offset:512 sc1
    v_cvt_pk_bf16_f32 v160, v4, v5
    v_cvt_pk_bf16_f32 v161, v6, v7
    v_cvt_pk_bf16_f32 v162, v20, v21
    v_cvt_pk_bf16_f32 v163, v22, v23
    v_cvt_pk_bf16_f32 v164, v12, v13
    v_cvt_pk_bf16_f32 v165, v14, v15
    v_cvt_pk_bf16_f32 v166, v28, v29
    v_cvt_pk_bf16_f32 v167, v30, v31
    s_mov_b64 exec, s[20:21]
    v_swap_b32 v162, v164
    v_swap_b32 v163, v165
    s_mov_b64 exec, -1
    buffer_store_dwordx4 v[160:163], v140, s[44:47], s77 offen offset:256 sc1
    buffer_store_dwordx4 v[164:167], v140, s[44:47], s77 offen offset:768 sc1
L_qk2:
    v_cvt_pk_bf16_f32 v168, v32, v33
    v_cvt_pk_bf16_f32 v169, v34, v35
    v_cvt_pk_bf16_f32 v170, v48, v49
    v_cvt_pk_bf16_f32 v171, v50, v51
    v_cvt_pk_bf16_f32 v172, v40, v41
    v_cvt_pk_bf16_f32 v173, v42, v43
    v_cvt_pk_bf16_f32 v174, v56, v57
    v_cvt_pk_bf16_f32 v175, v58, v59
    s_mov_b64 exec, s[22:23]
    v_swap_b32 v170, v172
    v_swap_b32 v171, v173
    s_mov_b64 exec, -1
    buffer_store_dwordx4 v[168:171], v140, s[44:47], s78 offen offset:0 sc1
    buffer_store_dwordx4 v[172:175], v140, s[44:47], s78 offen offset:512 sc1
    v_cvt_pk_bf16_f32 v176, v36, v37
    v_cvt_pk_bf16_f32 v177, v38, v39
    v_cvt_pk_bf16_f32 v178, v52, v53
    v_cvt_pk_bf16_f32 v179, v54, v55
    v_cvt_pk_bf16_f32 v180, v44, v45
    v_cvt_pk_bf16_f32 v181, v46, v47
    v_cvt_pk_bf16_f32 v182, v60, v61
    v_cvt_pk_bf16_f32 v183, v62, v63
    s_mov_b64 exec, s[22:23]
    v_swap_b32 v178, v180
    v_swap_b32 v179, v181
    s_mov_b64 exec, -1
    buffer_store_dwordx4 v[176:179], v140, s[44:47], s78 offen offset:256 sc1
    buffer_store_dwordx4 v[180:183], v140, s[44:47], s78 offen offset:768 sc1
    s_branch L_qdone
.p2align 6
.fill 544, 4, 0xbf810000
L_qV:
    s_cmp_eq_u32 s65, 15
    s_cbranch_scc0 L_qV2
    s_lshl_b32 s76, s64, 4
    v_mov_b32 v16, s76
    v_mov_b32 v17, 1
    s_waitcnt vmcnt(0)
    s_barrier
    s_cmp_eq_u32 s34, 0
    s_cbranch_scc0 L_nosig
    s_mov_b64 exec, 1
    global_store_dword v16, v17, s[30:31] sc1
    s_mov_b64 exec, -1
L_nosig:
    s_barrier
    s_and_b32 s76, s35, 1
    s_lshl1_add_u32 s76, s76, s73
    s_and_b32 s77, s3, 1
    s_lshl2_add_u32 s76, s77, s76
    s_mul_i32 s76, s76, 102400
    v_min_u32 v1, 39, v254
    v_mul_u32_u24 v1, 1280, v1
    v_add_u32 v2, 51200, v1
    s_and_b32 s77, s35, 1
    s_lshl1_add_u32 s77, s77, s73
    s_lshl1_add_u32 s77, s77, 0
    s_mul_i32 s77, s77, 5
    s_lshr_b32 s77, s77, 2
    s_add_u32 s78, s3, 1
    s_lshr_b32 s78, s78, 1
    s_add_u32 s80, s77, s78
    s_and_b32 s77, s35, 1
    s_lshl1_add_u32 s77, s77, s73
    s_lshl1_add_u32 s77, s77, 1
    s_mul_i32 s77, s77, 5
    s_lshr_b32 s77, s77, 2
    s_add_u32 s78, s3, 1
    s_lshr_b32 s78, s78, 1
    s_add_u32 s81, s77, s78
    s_add_u32 s77, s80, 4
    s_cmp_ge_u32 s77, 10
    s_cselect_b32 s78, 10, 0
    s_sub_u32 s77, s77, s78
    s_cmp_ge_u32 s77, 10
    s_cselect_b32 s78, 10, 0
    s_sub_u32 s77, s77, s78
    s_lshl_b32 s77, s77, 7
    s_add_u32 s77, s77, s76
    buffer_load_dword v111, v1, s[60:63], s77 offen
    s_add_u32 s77, s81, 4
    s_cmp_ge_u32 s77, 10
    s_cselect_b32 s78, 10, 0
    s_sub_u32 s77, s77, s78
    s_cmp_ge_u32 s77, 10
    s_cselect_b32 s78, 10, 0
    s_sub_u32 s77, s77, s78
    s_lshl_b32 s77, s77, 7
    s_add_u32 s77, s77, s76
    buffer_load_dword v111, v2, s[60:63], s77 offen
    s_add_u32 s77, s80, 9
    s_cmp_ge_u32 s77, 10
    s_cselect_b32 s78, 10, 0
    s_sub_u32 s77, s77, s78
    s_cmp_ge_u32 s77, 10
    s_cselect_b32 s78, 10, 0
    s_sub_u32 s77, s77, s78
    s_lshl_b32 s77, s77, 7
    s_add_u32 s77, s77, s76
    buffer_load_dword v111, v1, s[60:63], s77 offen
    s_add_u32 s77, s81, 9
    s_cmp_ge_u32 s77, 10
    s_cselect_b32 s78, 10, 0
    s_sub_u32 s77, s77, s78
    s_cmp_ge_u32 s77, 10
    s_cselect_b32 s78, 10, 0
    s_sub_u32 s77, s77, s78
    s_lshl_b32 s77, s77, 7
    s_add_u32 s77, s77, s76
    buffer_load_dword v111, v2, s[60:63], s77 offen
    s_barrier
    s_barrier
    s_barrier
    s_barrier
    s_barrier
    s_barrier
    s_barrier
    s_barrier
    s_barrier
    s_branch L_qdone
L_qV2:
    v_bfe_u32 v1, v254, 1, 1
    v_lshlrev_b32 v1, 4, v1
    v_xor_b32 v132, v1, v132
    v_xor_b32 v133, 32, v132
    v_xor_b32 v134, 64, v132
    v_xor_b32 v135, 96, v132
    v_add_u32 v136, 0x10000, v132
    v_add_u32 v137, 0x10000, v133
    v_add_u32 v138, 0x10000, v134
    v_add_u32 v139, 0x10000, v135
    s_lshl1_add_u32 s76, s65, s73
    v_and_b32 v1, 15, v254
    v_lshrrev_b32 v2, 4, v254
    v_mul_u32_u24 v2, 10368, v2
    v_lshl_add_u32 v140, v1, 4, v2
    s_sub_u32 s76, s76, 20
    s_lshl_b32 s76, s76, 10
    s_add_u32 s76, s76, s74
    s_add_u32 s76, s76, 164864
    s_add_u32 s77, s76, 41472
    s_barrier
    ds_read_b128 v[64:67], v128 offset:32768
    ds_read_b64_tr_b16 v[80:81], v132 offset:32768
    ds_read_b64_tr_b16 v[82:83], v132 offset:33792
    ds_read_b128 v[68:71], v128 offset:34816
    ds_read_b64_tr_b16 v[84:85], v133 offset:32768
    ds_read_b64_tr_b16 v[86:87], v133 offset:33792
    ds_read_b128 v[72:75], v128 offset:36864
    ds_read_b64_tr_b16 v[88:89], v134 offset:32768
    ds_read_b64_tr_b16 v[90:91], v134 offset:33792
    ds_read_b128 v[76:79], v128 offset:38912
    ds_read_b64_tr_b16 v[92:93], v135 offset:32768
    ds_read_b64_tr_b16 v[94:95], v135 offset:33792
    s_waitcnt lgkmcnt(0)
    v_mfma_f32_16x16x32_bf16 v[0:3], v[64:67], v[80:83], 0
    ds_read_b128 v[96:99], v129 offset:32768
    v_mfma_f32_16x16x32_bf16 v[4:7], v[64:67], v[84:87], 0
    ds_read_b64_tr_b16 v[112:113], v132 offset:40960
    ds_read_b64_tr_b16 v[114:115], v132 offset:41984
    v_mfma_f32_16x16x32_bf16 v[8:11], v[64:67], v[88:91], 0
    ds_read_b128 v[100:103], v129 offset:34816
    v_mfma_f32_16x16x32_bf16 v[12:15], v[64:67], v[92:95], 0
    ds_read_b64_tr_b16 v[116:117], v133 offset:40960
    ds_read_b64_tr_b16 v[118:119], v133 offset:41984
    v_mfma_f32_16x16x32_bf16 v[28:31], v[68:71], v[92:95], 0
    ds_read_b128 v[104:107], v129 offset:36864
    v_mfma_f32_16x16x32_bf16 v[24:27], v[68:71], v[88:91], 0
    ds_read_b64_tr_b16 v[120:121], v134 offset:40960
    ds_read_b64_tr_b16 v[122:123], v134 offset:41984
    v_mfma_f32_16x16x32_bf16 v[20:23], v[68:71], v[84:87], 0
    ds_read_b128 v[108:111], v129 offset:38912
    v_mfma_f32_16x16x32_bf16 v[16:19], v[68:71], v[80:83], 0
    ds_read_b64_tr_b16 v[124:125], v135 offset:40960
    ds_read_b64_tr_b16 v[126:127], v135 offset:41984
    v_mfma_f32_16x16x32_bf16 v[32:35], v[72:75], v[80:83], 0
    v_mfma_f32_16x16x32_bf16 v[36:39], v[72:75], v[84:87], 0
    v_mfma_f32_16x16x32_bf16 v[40:43], v[72:75], v[88:91], 0
    v_mfma_f32_16x16x32_bf16 v[44:47], v[72:75], v[92:95], 0
    v_mfma_f32_16x16x32_bf16 v[60:63], v[76:79], v[92:95], 0
    v_mfma_f32_16x16x32_bf16 v[56:59], v[76:79], v[88:91], 0
    v_mfma_f32_16x16x32_bf16 v[52:55], v[76:79], v[84:87], 0
    v_mfma_f32_16x16x32_bf16 v[48:51], v[76:79], v[80:83], 0
    s_waitcnt lgkmcnt(0)
    s_barrier
    v_mfma_f32_16x16x32_bf16 v[0:3], v[96:99], v[112:115], v[0:3]
    ds_read_b128 v[64:67], v130 offset:0
    v_mfma_f32_16x16x32_bf16 v[4:7], v[96:99], v[116:119], v[4:7]
    ds_read_b64_tr_b16 v[80:81], v136 offset:0
    ds_read_b64_tr_b16 v[82:83], v136 offset:1024
    v_mfma_f32_16x16x32_bf16 v[8:11], v[96:99], v[120:123], v[8:11]
    ds_read_b128 v[68:71], v130 offset:2048
    v_mfma_f32_16x16x32_bf16 v[12:15], v[96:99], v[124:127], v[12:15]
    ds_read_b64_tr_b16 v[84:85], v137 offset:0
    ds_read_b64_tr_b16 v[86:87], v137 offset:1024
    v_mfma_f32_16x16x32_bf16 v[28:31], v[100:103], v[124:127], v[28:31]
    ds_read_b128 v[72:75], v130 offset:4096
    v_mfma_f32_16x16x32_bf16 v[24:27], v[100:103], v[120:123], v[24:27]
    ds_read_b64_tr_b16 v[88:89], v138 offset:0
    ds_read_b64_tr_b16 v[90:91], v138 offset:1024
    v_mfma_f32_16x16x32_bf16 v[20:23], v[100:103], v[116:119], v[20:23]
    ds_read_b128 v[76:79], v130 offset:6144
    v_mfma_f32_16x16x32_bf16 v[16:19], v[100:103], v[112:115], v[16:19]
    ds_read_b64_tr_b16 v[92:93], v139 offset:0
    ds_read_b64_tr_b16 v[94:95], v139 offset:1024
    v_mfma_f32_16x16x32_bf16 v[32:35], v[104:107], v[112:115], v[32:35]
    v_mfma_f32_16x16x32_bf16 v[36:39], v[104:107], v[116:119], v[36:39]
    v_mfma_f32_16x16x32_bf16 v[40:43], v[104:107], v[120:123], v[40:43]
    v_mfma_f32_16x16x32_bf16 v[44:47], v[104:107], v[124:127], v[44:47]
    v_mfma_f32_16x16x32_bf16 v[60:63], v[108:111], v[124:127], v[60:63]
    v_mfma_f32_16x16x32_bf16 v[56:59], v[108:111], v[120:123], v[56:59]
    v_mfma_f32_16x16x32_bf16 v[52:55], v[108:111], v[116:119], v[52:55]
    v_mfma_f32_16x16x32_bf16 v[48:51], v[108:111], v[112:115], v[48:51]
    s_waitcnt lgkmcnt(0)
    v_mfma_f32_16x16x32_bf16 v[0:3], v[64:67], v[80:83], v[0:3]
    ds_read_b128 v[96:99], v131 offset:0
    v_mfma_f32_16x16x32_bf16 v[4:7], v[64:67], v[84:87], v[4:7]
    ds_read_b64_tr_b16 v[112:113], v136 offset:8192
    ds_read_b64_tr_b16 v[114:115], v136 offset:9216
    v_mfma_f32_16x16x32_bf16 v[8:11], v[64:67], v[88:91], v[8:11]
    ds_read_b128 v[100:103], v131 offset:2048
    v_mfma_f32_16x16x32_bf16 v[12:15], v[64:67], v[92:95], v[12:15]
    ds_read_b64_tr_b16 v[116:117], v137 offset:8192
    ds_read_b64_tr_b16 v[118:119], v137 offset:9216
    v_mfma_f32_16x16x32_bf16 v[28:31], v[68:71], v[92:95], v[28:31]
    ds_read_b128 v[104:107], v131 offset:4096
    v_mfma_f32_16x16x32_bf16 v[24:27], v[68:71], v[88:91], v[24:27]
    ds_read_b64_tr_b16 v[120:121], v138 offset:8192
    ds_read_b64_tr_b16 v[122:123], v138 offset:9216
    v_mfma_f32_16x16x32_bf16 v[20:23], v[68:71], v[84:87], v[20:23]
    ds_read_b128 v[108:111], v131 offset:6144
    v_mfma_f32_16x16x32_bf16 v[16:19], v[68:71], v[80:83], v[16:19]
    ds_read_b64_tr_b16 v[124:125], v139 offset:8192
    ds_read_b64_tr_b16 v[126:127], v139 offset:9216
    v_mfma_f32_16x16x32_bf16 v[32:35], v[72:75], v[80:83], v[32:35]
    v_mfma_f32_16x16x32_bf16 v[36:39], v[72:75], v[84:87], v[36:39]
    v_mfma_f32_16x16x32_bf16 v[40:43], v[72:75], v[88:91], v[40:43]
    v_mfma_f32_16x16x32_bf16 v[44:47], v[72:75], v[92:95], v[44:47]
    v_mfma_f32_16x16x32_bf16 v[60:63], v[76:79], v[92:95], v[60:63]
    v_mfma_f32_16x16x32_bf16 v[56:59], v[76:79], v[88:91], v[56:59]
    v_mfma_f32_16x16x32_bf16 v[52:55], v[76:79], v[84:87], v[52:55]
    v_mfma_f32_16x16x32_bf16 v[48:51], v[76:79], v[80:83], v[48:51]
    s_waitcnt lgkmcnt(0)
    s_barrier
    v_mfma_f32_16x16x32_bf16 v[0:3], v[96:99], v[112:115], v[0:3]
    ds_read_b128 v[64:67], v130 offset:32768
    v_mfma_f32_16x16x32_bf16 v[4:7], v[96:99], v[116:119], v[4:7]
    ds_read_b64_tr_b16 v[80:81], v136 offset:32768
    ds_read_b64_tr_b16 v[82:83], v136 offset:33792
    v_mfma_f32_16x16x32_bf16 v[8:11], v[96:99], v[120:123], v[8:11]
    ds_read_b128 v[68:71], v130 offset:34816
    v_mfma_f32_16x16x32_bf16 v[12:15], v[96:99], v[124:127], v[12:15]
    ds_read_b64_tr_b16 v[84:85], v137 offset:32768
    ds_read_b64_tr_b16 v[86:87], v137 offset:33792
    v_mfma_f32_16x16x32_bf16 v[28:31], v[100:103], v[124:127], v[28:31]
    ds_read_b128 v[72:75], v130 offset:36864
    v_mfma_f32_16x16x32_bf16 v[24:27], v[100:103], v[120:123], v[24:27]
    ds_read_b64_tr_b16 v[88:89], v138 offset:32768
    ds_read_b64_tr_b16 v[90:91], v138 offset:33792
    v_mfma_f32_16x16x32_bf16 v[20:23], v[100:103], v[116:119], v[20:23]
    ds_read_b128 v[76:79], v130 offset:38912
    v_mfma_f32_16x16x32_bf16 v[16:19], v[100:103], v[112:115], v[16:19]
    ds_read_b64_tr_b16 v[92:93], v139 offset:32768
    ds_read_b64_tr_b16 v[94:95], v139 offset:33792
    v_mfma_f32_16x16x32_bf16 v[32:35], v[104:107], v[112:115], v[32:35]
    v_mfma_f32_16x16x32_bf16 v[36:39], v[104:107], v[116:119], v[36:39]
    v_mfma_f32_16x16x32_bf16 v[40:43], v[104:107], v[120:123], v[40:43]
    v_mfma_f32_16x16x32_bf16 v[44:47], v[104:107], v[124:127], v[44:47]
    v_mfma_f32_16x16x32_bf16 v[60:63], v[108:111], v[124:127], v[60:63]
    v_mfma_f32_16x16x32_bf16 v[56:59], v[108:111], v[120:123], v[56:59]
    v_mfma_f32_16x16x32_bf16 v[52:55], v[108:111], v[116:119], v[52:55]
    v_mfma_f32_16x16x32_bf16 v[48:51], v[108:111], v[112:115], v[48:51]
    s_waitcnt lgkmcnt(0)
    v_mfma_f32_16x16x32_bf16 v[0:3], v[64:67], v[80:83], v[0:3]
    ds_read_b128 v[96:99], v131 offset:32768
    v_mfma_f32_16x16x32_bf16 v[4:7], v[64:67], v[84:87], v[4:7]
    ds_read_b64_tr_b16 v[112:113], v136 offset:40960
    ds_read_b64_tr_b16 v[114:115], v136 offset:41984
    v_mfma_f32_16x16x32_bf16 v[8:11], v[64:67], v[88:91], v[8:11]
    ds_read_b128 v[100:103], v131 offset:34816
    v_mfma_f32_16x16x32_bf16 v[12:15], v[64:67], v[92:95], v[12:15]
    ds_read_b64_tr_b16 v[116:117], v137 offset:40960
    ds_read_b64_tr_b16 v[118:119], v137 offset:41984
    v_mfma_f32_16x16x32_bf16 v[28:31], v[68:71], v[92:95], v[28:31]
    ds_read_b128 v[104:107], v131 offset:36864
    v_mfma_f32_16x16x32_bf16 v[24:27], v[68:71], v[88:91], v[24:27]
    ds_read_b64_tr_b16 v[120:121], v138 offset:40960
    ds_read_b64_tr_b16 v[122:123], v138 offset:41984
    v_mfma_f32_16x16x32_bf16 v[20:23], v[68:71], v[84:87], v[20:23]
    ds_read_b128 v[108:111], v131 offset:38912
    v_mfma_f32_16x16x32_bf16 v[16:19], v[68:71], v[80:83], v[16:19]
    ds_read_b64_tr_b16 v[124:125], v139 offset:40960
    ds_read_b64_tr_b16 v[126:127], v139 offset:41984
    v_mfma_f32_16x16x32_bf16 v[32:35], v[72:75], v[80:83], v[32:35]
    v_mfma_f32_16x16x32_bf16 v[36:39], v[72:75], v[84:87], v[36:39]
    v_mfma_f32_16x16x32_bf16 v[40:43], v[72:75], v[88:91], v[40:43]
    v_mfma_f32_16x16x32_bf16 v[44:47], v[72:75], v[92:95], v[44:47]
    v_mfma_f32_16x16x32_bf16 v[60:63], v[76:79], v[92:95], v[60:63]
    v_mfma_f32_16x16x32_bf16 v[56:59], v[76:79], v[88:91], v[56:59]
    v_mfma_f32_16x16x32_bf16 v[52:55], v[76:79], v[84:87], v[52:55]
    v_mfma_f32_16x16x32_bf16 v[48:51], v[76:79], v[80:83], v[48:51]
    s_waitcnt lgkmcnt(0)
    s_barrier
    v_mfma_f32_16x16x32_bf16 v[0:3], v[96:99], v[112:115], v[0:3]
    ds_read_b128 v[64:67], v128 offset:0
    v_mfma_f32_16x16x32_bf16 v[4:7], v[96:99], v[116:119], v[4:7]
    ds_read_b64_tr_b16 v[80:81], v132 offset:0
    ds_read_b64_tr_b16 v[82:83], v132 offset:1024
    v_mfma_f32_16x16x32_bf16 v[8:11], v[96:99], v[120:123], v[8:11]
    ds_read_b128 v[68:71], v128 offset:2048
    v_mfma_f32_16x16x32_bf16 v[12:15], v[96:99], v[124:127], v[12:15]
    ds_read_b64_tr_b16 v[84:85], v133 offset:0
    ds_read_b64_tr_b16 v[86:87], v133 offset:1024
    v_mfma_f32_16x16x32_bf16 v[28:31], v[100:103], v[124:127], v[28:31]
    ds_read_b128 v[72:75], v128 offset:4096
    v_mfma_f32_16x16x32_bf16 v[24:27], v[100:103], v[120:123], v[24:27]
    ds_read_b64_tr_b16 v[88:89], v134 offset:0
    ds_read_b64_tr_b16 v[90:91], v134 offset:1024
    v_mfma_f32_16x16x32_bf16 v[20:23], v[100:103], v[116:119], v[20:23]
    ds_read_b128 v[76:79], v128 offset:6144
    v_mfma_f32_16x16x32_bf16 v[16:19], v[100:103], v[112:115], v[16:19]
    ds_read_b64_tr_b16 v[92:93], v135 offset:0
    ds_read_b64_tr_b16 v[94:95], v135 offset:1024
    v_mfma_f32_16x16x32_bf16 v[32:35], v[104:107], v[112:115], v[32:35]
    v_mfma_f32_16x16x32_bf16 v[36:39], v[104:107], v[116:119], v[36:39]
    v_mfma_f32_16x16x32_bf16 v[40:43], v[104:107], v[120:123], v[40:43]
    v_mfma_f32_16x16x32_bf16 v[44:47], v[104:107], v[124:127], v[44:47]
    v_mfma_f32_16x16x32_bf16 v[60:63], v[108:111], v[124:127], v[60:63]
    v_mfma_f32_16x16x32_bf16 v[56:59], v[108:111], v[120:123], v[56:59]
    v_mfma_f32_16x16x32_bf16 v[52:55], v[108:111], v[116:119], v[52:55]
    v_mfma_f32_16x16x32_bf16 v[48:51], v[108:111], v[112:115], v[48:51]
    s_waitcnt lgkmcnt(0)
    v_mfma_f32_16x16x32_bf16 v[0:3], v[64:67], v[80:83], v[0:3]
    ds_read_b128 v[96:99], v129 offset:0
    v_mfma_f32_16x16x32_bf16 v[4:7], v[64:67], v[84:87], v[4:7]
    ds_read_b64_tr_b16 v[112:113], v132 offset:8192
    ds_read_b64_tr_b16 v[114:115], v132 offset:9216
    v_mfma_f32_16x16x32_bf16 v[8:11], v[64:67], v[88:91], v[8:11]
    ds_read_b128 v[100:103], v129 offset:2048
    v_mfma_f32_16x16x32_bf16 v[12:15], v[64:67], v[92:95], v[12:15]
    ds_read_b64_tr_b16 v[116:117], v133 offset:8192
    ds_read_b64_tr_b16 v[118:119], v133 offset:9216
    v_mfma_f32_16x16x32_bf16 v[28:31], v[68:71], v[92:95], v[28:31]
    ds_read_b128 v[104:107], v129 offset:4096
    v_mfma_f32_16x16x32_bf16 v[24:27], v[68:71], v[88:91], v[24:27]
    ds_read_b64_tr_b16 v[120:121], v134 offset:8192
    ds_read_b64_tr_b16 v[122:123], v134 offset:9216
    v_mfma_f32_16x16x32_bf16 v[20:23], v[68:71], v[84:87], v[20:23]
    ds_read_b128 v[108:111], v129 offset:6144
    v_mfma_f32_16x16x32_bf16 v[16:19], v[68:71], v[80:83], v[16:19]
    ds_read_b64_tr_b16 v[124:125], v135 offset:8192
    ds_read_b64_tr_b16 v[126:127], v135 offset:9216
    v_mfma_f32_16x16x32_bf16 v[32:35], v[72:75], v[80:83], v[32:35]
    v_mfma_f32_16x16x32_bf16 v[36:39], v[72:75], v[84:87], v[36:39]
    v_mfma_f32_16x16x32_bf16 v[40:43], v[72:75], v[88:91], v[40:43]
    v_mfma_f32_16x16x32_bf16 v[44:47], v[72:75], v[92:95], v[44:47]
    v_mfma_f32_16x16x32_bf16 v[60:63], v[76:79], v[92:95], v[60:63]
    v_mfma_f32_16x16x32_bf16 v[56:59], v[76:79], v[88:91], v[56:59]
    v_mfma_f32_16x16x32_bf16 v[52:55], v[76:79], v[84:87], v[52:55]
    v_mfma_f32_16x16x32_bf16 v[48:51], v[76:79], v[80:83], v[48:51]
    s_waitcnt lgkmcnt(0)
    s_barrier
    v_mfma_f32_16x16x32_bf16 v[0:3], v[96:99], v[112:115], v[0:3]
    ds_read_b128 v[64:67], v128 offset:32768
    v_mfma_f32_16x16x32_bf16 v[4:7], v[96:99], v[116:119], v[4:7]
    ds_read_b64_tr_b16 v[80:81], v132 offset:32768
    ds_read_b64_tr_b16 v[82:83], v132 offset:33792
    v_mfma_f32_16x16x32_bf16 v[8:11], v[96:99], v[120:123], v[8:11]
    ds_read_b128 v[68:71], v128 offset:34816
    v_mfma_f32_16x16x32_bf16 v[12:15], v[96:99], v[124:127], v[12:15]
    ds_read_b64_tr_b16 v[84:85], v133 offset:32768
    ds_read_b64_tr_b16 v[86:87], v133 offset:33792
    v_mfma_f32_16x16x32_bf16 v[28:31], v[100:103], v[124:127], v[28:31]
    ds_read_b128 v[72:75], v128 offset:36864
    v_mfma_f32_16x16x32_bf16 v[24:27], v[100:103], v[120:123], v[24:27]
    ds_read_b64_tr_b16 v[88:89], v134 offset:32768
    ds_read_b64_tr_b16 v[90:91], v134 offset:33792
    v_mfma_f32_16x16x32_bf16 v[20:23], v[100:103], v[116:119], v[20:23]
    ds_read_b128 v[76:79], v128 offset:38912
    v_mfma_f32_16x16x32_bf16 v[16:19], v[100:103], v[112:115], v[16:19]
    ds_read_b64_tr_b16 v[92:93], v135 offset:32768
    ds_read_b64_tr_b16 v[94:95], v135 offset:33792
    v_mfma_f32_16x16x32_bf16 v[32:35], v[104:107], v[112:115], v[32:35]
    v_mfma_f32_16x16x32_bf16 v[36:39], v[104:107], v[116:119], v[36:39]
    v_mfma_f32_16x16x32_bf16 v[40:43], v[104:107], v[120:123], v[40:43]
    v_mfma_f32_16x16x32_bf16 v[44:47], v[104:107], v[124:127], v[44:47]
    v_mfma_f32_16x16x32_bf16 v[60:63], v[108:111], v[124:127], v[60:63]
    v_mfma_f32_16x16x32_bf16 v[56:59], v[108:111], v[120:123], v[56:59]
    v_mfma_f32_16x16x32_bf16 v[52:55], v[108:111], v[116:119], v[52:55]
    v_mfma_f32_16x16x32_bf16 v[48:51], v[108:111], v[112:115], v[48:51]
    s_waitcnt lgkmcnt(0)
    v_mfma_f32_16x16x32_bf16 v[0:3], v[64:67], v[80:83], v[0:3]
    ds_read_b128 v[96:99], v129 offset:32768
    v_mfma_f32_16x16x32_bf16 v[4:7], v[64:67], v[84:87], v[4:7]
    ds_read_b64_tr_b16 v[112:113], v132 offset:40960
    ds_read_b64_tr_b16 v[114:115], v132 offset:41984
    v_mfma_f32_16x16x32_bf16 v[8:11], v[64:67], v[88:91], v[8:11]
    ds_read_b128 v[100:103], v129 offset:34816
    v_mfma_f32_16x16x32_bf16 v[12:15], v[64:67], v[92:95], v[12:15]
    ds_read_b64_tr_b16 v[116:117], v133 offset:40960
    ds_read_b64_tr_b16 v[118:119], v133 offset:41984
    v_mfma_f32_16x16x32_bf16 v[28:31], v[68:71], v[92:95], v[28:31]
    ds_read_b128 v[104:107], v129 offset:36864
    v_mfma_f32_16x16x32_bf16 v[24:27], v[68:71], v[88:91], v[24:27]
    ds_read_b64_tr_b16 v[120:121], v134 offset:40960
    ds_read_b64_tr_b16 v[122:123], v134 offset:41984
    v_mfma_f32_16x16x32_bf16 v[20:23], v[68:71], v[84:87], v[20:23]
    ds_read_b128 v[108:111], v129 offset:38912
    v_mfma_f32_16x16x32_bf16 v[16:19], v[68:71], v[80:83], v[16:19]
    ds_read_b64_tr_b16 v[124:125], v135 offset:40960
    ds_read_b64_tr_b16 v[126:127], v135 offset:41984
    v_mfma_f32_16x16x32_bf16 v[32:35], v[72:75], v[80:83], v[32:35]
    v_mfma_f32_16x16x32_bf16 v[36:39], v[72:75], v[84:87], v[36:39]
    v_mfma_f32_16x16x32_bf16 v[40:43], v[72:75], v[88:91], v[40:43]
    v_mfma_f32_16x16x32_bf16 v[44:47], v[72:75], v[92:95], v[44:47]
    v_mfma_f32_16x16x32_bf16 v[60:63], v[76:79], v[92:95], v[60:63]
    v_mfma_f32_16x16x32_bf16 v[56:59], v[76:79], v[88:91], v[56:59]
    v_mfma_f32_16x16x32_bf16 v[52:55], v[76:79], v[84:87], v[52:55]
    v_mfma_f32_16x16x32_bf16 v[48:51], v[76:79], v[80:83], v[48:51]
L_pgV:
    s_waitcnt lgkmcnt(0)
    s_barrier
    v_mfma_f32_16x16x32_bf16 v[0:3], v[96:99], v[112:115], v[0:3]
    ds_read_b128 v[64:67], v130 offset:0
    v_mfma_f32_16x16x32_bf16 v[4:7], v[96:99], v[116:119], v[4:7]
    ds_read_b64_tr_b16 v[80:81], v136 offset:0
    ds_read_b64_tr_b16 v[82:83], v136 offset:1024
    v_mfma_f32_16x16x32_bf16 v[8:11], v[96:99], v[120:123], v[8:11]
    ds_read_b128 v[68:71], v130 offset:2048
    v_mfma_f32_16x16x32_bf16 v[12:15], v[96:99], v[124:127], v[12:15]
    ds_read_b64_tr_b16 v[84:85], v137 offset:0
    ds_read_b64_tr_b16 v[86:87], v137 offset:1024
    v_mfma_f32_16x16x32_bf16 v[28:31], v[100:103], v[124:127], v[28:31]
    ds_read_b128 v[72:75], v130 offset:4096
    v_mfma_f32_16x16x32_bf16 v[24:27], v[100:103], v[120:123], v[24:27]
    ds_read_b64_tr_b16 v[88:89], v138 offset:0
    ds_read_b64_tr_b16 v[90:91], v138 offset:1024
    v_mfma_f32_16x16x32_bf16 v[20:23], v[100:103], v[116:119], v[20:23]
    ds_read_b128 v[76:79], v130 offset:6144
    v_mfma_f32_16x16x32_bf16 v[16:19], v[100:103], v[112:115], v[16:19]
    ds_read_b64_tr_b16 v[92:93], v139 offset:0
    ds_read_b64_tr_b16 v[94:95], v139 offset:1024
    v_mfma_f32_16x16x32_bf16 v[32:35], v[104:107], v[112:115], v[32:35]
    v_mfma_f32_16x16x32_bf16 v[36:39], v[104:107], v[116:119], v[36:39]
    v_mfma_f32_16x16x32_bf16 v[40:43], v[104:107], v[120:123], v[40:43]
    v_mfma_f32_16x16x32_bf16 v[44:47], v[104:107], v[124:127], v[44:47]
    v_mfma_f32_16x16x32_bf16 v[60:63], v[108:111], v[124:127], v[60:63]
    v_mfma_f32_16x16x32_bf16 v[56:59], v[108:111], v[120:123], v[56:59]
    v_mfma_f32_16x16x32_bf16 v[52:55], v[108:111], v[116:119], v[52:55]
    v_mfma_f32_16x16x32_bf16 v[48:51], v[108:111], v[112:115], v[48:51]
    s_waitcnt lgkmcnt(0)
    v_mfma_f32_16x16x32_bf16 v[0:3], v[64:67], v[80:83], v[0:3]
    ds_read_b128 v[96:99], v131 offset:0
    v_mfma_f32_16x16x32_bf16 v[4:7], v[64:67], v[84:87], v[4:7]
    ds_read_b64_tr_b16 v[112:113], v136 offset:8192
    ds_read_b64_tr_b16 v[114:115], v136 offset:9216
    v_mfma_f32_16x16x32_bf16 v[8:11], v[64:67], v[88:91], v[8:11]
    ds_read_b128 v[100:103], v131 offset:2048
    v_mfma_f32_16x16x32_bf16 v[12:15], v[64:67], v[92:95], v[12:15]
    ds_read_b64_tr_b16 v[116:117], v137 offset:8192
    ds_read_b64_tr_b16 v[118:119], v137 offset:9216
    v_mfma_f32_16x16x32_bf16 v[28:31], v[68:71], v[92:95], v[28:31]
    ds_read_b128 v[104:107], v131 offset:4096
    v_mfma_f32_16x16x32_bf16 v[24:27], v[68:71], v[88:91], v[24:27]
    ds_read_b64_tr_b16 v[120:121], v138 offset:8192
    ds_read_b64_tr_b16 v[122:123], v138 offset:9216
    v_mfma_f32_16x16x32_bf16 v[20:23], v[68:71], v[84:87], v[20:23]
    ds_read_b128 v[108:111], v131 offset:6144
    v_mfma_f32_16x16x32_bf16 v[16:19], v[68:71], v[80:83], v[16:19]
    ds_read_b64_tr_b16 v[124:125], v139 offset:8192
    ds_read_b64_tr_b16 v[126:127], v139 offset:9216
    v_mfma_f32_16x16x32_bf16 v[32:35], v[72:75], v[80:83], v[32:35]
    v_mfma_f32_16x16x32_bf16 v[36:39], v[72:75], v[84:87], v[36:39]
    v_mfma_f32_16x16x32_bf16 v[40:43], v[72:75], v[88:91], v[40:43]
    v_mfma_f32_16x16x32_bf16 v[44:47], v[72:75], v[92:95], v[44:47]
    v_mfma_f32_16x16x32_bf16 v[60:63], v[76:79], v[92:95], v[60:63]
    v_mfma_f32_16x16x32_bf16 v[56:59], v[76:79], v[88:91], v[56:59]
    v_mfma_f32_16x16x32_bf16 v[52:55], v[76:79], v[84:87], v[52:55]
    v_mfma_f32_16x16x32_bf16 v[48:51], v[76:79], v[80:83], v[48:51]
    s_waitcnt lgkmcnt(0)
    s_barrier
    v_mfma_f32_16x16x32_bf16 v[0:3], v[96:99], v[112:115], v[0:3]
    ds_read_b128 v[64:67], v130 offset:32768
    v_mfma_f32_16x16x32_bf16 v[4:7], v[96:99], v[116:119], v[4:7]
    ds_read_b64_tr_b16 v[80:81], v136 offset:32768
    ds_read_b64_tr_b16 v[82:83], v136 offset:33792
    v_mfma_f32_16x16x32_bf16 v[8:11], v[96:99], v[120:123], v[8:11]
    ds_read_b128 v[68:71], v130 offset:34816
    v_mfma_f32_16x16x32_bf16 v[12:15], v[96:99], v[124:127], v[12:15]
    ds_read_b64_tr_b16 v[84:85], v137 offset:32768
    ds_read_b64_tr_b16 v[86:87], v137 offset:33792
    v_mfma_f32_16x16x32_bf16 v[28:31], v[100:103], v[124:127], v[28:31]
    ds_read_b128 v[72:75], v130 offset:36864
    v_mfma_f32_16x16x32_bf16 v[24:27], v[100:103], v[120:123], v[24:27]
    ds_read_b64_tr_b16 v[88:89], v138 offset:32768
    ds_read_b64_tr_b16 v[90:91], v138 offset:33792
    v_mfma_f32_16x16x32_bf16 v[20:23], v[100:103], v[116:119], v[20:23]
    ds_read_b128 v[76:79], v130 offset:38912
    v_mfma_f32_16x16x32_bf16 v[16:19], v[100:103], v[112:115], v[16:19]
    ds_read_b64_tr_b16 v[92:93], v139 offset:32768
    ds_read_b64_tr_b16 v[94:95], v139 offset:33792
    v_mfma_f32_16x16x32_bf16 v[32:35], v[104:107], v[112:115], v[32:35]
    v_mfma_f32_16x16x32_bf16 v[36:39], v[104:107], v[116:119], v[36:39]
    v_mfma_f32_16x16x32_bf16 v[40:43], v[104:107], v[120:123], v[40:43]
    v_mfma_f32_16x16x32_bf16 v[44:47], v[104:107], v[124:127], v[44:47]
    v_mfma_f32_16x16x32_bf16 v[60:63], v[108:111], v[124:127], v[60:63]
    v_mfma_f32_16x16x32_bf16 v[56:59], v[108:111], v[120:123], v[56:59]
    v_mfma_f32_16x16x32_bf16 v[52:55], v[108:111], v[116:119], v[52:55]
    v_mfma_f32_16x16x32_bf16 v[48:51], v[108:111], v[112:115], v[48:51]
    s_waitcnt lgkmcnt(0)
    v_mfma_f32_16x16x32_bf16 v[0:3], v[64:67], v[80:83], v[0:3]
    ds_read_b128 v[96:99], v131 offset:32768
    v_mfma_f32_16x16x32_bf16 v[4:7], v[64:67], v[84:87], v[4:7]
    ds_read_b64_tr_b16 v[112:113], v136 offset:40960
    ds_read_b64_tr_b16 v[114:115], v136 offset:41984
    v_mfma_f32_16x16x32_bf16 v[8:11], v[64:67], v[88:91], v[8:11]
    ds_read_b128 v[100:103], v131 offset:34816
    v_mfma_f32_16x16x32_bf16 v[12:15], v[64:67], v[92:95], v[12:15]
    ds_read_b64_tr_b16 v[116:117], v137 offset:40960
    ds_read_b64_tr_b16 v[118:119], v137 offset:41984
    v_mfma_f32_16x16x32_bf16 v[28:31], v[68:71], v[92:95], v[28:31]
    ds_read_b128 v[104:107], v131 offset:36864
    v_mfma_f32_16x16x32_bf16 v[24:27], v[68:71], v[88:91], v[24:27]
    ds_read_b64_tr_b16 v[120:121], v138 offset:40960
    ds_read_b64_tr_b16 v[122:123], v138 offset:41984
    v_mfma_f32_16x16x32_bf16 v[20:23], v[68:71], v[84:87], v[20:23]
    ds_read_b128 v[108:111], v131 offset:38912
    v_mfma_f32_16x16x32_bf16 v[16:19], v[68:71], v[80:83], v[16:19]
    ds_read_b64_tr_b16 v[124:125], v139 offset:40960
    ds_read_b64_tr_b16 v[126:127], v139 offset:41984
    v_mfma_f32_16x16x32_bf16 v[32:35], v[72:75], v[80:83], v[32:35]
    v_mfma_f32_16x16x32_bf16 v[36:39], v[72:75], v[84:87], v[36:39]
    v_mfma_f32_16x16x32_bf16 v[40:43], v[72:75], v[88:91], v[40:43]
    v_mfma_f32_16x16x32_bf16 v[44:47], v[72:75], v[92:95], v[44:47]
    v_mfma_f32_16x16x32_bf16 v[60:63], v[76:79], v[92:95], v[60:63]
    v_mfma_f32_16x16x32_bf16 v[56:59], v[76:79], v[88:91], v[56:59]
    v_mfma_f32_16x16x32_bf16 v[52:55], v[76:79], v[84:87], v[52:55]
    v_mfma_f32_16x16x32_bf16 v[48:51], v[76:79], v[80:83], v[48:51]
    s_waitcnt lgkmcnt(0)
    s_barrier
    v_mfma_f32_16x16x32_bf16 v[0:3], v[96:99], v[112:115], v[0:3]
    ds_read_b128 v[64:67], v128 offset:0
    v_mfma_f32_16x16x32_bf16 v[4:7], v[96:99], v[116:119], v[4:7]
    ds_read_b64_tr_b16 v[80:81], v132 offset:0
    ds_read_b64_tr_b16 v[82:83], v132 offset:1024
    v_mfma_f32_16x16x32_bf16 v[8:11], v[96:99], v[120:123], v[8:11]
    ds_read_b128 v[68:71], v128 offset:2048
    v_mfma_f32_16x16x32_bf16 v[12:15], v[96:99], v[124:127], v[12:15]
    ds_read_b64_tr_b16 v[84:85], v133 offset:0
    ds_read_b64_tr_b16 v[86:87], v133 offset:1024
    v_mfma_f32_16x16x32_bf16 v[28:31], v[100:103], v[124:127], v[28:31]
    ds_read_b128 v[72:75], v128 offset:4096
    v_mfma_f32_16x16x32_bf16 v[24:27], v[100:103], v[120:123], v[24:27]
    ds_read_b64_tr_b16 v[88:89], v134 offset:0
    ds_read_b64_tr_b16 v[90:91], v134 offset:1024
    v_mfma_f32_16x16x32_bf16 v[20:23], v[100:103], v[116:119], v[20:23]
    ds_read_b128 v[76:79], v128 offset:6144
    v_mfma_f32_16x16x32_bf16 v[16:19], v[100:103], v[112:115], v[16:19]
    ds_read_b64_tr_b16 v[92:93], v135 offset:0
    ds_read_b64_tr_b16 v[94:95], v135 offset:1024
    v_mfma_f32_16x16x32_bf16 v[32:35], v[104:107], v[112:115], v[32:35]
    v_mfma_f32_16x16x32_bf16 v[36:39], v[104:107], v[116:119], v[36:39]
    v_mfma_f32_16x16x32_bf16 v[40:43], v[104:107], v[120:123], v[40:43]
    v_mfma_f32_16x16x32_bf16 v[44:47], v[104:107], v[124:127], v[44:47]
    v_mfma_f32_16x16x32_bf16 v[60:63], v[108:111], v[124:127], v[60:63]
    v_mfma_f32_16x16x32_bf16 v[56:59], v[108:111], v[120:123], v[56:59]
    v_mfma_f32_16x16x32_bf16 v[52:55], v[108:111], v[116:119], v[52:55]
    v_mfma_f32_16x16x32_bf16 v[48:51], v[108:111], v[112:115], v[48:51]
    s_waitcnt lgkmcnt(0)
    v_mfma_f32_16x16x32_bf16 v[0:3], v[64:67], v[80:83], v[0:3]
    ds_read_b128 v[96:99], v129 offset:0
    v_mfma_f32_16x16x32_bf16 v[4:7], v[64:67], v[84:87], v[4:7]
    ds_read_b64_tr_b16 v[112:113], v132 offset:8192
    ds_read_b64_tr_b16 v[114:115], v132 offset:9216
    v_mfma_f32_16x16x32_bf16 v[8:11], v[64:67], v[88:91], v[8:11]
    ds_read_b128 v[100:103], v129 offset:2048
    v_mfma_f32_16x16x32_bf16 v[12:15], v[64:67], v[92:95], v[12:15]
    ds_read_b64_tr_b16 v[116:117], v133 offset:8192
    ds_read_b64_tr_b16 v[118:119], v133 offset:9216
    v_mfma_f32_16x16x32_bf16 v[28:31], v[68:71], v[92:95], v[28:31]
    ds_read_b128 v[104:107], v129 offset:4096
    v_mfma_f32_16x16x32_bf16 v[24:27], v[68:71], v[88:91], v[24:27]
    ds_read_b64_tr_b16 v[120:121], v134 offset:8192
    ds_read_b64_tr_b16 v[122:123], v134 offset:9216
    v_mfma_f32_16x16x32_bf16 v[20:23], v[68:71], v[84:87], v[20:23]
    ds_read_b128 v[108:111], v129 offset:6144
    v_mfma_f32_16x16x32_bf16 v[16:19], v[68:71], v[80:83], v[16:19]
    ds_read_b64_tr_b16 v[124:125], v135 offset:8192
    ds_read_b64_tr_b16 v[126:127], v135 offset:9216
    v_mfma_f32_16x16x32_bf16 v[32:35], v[72:75], v[80:83], v[32:35]
    v_mfma_f32_16x16x32_bf16 v[36:39], v[72:75], v[84:87], v[36:39]
    v_mfma_f32_16x16x32_bf16 v[40:43], v[72:75], v[88:91], v[40:43]
    v_mfma_f32_16x16x32_bf16 v[44:47], v[72:75], v[92:95], v[44:47]
    v_mfma_f32_16x16x32_bf16 v[60:63], v[76:79], v[92:95], v[60:63]
    v_mfma_f32_16x16x32_bf16 v[56:59], v[76:79], v[88:91], v[56:59]
    v_mfma_f32_16x16x32_bf16 v[52:55], v[76:79], v[84:87], v[52:55]
    v_mfma_f32_16x16x32_bf16 v[48:51], v[76:79], v[80:83], v[48:51]
    s_waitcnt lgkmcnt(0)
    s_barrier
    v_mfma_f32_16x16x32_bf16 v[0:3], v[96:99], v[112:115], v[0:3]
    ds_read_b128 v[64:67], v128 offset:32768
    v_mfma_f32_16x16x32_bf16 v[4:7], v[96:99], v[116:119], v[4:7]
    ds_read_b64_tr_b16 v[80:81], v132 offset:32768
    ds_read_b64_tr_b16 v[82:83], v132 offset:33792
    v_mfma_f32_16x16x32_bf16 v[8:11], v[96:99], v[120:123], v[8:11]
    ds_read_b128 v[68:71], v128 offset:34816
    v_mfma_f32_16x16x32_bf16 v[12:15], v[96:99], v[124:127], v[12:15]
    ds_read_b64_tr_b16 v[84:85], v133 offset:32768
    ds_read_b64_tr_b16 v[86:87], v133 offset:33792
    v_mfma_f32_16x16x32_bf16 v[28:31], v[100:103], v[124:127], v[28:31]
    ds_read_b128 v[72:75], v128 offset:36864
    v_mfma_f32_16x16x32_bf16 v[24:27], v[100:103], v[120:123], v[24:27]
    ds_read_b64_tr_b16 v[88:89], v134 offset:32768
    ds_read_b64_tr_b16 v[90:91], v134 offset:33792
    v_mfma_f32_16x16x32_bf16 v[20:23], v[100:103], v[116:119], v[20:23]
    ds_read_b128 v[76:79], v128 offset:38912
    v_mfma_f32_16x16x32_bf16 v[16:19], v[100:103], v[112:115], v[16:19]
    ds_read_b64_tr_b16 v[92:93], v135 offset:32768
    ds_read_b64_tr_b16 v[94:95], v135 offset:33792
    v_mfma_f32_16x16x32_bf16 v[32:35], v[104:107], v[112:115], v[32:35]
    v_mfma_f32_16x16x32_bf16 v[36:39], v[104:107], v[116:119], v[36:39]
    v_mfma_f32_16x16x32_bf16 v[40:43], v[104:107], v[120:123], v[40:43]
    v_mfma_f32_16x16x32_bf16 v[44:47], v[104:107], v[124:127], v[44:47]
    v_mfma_f32_16x16x32_bf16 v[60:63], v[108:111], v[124:127], v[60:63]
    v_mfma_f32_16x16x32_bf16 v[56:59], v[108:111], v[120:123], v[56:59]
    v_mfma_f32_16x16x32_bf16 v[52:55], v[108:111], v[116:119], v[52:55]
    v_mfma_f32_16x16x32_bf16 v[48:51], v[108:111], v[112:115], v[48:51]
    s_waitcnt lgkmcnt(0)
    v_mfma_f32_16x16x32_bf16 v[0:3], v[64:67], v[80:83], v[0:3]
    ds_read_b128 v[96:99], v129 offset:32768
    v_mfma_f32_16x16x32_bf16 v[4:7], v[64:67], v[84:87], v[4:7]
    ds_read_b64_tr_b16 v[112:113], v132 offset:40960
    ds_read_b64_tr_b16 v[114:115], v132 offset:41984
    v_mfma_f32_16x16x32_bf16 v[8:11], v[64:67], v[88:91], v[8:11]
    ds_read_b128 v[100:103], v129 offset:34816
    v_mfma_f32_16x16x32_bf16 v[12:15], v[64:67], v[92:95], v[12:15]
    ds_read_b64_tr_b16 v[116:117], v133 offset:40960
    ds_read_b64_tr_b16 v[118:119], v133 offset:41984
    v_mfma_f32_16x16x32_bf16 v[28:31], v[68:71], v[92:95], v[28:31]
    ds_read_b128 v[104:107], v129 offset:36864
    v_mfma_f32_16x16x32_bf16 v[24:27], v[68:71], v[88:91], v[24:27]
    ds_read_b64_tr_b16 v[120:121], v134 offset:40960
    ds_read_b64_tr_b16 v[122:123], v134 offset:41984
    v_mfma_f32_16x16x32_bf16 v[20:23], v[68:71], v[84:87], v[20:23]
    ds_read_b128 v[108:111], v129 offset:38912
    v_mfma_f32_16x16x32_bf16 v[16:19], v[68:71], v[80:83], v[16:19]
    ds_read_b64_tr_b16 v[124:125], v135 offset:40960
    ds_read_b64_tr_b16 v[126:127], v135 offset:41984
    v_mfma_f32_16x16x32_bf16 v[32:35], v[72:75], v[80:83], v[32:35]
    v_mfma_f32_16x16x32_bf16 v[36:39], v[72:75], v[84:87], v[36:39]
    v_mfma_f32_16x16x32_bf16 v[40:43], v[72:75], v[88:91], v[40:43]
    v_mfma_f32_16x16x32_bf16 v[44:47], v[72:75], v[92:95], v[44:47]
    v_mfma_f32_16x16x32_bf16 v[60:63], v[76:79], v[92:95], v[60:63]
    v_mfma_f32_16x16x32_bf16 v[56:59], v[76:79], v[88:91], v[56:59]
    v_mfma_f32_16x16x32_bf16 v[52:55], v[76:79], v[84:87], v[52:55]
    v_mfma_f32_16x16x32_bf16 v[48:51], v[76:79], v[80:83], v[48:51]
    s_waitcnt lgkmcnt(0)
    s_barrier
    v_mfma_f32_16x16x32_bf16 v[0:3], v[96:99], v[112:115], v[0:3]
    ds_read_b128 v[64:67], v130 offset:0
    v_mfma_f32_16x16x32_bf16 v[4:7], v[96:99], v[116:119], v[4:7]
    ds_read_b64_tr_b16 v[80:81], v136 offset:0
    ds_read_b64_tr_b16 v[82:83], v136 offset:1024
    v_mfma_f32_16x16x32_bf16 v[8:11], v[96:99], v[120:123], v[8:11]
    ds_read_b128 v[68:71], v130 offset:2048
    v_mfma_f32_16x16x32_bf16 v[12:15], v[96:99], v[124:127], v[12:15]
    ds_read_b64_tr_b16 v[84:85], v137 offset:0
    ds_read_b64_tr_b16 v[86:87], v137 offset:1024
    v_mfma_f32_16x16x32_bf16 v[28:31], v[100:103], v[124:127], v[28:31]
    ds_read_b128 v[72:75], v130 offset:4096
    v_mfma_f32_16x16x32_bf16 v[24:27], v[100:103], v[120:123], v[24:27]
    ds_read_b64_tr_b16 v[88:89], v138 offset:0
    ds_read_b64_tr_b16 v[90:91], v138 offset:1024
    v_mfma_f32_16x16x32_bf16 v[20:23], v[100:103], v[116:119], v[20:23]
    ds_read_b128 v[76:79], v130 offset:6144
    v_mfma_f32_16x16x32_bf16 v[16:19], v[100:103], v[112:115], v[16:19]
    ds_read_b64_tr_b16 v[92:93], v139 offset:0
    ds_read_b64_tr_b16 v[94:95], v139 offset:1024
    v_mfma_f32_16x16x32_bf16 v[32:35], v[104:107], v[112:115], v[32:35]
    v_mfma_f32_16x16x32_bf16 v[36:39], v[104:107], v[116:119], v[36:39]
    v_mfma_f32_16x16x32_bf16 v[40:43], v[104:107], v[120:123], v[40:43]
    v_mfma_f32_16x16x32_bf16 v[44:47], v[104:107], v[124:127], v[44:47]
    v_mfma_f32_16x16x32_bf16 v[60:63], v[108:111], v[124:127], v[60:63]
    v_mfma_f32_16x16x32_bf16 v[56:59], v[108:111], v[120:123], v[56:59]
    v_mfma_f32_16x16x32_bf16 v[52:55], v[108:111], v[116:119], v[52:55]
    v_mfma_f32_16x16x32_bf16 v[48:51], v[108:111], v[112:115], v[48:51]
    s_waitcnt lgkmcnt(0)
    v_mfma_f32_16x16x32_bf16 v[0:3], v[64:67], v[80:83], v[0:3]
    ds_read_b128 v[96:99], v131 offset:0
    v_mfma_f32_16x16x32_bf16 v[4:7], v[64:67], v[84:87], v[4:7]
    ds_read_b64_tr_b16 v[112:113], v136 offset:8192
    ds_read_b64_tr_b16 v[114:115], v136 offset:9216
    v_mfma_f32_16x16x32_bf16 v[8:11], v[64:67], v[88:91], v[8:11]
    ds_read_b128 v[100:103], v131 offset:2048
    v_mfma_f32_16x16x32_bf16 v[12:15], v[64:67], v[92:95], v[12:15]
    ds_read_b64_tr_b16 v[116:117], v137 offset:8192
    ds_read_b64_tr_b16 v[118:119], v137 offset:9216
    v_mfma_f32_16x16x32_bf16 v[28:31], v[68:71], v[92:95], v[28:31]
    ds_read_b128 v[104:107], v131 offset:4096
    v_mfma_f32_16x16x32_bf16 v[24:27], v[68:71], v[88:91], v[24:27]
    ds_read_b64_tr_b16 v[120:121], v138 offset:8192
    ds_read_b64_tr_b16 v[122:123], v138 offset:9216
    v_mfma_f32_16x16x32_bf16 v[20:23], v[68:71], v[84:87], v[20:23]
    ds_read_b128 v[108:111], v131 offset:6144
    v_mfma_f32_16x16x32_bf16 v[16:19], v[68:71], v[80:83], v[16:19]
    ds_read_b64_tr_b16 v[124:125], v139 offset:8192
    ds_read_b64_tr_b16 v[126:127], v139 offset:9216
    v_mfma_f32_16x16x32_bf16 v[32:35], v[72:75], v[80:83], v[32:35]
    v_mfma_f32_16x16x32_bf16 v[36:39], v[72:75], v[84:87], v[36:39]
    v_mfma_f32_16x16x32_bf16 v[40:43], v[72:75], v[88:91], v[40:43]
    v_mfma_f32_16x16x32_bf16 v[44:47], v[72:75], v[92:95], v[44:47]
    v_mfma_f32_16x16x32_bf16 v[60:63], v[76:79], v[92:95], v[60:63]
    v_mfma_f32_16x16x32_bf16 v[56:59], v[76:79], v[88:91], v[56:59]
    v_mfma_f32_16x16x32_bf16 v[52:55], v[76:79], v[84:87], v[52:55]
    v_mfma_f32_16x16x32_bf16 v[48:51], v[76:79], v[80:83], v[48:51]
    s_waitcnt lgkmcnt(0)
    s_barrier
    v_mfma_f32_16x16x32_bf16 v[0:3], v[96:99], v[112:115], v[0:3]
    v_mfma_f32_16x16x32_bf16 v[4:7], v[96:99], v[116:119], v[4:7]
    v_mfma_f32_16x16x32_bf16 v[8:11], v[96:99], v[120:123], v[8:11]
    v_mfma_f32_16x16x32_bf16 v[12:15], v[96:99], v[124:127], v[12:15]
    v_mfma_f32_16x16x32_bf16 v[28:31], v[100:103], v[124:127], v[28:31]
    v_mfma_f32_16x16x32_bf16 v[24:27], v[100:103], v[120:123], v[24:27]
    v_mfma_f32_16x16x32_bf16 v[20:23], v[100:103], v[116:119], v[20:23]
    v_mfma_f32_16x16x32_bf16 v[16:19], v[100:103], v[112:115], v[16:19]
    v_mfma_f32_16x16x32_bf16 v[32:35], v[104:107], v[112:115], v[32:35]
    s_nop 1
    v_mfma_f32_16x16x32_bf16 v[36:39], v[104:107], v[116:119], v[36:39]
    s_nop 1
    v_mfma_f32_16x16x32_bf16 v[40:43], v[104:107], v[120:123], v[40:43]
    s_nop 1
    v_mfma_f32_16x16x32_bf16 v[44:47], v[104:107], v[124:127], v[44:47]
    v_cvt_pk_bf16_f32 v152, v0, v1
    v_cvt_pk_bf16_f32 v153, v2, v3
    v_mfma_f32_16x16x32_bf16 v[60:63], v[108:111], v[124:127], v[60:63]
    v_cvt_pk_bf16_f32 v154, v16, v17
    v_cvt_pk_bf16_f32 v155, v18, v19
    v_mfma_f32_16x16x32_bf16 v[56:59], v[108:111], v[120:123], v[56:59]
    buffer_store_dwordx4 v[152:155], v140, s[44:47], s76 offen offset:0 sc1
    v_cvt_pk_bf16_f32 v156, v4, v5
    v_mfma_f32_16x16x32_bf16 v[52:55], v[108:111], v[116:119], v[52:55]
    v_cvt_pk_bf16_f32 v157, v6, v7
    v_cvt_pk_bf16_f32 v158, v20, v21
    v_mfma_f32_16x16x32_bf16 v[48:51], v[108:111], v[112:115], v[48:51]
    v_cvt_pk_bf16_f32 v159, v22, v23
    buffer_store_dwordx4 v[156:159], v140, s[44:47], s76 offen offset:256 sc1
    v_cvt_pk_bf16_f32 v160, v8, v9
    v_cvt_pk_bf16_f32 v161, v10, v11
    v_cvt_pk_bf16_f32 v162, v24, v25
    v_cvt_pk_bf16_f32 v163, v26, v27
    buffer_store_dwordx4 v[160:163], v140, s[44:47], s76 offen offset:512 sc1
    v_cvt_pk_bf16_f32 v164, v12, v13
    v_cvt_pk_bf16_f32 v165, v14, v15
    v_cvt_pk_bf16_f32 v166, v28, v29
    v_cvt_pk_bf16_f32 v167, v30, v31
    buffer_store_dwordx4 v[164:167], v140, s[44:47], s76 offen offset:768 sc1
    v_cvt_pk_bf16_f32 v168, v32, v33
    v_cvt_pk_bf16_f32 v169, v34, v35
    v_cvt_pk_bf16_f32 v170, v48, v49
    v_cvt_pk_bf16_f32 v171, v50, v51
    buffer_store_dwordx4 v[168:171], v140, s[44:47], s77 offen offset:0 sc1
    v_cvt_pk_bf16_f32 v172, v36, v37
    v_cvt_pk_bf16_f32 v173, v38, v39
    v_cvt_pk_bf16_f32 v174, v52, v53
    v_cvt_pk_bf16_f32 v175, v54, v55
    buffer_store_dwordx4 v[172:175], v140, s[44:47], s77 offen offset:256 sc1
    v_cvt_pk_bf16_f32 v176, v40, v41
    v_cvt_pk_bf16_f32 v177, v42, v43
    v_cvt_pk_bf16_f32 v178, v56, v57
    v_cvt_pk_bf16_f32 v179, v58, v59
    buffer_store_dwordx4 v[176:179], v140, s[44:47], s77 offen offset:512 sc1
    v_cvt_pk_bf16_f32 v180, v44, v45
    v_cvt_pk_bf16_f32 v181, v46, v47
    v_cvt_pk_bf16_f32 v182, v60, v61
    v_cvt_pk_bf16_f32 v183, v62, v63
    buffer_store_dwordx4 v[180:183], v140, s[44:47], s77 offen offset:768 sc1
    s_branch L_qdone
.p2align 6
.fill 816, 4, 0xbf810000
L_qdone:
    s_barrier
    s_barrier
    s_add_u32 m0, s6, 65536
    s_lshl_b32 s9, s8, 7
    s_add_u32 s12, s4, s9
    buffer_load_dwordx4 v141, s[56:59], s12 offen offset:0 lds
    buffer_load_dwordx4 v142, s[56:59], s12 offen offset:1024 lds
    buffer_load_dwordx4 v143, s[56:59], s12 offen offset:2048 lds
    buffer_load_dwordx4 v144, s[56:59], s12 offen offset:3072 lds
    s_add_u32 m0, s7, 81920
    s_add_u32 s12, s5, s9
    buffer_load_dwordx4 v145, s[60:63], s12 offen offset:0 lds
    buffer_load_dwordx4 v146, s[60:63], s12 offen offset:1024 lds
    s_cmp_eq_u32 s73, 1
    s_cbranch_scc1 L_b3rd_31
    buffer_load_dwordx4 v147, s[60:63], s12 offen offset:2048 lds
L_b3rd_31:
    s_add_u32 s8, s8, 1
    s_cmp_eq_u32 s8, 10
    s_cselect_b32 s8, 0, s8
    s_barrier
    s_add_u32 m0, s6, 98304
    s_lshl_b32 s9, s8, 7
    s_add_u32 s12, s4, s9
    buffer_load_dwordx4 v141, s[56:59], s12 offen offset:0 lds
    buffer_load_dwordx4 v142, s[56:59], s12 offen offset:1024 lds
    buffer_load_dwordx4 v143, s[56:59], s12 offen offset:2048 lds
    buffer_load_dwordx4 v144, s[56:59], s12 offen offset:3072 lds
    s_add_u32 m0, s7, 114688
    s_add_u32 s12, s5, s9
    buffer_load_dwordx4 v145, s[60:63], s12 offen offset:0 lds
    buffer_load_dwordx4 v146, s[60:63], s12 offen offset:1024 lds
    s_cmp_eq_u32 s73, 1
    s_cbranch_scc1 L_b3rd_32
    buffer_load_dwordx4 v147, s[60:63], s12 offen offset:2048 lds
L_b3rd_32:
    s_add_u32 s8, s8, 1
    s_cmp_eq_u32 s8, 10
    s_cselect_b32 s8, 0, s8
    v_mov_b32 v0, 0
    v_mov_b32 v1, 0
    v_mov_b32 v2, 0
    v_mov_b32 v3, 0
    v_mov_b32 v4, 0
    v_mov_b32 v5, 0
    v_mov_b32 v6, 0
    v_mov_b32 v7, 0
    v_mov_b32 v8, 0
    v_mov_b32 v9, 0
    v_mov_b32 v10, 0
    v_mov_b32 v11, 0
    v_mov_b32 v12, 0
    v_mov_b32 v13, 0
    v_mov_b32 v14, 0
    v_mov_b32 v15, 0
    v_mov_b32 v16, 0
    v_mov_b32 v17, 0
    v_mov_b32 v18, 0
    v_mov_b32 v19, 0
    v_mov_b32 v20, 0
    v_mov_b32 v21, 0
    v_mov_b32 v22, 0
    v_mov_b32 v23, 0
    v_mov_b32 v24, 0
    v_mov_b32 v25, 0
    v_mov_b32 v26, 0
    v_mov_b32 v27, 0
    v_mov_b32 v28, 0
    v_mov_b32 v29, 0
    v_mov_b32 v30, 0
    v_mov_b32 v31, 0
    v_mov_b32 v32, 0
    v_mov_b32 v33, 0
    v_mov_b32 v34, 0
    v_mov_b32 v35, 0
    v_mov_b32 v36, 0
    v_mov_b32 v37, 0
    v_mov_b32 v38, 0
    v_mov_b32 v39, 0
    v_mov_b32 v40, 0
    v_mov_b32 v41, 0
    v_mov_b32 v42, 0
    v_mov_b32 v43, 0
    v_mov_b32 v44, 0
    v_mov_b32 v45, 0
    v_mov_b32 v46, 0
    v_mov_b32 v47, 0
    v_mov_b32 v48, 0
    v_mov_b32 v49, 0
    v_mov_b32 v50, 0
    v_mov_b32 v51, 0
    v_mov_b32 v52, 0
    v_mov_b32 v53, 0
    v_mov_b32 v54, 0
    v_mov_b32 v55, 0
    v_mov_b32 v56, 0
    v_mov_b32 v57, 0
    v_mov_b32 v58, 0
    v_mov_b32 v59, 0
    v_mov_b32 v60, 0
    v_mov_b32 v61, 0
    v_mov_b32 v62, 0
    v_mov_b32 v63, 0
    s_mov_b32 s85, 0xfa0000
    s_waitcnt vmcnt(6)
    s_barrier
    s_add_u32 m0, s6, 0
    s_lshl_b32 s9, s8, 7
    s_add_u32 s12, s4, s9
    buffer_load_dwordx4 v141, s[56:59], s12 offen offset:0 lds
    buffer_load_dwordx4 v142, s[56:59], s12 offen offset:1024 lds
    buffer_load_dwordx4 v143, s[56:59], s12 offen offset:2048 lds
    buffer_load_dwordx4 v144, s[56:59], s12 offen offset:3072 lds
    s_add_u32 m0, s7, 16384
    s_add_u32 s12, s5, s9
    buffer_load_dwordx4 v145, s[60:63], s12 offen offset:0 lds
    buffer_load_dwordx4 v146, s[60:63], s12 offen offset:1024 lds
    s_cmp_eq_u32 s73, 1
    s_cbranch_scc1 L_b3rd_33
    buffer_load_dwordx4 v147, s[60:63], s12 offen offset:2048 lds
L_b3rd_33:
    s_add_u32 s8, s8, 1
    s_cmp_eq_u32 s8, 10
    s_cselect_b32 s8, 0, s8
    s_and_b32 s76, s34, 1
    s_lshr_b32 s77, s34, 1
    s_and_b32 s78, s66, 1
    s_lshr_b32 s85, s66, 1
    s_mul_i32 s79, s85, 5
    s_lshl1_add_u32 s90, s67, s76
    s_lshl1_add_u32 s90, s90, s77
    s_mul_i32 s92, s90, 247808
    s_xor_b32 s91, s90, 1
    s_mul_i32 s91, s91, 247808
    s_waitcnt vmcnt(6)
    s_barrier
    s_add_u32 m0, s6, 32768
    s_lshl_b32 s9, s8, 7
    s_add_u32 s12, s4, s9
    buffer_load_dwordx4 v141, s[56:59], s12 offen offset:0 lds
    buffer_load_dwordx4 v142, s[56:59], s12 offen offset:1024 lds
    buffer_load_dwordx4 v143, s[56:59], s12 offen offset:2048 lds
    buffer_load_dwordx4 v144, s[56:59], s12 offen offset:3072 lds
    s_add_u32 m0, s7, 49152
    s_add_u32 s12, s5, s9
    buffer_load_dwordx4 v145, s[60:63], s12 offen offset:0 lds
    buffer_load_dwordx4 v146, s[60:63], s12 offen offset:1024 lds
    s_cmp_eq_u32 s73, 1
    s_cbranch_scc1 L_b3rd_34
    buffer_load_dwordx4 v147, s[60:63], s12 offen offset:2048 lds
L_b3rd_34:
    s_add_u32 s8, s8, 1
    s_cmp_eq_u32 s8, 10
    s_cselect_b32 s8, 0, s8
    s_mov_b32 s10, 0x3d800000
    s_mov_b32 s11, 0x63800000
    s_mul_i32 s36, s34, 14848
    s_add_u32 s36, s36, 110592
    s_xor_b32 s37, s34, 2
    s_mul_i32 s37, s37, 14848
    s_add_u32 s37, s37, 110592
    v_lshl_add_u32 v240, v254, 4, s36
    v_lshl_add_u32 v241, v254, 3, s36
    v_lshl_add_u32 v242, v254, 4, s37
    v_lshl_add_u32 v243, v254, 3, s37
    s_waitcnt vmcnt(6)
    s_barrier
    s_add_u32 m0, s6, 65536
    s_lshl_b32 s9, s8, 7
    s_add_u32 s12, s4, s9
    buffer_load_dwordx4 v141, s[56:59], s12 offen offset:0 lds
    buffer_load_dwordx4 v142, s[56:59], s12 offen offset:1024 lds
    buffer_load_dwordx4 v143, s[56:59], s12 offen offset:2048 lds
    buffer_load_dwordx4 v144, s[56:59], s12 offen offset:3072 lds
    s_add_u32 m0, s7, 81920
    s_add_u32 s12, s5, s9
    buffer_load_dwordx4 v145, s[60:63], s12 offen offset:0 lds
    buffer_load_dwordx4 v146, s[60:63], s12 offen offset:1024 lds
    s_cmp_eq_u32 s73, 1
    s_cbranch_scc1 L_b3rd_35
    buffer_load_dwordx4 v147, s[60:63], s12 offen offset:2048 lds
L_b3rd_35:
    s_add_u32 s8, s8, 1
    s_cmp_eq_u32 s8, 10
    s_cselect_b32 s8, 0, s8
    v_xor_b32 v244, 512, v253
    v_add_u32 v245, 1024, v249
    v_bfe_u32 v227, v254, 4, 1
    v_mul_u32_u24 v227, 20480, v227
    v_and_b32 v226, 15, v254
    v_lshl_add_u32 v227, v226, 4, v227
    v_mul_u32_u24 v226, 40960, v225
    v_add_u32 v247, v226, v227
    v_lshl_add_u32 v246, v225, 8, v227
    s_mul_i32 s40, s90, 81920
    s_waitcnt vmcnt(6)
    s_barrier
    s_add_u32 m0, s6, 98304
    s_lshl_b32 s9, s8, 7
    s_add_u32 s12, s4, s9
    buffer_load_dwordx4 v141, s[56:59], s12 offen offset:0 lds
    buffer_load_dwordx4 v142, s[56:59], s12 offen offset:1024 lds
    buffer_load_dwordx4 v143, s[56:59], s12 offen offset:2048 lds
    buffer_load_dwordx4 v144, s[56:59], s12 offen offset:3072 lds
    s_add_u32 m0, s7, 114688
    s_add_u32 s12, s5, s9
    buffer_load_dwordx4 v145, s[60:63], s12 offen offset:0 lds
    buffer_load_dwordx4 v146, s[60:63], s12 offen offset:1024 lds
    s_cmp_eq_u32 s73, 1
    s_cbranch_scc1 L_b3rd_36
    buffer_load_dwordx4 v147, s[60:63], s12 offen offset:2048 lds
L_b3rd_36:
    s_add_u32 s8, s8, 1
    s_cmp_eq_u32 s8, 10
    s_cselect_b32 s8, 0, s8
    s_add_u32 s40, s40, 0xd00000
    s_lshl_b32 s41, s79, 8
    s_add_u32 s40, s40, s41
    s_mul_i32 s41, s78, 768
    s_add_u32 s41, s41, s40
    s_add_u32 s42, s41, 40960
    s_lshl3_add_u32 s40, s78, s40
    s_lshl_b32 s43, s90, 5
    s_add_u32 s43, s43, s66
    s_lshl_b32 s43, s43, 7
    s_add_u32 s43, s43, 0xfc8000
    s_mov_b32 s85, 0xfa0000
    s_waitcnt vmcnt(6)
    s_barrier
    s_add_u32 m0, s6, 0
    s_lshl_b32 s9, s8, 7
    s_add_u32 s12, s4, s9
    buffer_load_dwordx4 v141, s[56:59], s12 offen offset:0 lds
    buffer_load_dwordx4 v142, s[56:59], s12 offen offset:1024 lds
    buffer_load_dwordx4 v143, s[56:59], s12 offen offset:2048 lds
    buffer_load_dwordx4 v144, s[56:59], s12 offen offset:3072 lds
    s_add_u32 m0, s7, 16384
    s_add_u32 s12, s5, s9
    buffer_load_dwordx4 v145, s[60:63], s12 offen offset:0 lds
    buffer_load_dwordx4 v146, s[60:63], s12 offen offset:1024 lds
    s_cmp_eq_u32 s73, 1
    s_cbranch_scc1 L_b3rd_37
    buffer_load_dwordx4 v147, s[60:63], s12 offen offset:2048 lds
L_b3rd_37:
    s_add_u32 s8, s8, 1
    s_cmp_eq_u32 s8, 10
    s_cselect_b32 s8, 0, s8
    s_cmp_eq_u32 s34, 0
    s_cbranch_scc0 L_nopoll
    buffer_load_dword v104, v252, s[44:47], s85 offen sc1
    buffer_load_dword v105, v251, s[44:47], s85 offen sc1
L_nopoll:
    s_waitcnt vmcnt(6)
    s_barrier
    s_waitcnt vmcnt(0)
    s_cmp_eq_u32 s34, 0
    s_cbranch_scc0 L_c19
    v_and_b32 v104, v104, v105
    v_cmp_eq_u32 vcc, 0, v104
    s_cbranch_vccnz L_c19
    v_mov_b32 v102, 4
    ds_write_b32 v253, v102
    s_waitcnt lgkmcnt(0)
L_c19:
    s_barrier
    s_cmp_eq_u32 s34, 0
    s_cbranch_scc0 L_f1wait
    s_cbranch_vccz L_f1go
    s_mov_b64 exec, vcc
L_pf_38:
    buffer_load_dword v104, v252, s[44:47], s85 offen sc1
    buffer_load_dword v105, v251, s[44:47], s85 offen sc1
    s_sub_u32 s96, s96, 1
    s_cbranch_scc1 L_exit
    s_waitcnt vmcnt(0)
    v_and_b32 v104, v104, v105
    v_cmp_eq_u32 vcc, 0, v104
    s_and_b64 exec, exec, vcc
    s_cbranch_scc1 L_pf_38
    s_mov_b64 exec, -1
    v_mov_b32 v102, 4
    ds_write_b32 v253, v102
L_f1wait:
L_pw_40:
    ds_read_b32 v102, v250
    s_sub_u32 s96, s96, 1
    s_cbranch_scc1 L_exit
    s_waitcnt lgkmcnt(0)
    v_cmp_gt_u32 vcc, 4, v102
    s_cbranch_vccnz L_pw_40
L_f1go:
    buffer_load_dwordx4 v[184:187], v228, s[44:47], s91 offen offset:0 sc1
    buffer_load_dwordx4 v[188:191], v228, s[44:47], s91 offen offset:512 sc1
    buffer_load_dwordx4 v[192:195], v228, s[44:47], s92 offen offset:0 sc1
    buffer_load_dwordx4 v[196:199], v228, s[44:47], s92 offen offset:512 sc1
    buffer_load_dwordx4 v[200:203], v229, s[44:47], s91 offen sc1
    buffer_load_dwordx4 v[204:207], v229, s[44:47], s92 offen sc1
L_attload:
    buffer_load_dwordx4 v[128:131], v208, s[48:51], s93 offen offset:0 sc1
    buffer_load_dwordx4 v[136:139], v209, s[48:51], s93 offen sc1
L_att2:
    s_cmp_eq_u32 s93, s70
    s_cselect_b32 s83, s71, s93
    s_sub_u32 s83, s83, 247808
    s_add_u32 s80, s93, 247808
    v_mov_b32 v180, 0
    v_mov_b32 v181, 0
    v_mov_b32 v182, 0
    v_mov_b32 v183, 0
    s_waitcnt vmcnt(4)
    buffer_load_dwordx4 v[140:143], v210, s[48:51], s93 offen sc1
    buffer_load_dwordx4 v[144:147], v211, s[48:51], s93 offen sc1
    buffer_load_dwordx4 v[132:135], v208, s[48:51], s93 offen offset:512 sc1
    buffer_load_dwordx4 v[148:151], v212, s[48:51], s93 offen sc1
    buffer_load_dwordx4 v[152:155], v213, s[48:51], s93 offen sc1
    s_waitcnt vmcnt(5)
    s_cmp_eq_u32 s82, 0
    s_cbranch_scc0 L_setc
    v_mfma_f32_32x32x16_bf16 v[64:79], v[128:131], v[184:187], 0
    v_mfma_f32_32x32x8bf16_1k v[64:79], v[136:137], v[200:201], v[64:79]
    v_mfma_f32_32x32x16_bf16 v[80:95], v[128:131], v[188:191], 0
    v_mfma_f32_32x32x8bf16_1k v[80:95], v[136:137], v[202:203], v[80:95]
    v_mfma_f32_32x32x16_bf16 v[96:111], v[128:131], v[192:195], 0
    s_nop 6
    v_mfma_f32_32x32x8bf16_1k v[96:111], v[136:137], v[204:205], v[96:111]
    s_nop 0
    v_max3_f32 v220, v64, v65, v66
    v_max3_f32 v220, v220, v69, v72
    v_max3_f32 v220, v220, v75, v78
    v_cvt_pk_bf16_f32 v232, -v220, -v220
    v_and_b32 v232, 0xffff0000, v232
    v_mfma_f32_32x32x16_bf16 v[112:127], v[128:131], v[196:199], 0
    v_sub_f32 v220, -v220, v232
    v_cvt_pk_bf16_f32 v220, v232, v220
    v_cndmask_b32 v200, v200, v220, s[94:95]
    v_max3_f32 v221, v80, v81, v82
    v_max3_f32 v221, v221, v85, v88
    v_max3_f32 v221, v221, v91, v94
    v_mfma_f32_32x32x8bf16_1k v[112:127], v[136:137], v[206:207], v[112:127]
    v_cvt_pk_bf16_f32 v233, -v221, -v221
    v_and_b32 v233, 0xffff0000, v233
    v_sub_f32 v221, -v221, v233
    v_cvt_pk_bf16_f32 v221, v233, v221
    v_cndmask_b32 v202, v202, v221, s[94:95]
    v_and_b32 v220, 0xffff0000, v220
    v_mfma_f32_32x32x16_bf16 v[64:79], v[128:131], v[184:187], 0
    v_max3_f32 v222, v96, v97, v98
    v_max3_f32 v222, v222, v101, v104
    v_max3_f32 v222, v222, v107, v110
    v_cvt_pk_bf16_f32 v234, -v222, -v222
    v_and_b32 v234, 0xffff0000, v234
    v_sub_f32 v222, -v222, v234
    v_mfma_f32_32x32x8bf16_1k v[64:79], v[136:137], v[200:201], v[64:79]
    v_max3_f32 v223, v112, v113, v114
    v_max3_f32 v223, v223, v117, v120
    v_max3_f32 v223, v223, v123, v126
    v_mov_b32 v120, 0
    v_mov_b32 v121, 0
    v_mov_b32 v122, 0
    v_mov_b32 v123, 0
    v_mov_b32 v124, 0
    v_mov_b32 v125, 0
    v_mov_b32 v126, 0
    v_mov_b32 v127, 0
    v_cvt_pk_bf16_f32 v222, v234, v222
    v_cndmask_b32 v204, v204, v222, s[94:95]
    v_cvt_pk_bf16_f32 v235, -v223, -v223
    v_and_b32 v235, 0xffff0000, v235
    v_sub_f32 v223, -v223, v235
    v_cvt_pk_bf16_f32 v223, v235, v223
    v_cndmask_b32 v206, v206, v223, s[94:95]
    v_add_f32 v216, v220, v232
    v_add_f32 v220, v220, v232
    v_and_b32 v221, 0xffff0000, v221
    v_add_f32 v217, v221, v233
    v_add_f32 v221, v221, v233
    v_and_b32 v222, 0xffff0000, v222
    v_add_f32 v218, v222, v234
    v_add_f32 v222, v222, v234
    v_permlane32_swap_b32 v220, v216
    v_and_b32 v223, 0xffff0000, v223
    v_add_f32 v219, v223, v235
    v_add_f32 v223, v223, v235
    v_permlane32_swap_b32 v221, v217
    v_permlane32_swap_b32 v222, v218
    v_permlane32_swap_b32 v223, v219
L_loopentry:
    buffer_load_dwordx4 v[156:159], v208, s[48:51], s80 offen offset:0 sc1
    buffer_load_dwordx4 v[168:171], v210, s[48:51], s80 offen sc1
    buffer_load_dwordx4 v[172:175], v211, s[48:51], s80 offen sc1
    buffer_load_dwordx4 v[160:163], v208, s[48:51], s80 offen offset:512 sc1
    buffer_load_dwordx4 v[164:167], v209, s[48:51], s80 offen sc1
    buffer_load_dwordx4 v[176:179], v212, s[48:51], s80 offen sc1
    s_waitcnt vmcnt(8)
.p2align 6
L_attloop:
    v_mfma_f32_32x32x8bf16_1k v[80:95], v[136:137], v[202:203], 0
    v_exp_f32 v64, v64
    v_exp_f32 v65, v65
    v_exp_f32 v66, v66
    v_exp_f32 v67, v67
    v_mfma_f32_32x32x16_bf16 v[80:95], v[128:131], v[188:191], v[80:95]
    v_exp_f32 v68, v68
    v_exp_f32 v69, v69
    v_exp_f32 v70, v70
    v_exp_f32 v71, v71
    v_smfmac_f32_32x32x32_bf16 v[48:63], v[180:183], v[120:127], v214
    buffer_load_dwordx4 v[180:183], v213, s[48:51], s80 offen sc1
    v_exp_f32 v72, v72
    v_exp_f32 v73, v73
    v_exp_f32 v74, v74
    v_exp_f32 v75, v75
    v_smfmac_f32_32x32x32_bf16 v[0:15], v[140:143], v[64:71], v214
    v_exp_f32 v76, v76
    v_exp_f32 v77, v77
    v_exp_f32 v78, v78
    v_exp_f32 v79, v79
    v_mfma_f32_32x32x8bf16_1k v[96:111], v[136:137], v[204:205], 0
    s_add_u32 s80, s80, 247808
    v_exp_f32 v80, v80
    v_exp_f32 v81, v81
    v_exp_f32 v82, v82
    v_exp_f32 v83, v83
    v_mfma_f32_32x32x16_bf16 v[96:111], v[128:131], v[192:195], v[96:111]
    s_cmp_eq_u32 s80, s71
    s_cselect_b32 s80, s70, s80
    v_exp_f32 v84, v84
    v_exp_f32 v85, v85
    v_exp_f32 v86, v86
    v_exp_f32 v87, v87
    v_smfmac_f32_32x32x32_bf16 v[0:15], v[144:147], v[72:79], v214
    v_exp_f32 v88, v88
    v_exp_f32 v89, v89
    v_exp_f32 v90, v90
    v_exp_f32 v91, v91
    v_smfmac_f32_32x32x32_bf16 v[16:31], v[140:143], v[80:87], v214
    v_exp_f32 v92, v92
    v_exp_f32 v93, v93
    v_exp_f32 v94, v94
    v_exp_f32 v95, v95
    v_mfma_f32_32x32x8bf16_1k v[112:127], v[136:137], v[206:207], 0
    v_exp_f32 v96, v96
    v_exp_f32 v97, v97
    v_exp_f32 v98, v98
    v_exp_f32 v99, v99
    v_mfma_f32_32x32x16_bf16 v[112:127], v[128:131], v[196:199], v[112:127]
    buffer_load_dwordx4 v[128:131], v208, s[48:51], s80 offen offset:0 sc1
    v_exp_f32 v100, v100
    v_exp_f32 v101, v101
    v_exp_f32 v102, v102
    v_exp_f32 v103, v103
    v_smfmac_f32_32x32x32_bf16 v[16:31], v[144:147], v[88:95], v214
    v_exp_f32 v104, v104
    v_exp_f32 v105, v105
    v_exp_f32 v106, v106
    v_exp_f32 v107, v107
    v_smfmac_f32_32x32x32_bf16 v[32:47], v[140:143], v[96:103], v214
    v_exp_f32 v108, v108
    v_exp_f32 v109, v109
    v_exp_f32 v110, v110
    v_exp_f32 v111, v111
    v_mfma_f32_32x32x8bf16_1k v[64:79], v[138:139], v[200:201], 0
    v_exp_f32 v112, v112
    v_exp_f32 v113, v113
    v_exp_f32 v114, v114
    v_exp_f32 v115, v115
    v_mfma_f32_32x32x16_bf16 v[64:79], v[132:135], v[184:187], v[64:79]
    v_exp_f32 v116, v116
    v_exp_f32 v117, v117
    v_exp_f32 v118, v118
    v_exp_f32 v119, v119
    v_smfmac_f32_32x32x32_bf16 v[32:47], v[144:147], v[104:111], v214
    v_exp_f32 v120, v120
    v_exp_f32 v121, v121
    v_exp_f32 v122, v122
    v_exp_f32 v123, v123
    v_smfmac_f32_32x32x32_bf16 v[48:63], v[140:143], v[112:119], v214
    buffer_load_dwordx4 v[140:143], v210, s[48:51], s80 offen sc1
    v_exp_f32 v124, v124
    v_exp_f32 v125, v125
    v_exp_f32 v126, v126
    v_exp_f32 v127, v127
    v_mfma_f32_32x32x8bf16_1k v[80:95], v[138:139], v[202:203], 0
    v_exp_f32 v64, v64
    v_exp_f32 v65, v65
    v_exp_f32 v66, v66
    v_exp_f32 v67, v67
    v_mfma_f32_32x32x16_bf16 v[80:95], v[132:135], v[188:191], v[80:95]
    v_exp_f32 v68, v68
    v_exp_f32 v69, v69
    v_exp_f32 v70, v70
    v_exp_f32 v71, v71
    v_smfmac_f32_32x32x32_bf16 v[48:63], v[144:147], v[120:127], v214
    buffer_load_dwordx4 v[144:147], v211, s[48:51], s80 offen sc1
    v_exp_f32 v72, v72
    v_exp_f32 v73, v73
    v_exp_f32 v74, v74
    v_exp_f32 v75, v75
    s_waitcnt vmcnt(10)
    v_smfmac_f32_32x32x32_bf16 v[0:15], v[148:151], v[64:71], v214
    v_exp_f32 v76, v76
    v_exp_f32 v77, v77
    v_exp_f32 v78, v78
    v_exp_f32 v79, v79
    v_mfma_f32_32x32x8bf16_1k v[96:111], v[138:139], v[204:205], 0
    v_exp_f32 v80, v80
    v_exp_f32 v81, v81
    v_exp_f32 v82, v82
    v_exp_f32 v83, v83
    v_mfma_f32_32x32x16_bf16 v[96:111], v[132:135], v[192:195], v[96:111]
    v_exp_f32 v84, v84
    v_exp_f32 v85, v85
    v_exp_f32 v86, v86
    v_exp_f32 v87, v87
    v_smfmac_f32_32x32x32_bf16 v[0:15], v[152:155], v[72:79], v214
    v_exp_f32 v88, v88
    v_exp_f32 v89, v89
    v_exp_f32 v90, v90
    v_exp_f32 v91, v91
    v_smfmac_f32_32x32x32_bf16 v[16:31], v[148:151], v[80:87], v214
    v_exp_f32 v92, v92
    v_exp_f32 v93, v93
    v_exp_f32 v94, v94
    v_exp_f32 v95, v95
    v_mfma_f32_32x32x8bf16_1k v[112:127], v[138:139], v[206:207], 0
    buffer_load_dwordx4 v[136:139], v209, s[48:51], s80 offen sc1
    v_exp_f32 v96, v96
    v_exp_f32 v97, v97
    v_exp_f32 v98, v98
    v_exp_f32 v99, v99
    v_mfma_f32_32x32x16_bf16 v[112:127], v[132:135], v[196:199], v[112:127]
    buffer_load_dwordx4 v[132:135], v208, s[48:51], s80 offen offset:512 sc1
    v_exp_f32 v100, v100
    v_exp_f32 v101, v101
    v_exp_f32 v102, v102
    v_exp_f32 v103, v103
    v_smfmac_f32_32x32x32_bf16 v[16:31], v[152:155], v[88:95], v214
    v_exp_f32 v104, v104
    v_exp_f32 v105, v105
    v_exp_f32 v106, v106
    v_exp_f32 v107, v107
    v_smfmac_f32_32x32x32_bf16 v[32:47], v[148:151], v[96:103], v214
    v_exp_f32 v108, v108
    v_exp_f32 v109, v109
    v_exp_f32 v110, v110
    v_exp_f32 v111, v111
    s_waitcnt vmcnt(7)
    v_mfma_f32_32x32x8bf16_1k v[64:79], v[164:165], v[200:201], 0
    v_exp_f32 v112, v112
    v_exp_f32 v113, v113
    v_exp_f32 v114, v114
    v_exp_f32 v115, v115
    v_mfma_f32_32x32x16_bf16 v[64:79], v[156:159], v[184:187], v[64:79]
    v_exp_f32 v116, v116
    v_exp_f32 v117, v117
    v_exp_f32 v118, v118
    v_exp_f32 v119, v119
    v_smfmac_f32_32x32x32_bf16 v[32:47], v[152:155], v[104:111], v214
    v_exp_f32 v120, v120
    v_exp_f32 v121, v121
    v_exp_f32 v122, v122
    v_exp_f32 v123, v123
    v_smfmac_f32_32x32x32_bf16 v[48:63], v[148:151], v[112:119], v214
    buffer_load_dwordx4 v[148:151], v212, s[48:51], s80 offen sc1
    v_exp_f32 v124, v124
    v_exp_f32 v125, v125
    v_exp_f32 v126, v126
    v_exp_f32 v127, v127
    v_mfma_f32_32x32x8bf16_1k v[80:95], v[164:165], v[202:203], 0
    v_exp_f32 v64, v64
    v_exp_f32 v65, v65
    v_exp_f32 v66, v66
    v_exp_f32 v67, v67
    v_mfma_f32_32x32x16_bf16 v[80:95], v[156:159], v[188:191], v[80:95]
    v_exp_f32 v68, v68
    v_exp_f32 v69, v69
    v_exp_f32 v70, v70
    v_exp_f32 v71, v71
    v_smfmac_f32_32x32x32_bf16 v[48:63], v[152:155], v[120:127], v214
    buffer_load_dwordx4 v[152:155], v213, s[48:51], s80 offen sc1
    v_exp_f32 v72, v72
    v_exp_f32 v73, v73
    v_exp_f32 v74, v74
    v_exp_f32 v75, v75
    v_smfmac_f32_32x32x32_bf16 v[0:15], v[168:171], v[64:71], v214
    v_exp_f32 v76, v76
    v_exp_f32 v77, v77
    v_exp_f32 v78, v78
    v_exp_f32 v79, v79
    v_mfma_f32_32x32x8bf16_1k v[96:111], v[164:165], v[204:205], 0
    s_add_u32 s80, s80, 247808
    v_exp_f32 v80, v80
    v_exp_f32 v81, v81
    v_exp_f32 v82, v82
    v_exp_f32 v83, v83
    v_mfma_f32_32x32x16_bf16 v[96:111], v[156:159], v[192:195], v[96:111]
    v_exp_f32 v84, v84
    v_exp_f32 v85, v85
    v_exp_f32 v86, v86
    v_exp_f32 v87, v87
    v_smfmac_f32_32x32x32_bf16 v[0:15], v[172:175], v[72:79], v214
    v_exp_f32 v88, v88
    v_exp_f32 v89, v89
    v_exp_f32 v90, v90
    v_exp_f32 v91, v91
    v_smfmac_f32_32x32x32_bf16 v[16:31], v[168:171], v[80:87], v214
    v_exp_f32 v92, v92
    v_exp_f32 v93, v93
    v_exp_f32 v94, v94
    v_exp_f32 v95, v95
    v_mfma_f32_32x32x8bf16_1k v[112:127], v[164:165], v[206:207], 0
    v_exp_f32 v96, v96
    v_exp_f32 v97, v97
    v_exp_f32 v98, v98
    v_exp_f32 v99, v99
    v_mfma_f32_32x32x16_bf16 v[112:127], v[156:159], v[196:199], v[112:127]
    buffer_load_dwordx4 v[156:159], v208, s[48:51], s80 offen offset:0 sc1
    v_exp_f32 v100, v100
    v_exp_f32 v101, v101
    v_exp_f32 v102, v102
    v_exp_f32 v103, v103
    v_smfmac_f32_32x32x32_bf16 v[16:31], v[172:175], v[88:95], v214
    v_exp_f32 v104, v104
    v_exp_f32 v105, v105
    v_exp_f32 v106, v106
    v_exp_f32 v107, v107
    v_smfmac_f32_32x32x32_bf16 v[32:47], v[168:171], v[96:103], v214
    v_exp_f32 v108, v108
    v_exp_f32 v109, v109
    v_exp_f32 v110, v110
    v_exp_f32 v111, v111
    v_mfma_f32_32x32x8bf16_1k v[64:79], v[166:167], v[200:201], 0
    v_exp_f32 v112, v112
    v_exp_f32 v113, v113
    v_exp_f32 v114, v114
    v_exp_f32 v115, v115
    v_mfma_f32_32x32x16_bf16 v[64:79], v[160:163], v[184:187], v[64:79]
    v_exp_f32 v116, v116
    v_exp_f32 v117, v117
    v_exp_f32 v118, v118
    v_exp_f32 v119, v119
    v_smfmac_f32_32x32x32_bf16 v[32:47], v[172:175], v[104:111], v214
    v_exp_f32 v120, v120
    v_exp_f32 v121, v121
    v_exp_f32 v122, v122
    v_exp_f32 v123, v123
    v_smfmac_f32_32x32x32_bf16 v[48:63], v[168:171], v[112:119], v214
    buffer_load_dwordx4 v[168:171], v210, s[48:51], s80 offen sc1
    v_exp_f32 v124, v124
    v_exp_f32 v125, v125
    v_exp_f32 v126, v126
    v_exp_f32 v127, v127
    v_mfma_f32_32x32x8bf16_1k v[80:95], v[166:167], v[202:203], 0
    v_exp_f32 v64, v64
    v_exp_f32 v65, v65
    v_exp_f32 v66, v66
    v_exp_f32 v67, v67
    v_mfma_f32_32x32x16_bf16 v[80:95], v[160:163], v[188:191], v[80:95]
    v_exp_f32 v68, v68
    v_exp_f32 v69, v69
    v_exp_f32 v70, v70
    v_exp_f32 v71, v71
    v_smfmac_f32_32x32x32_bf16 v[48:63], v[172:175], v[120:127], v214
    buffer_load_dwordx4 v[172:175], v211, s[48:51], s80 offen sc1
    v_exp_f32 v72, v72
    v_exp_f32 v73, v73
    v_exp_f32 v74, v74
    v_exp_f32 v75, v75
    s_waitcnt vmcnt(10)
    v_smfmac_f32_32x32x32_bf16 v[0:15], v[176:179], v[64:71], v214
    v_exp_f32 v76, v76
    v_exp_f32 v77, v77
    v_exp_f32 v78, v78
    v_exp_f32 v79, v79
    v_mfma_f32_32x32x8bf16_1k v[96:111], v[166:167], v[204:205], 0
    v_exp_f32 v80, v80
    v_exp_f32 v81, v81
    v_exp_f32 v82, v82
    v_exp_f32 v83, v83
    v_mfma_f32_32x32x16_bf16 v[96:111], v[160:163], v[192:195], v[96:111]
    v_exp_f32 v84, v84
    v_exp_f32 v85, v85
    v_exp_f32 v86, v86
    v_exp_f32 v87, v87
    v_smfmac_f32_32x32x32_bf16 v[0:15], v[180:183], v[72:79], v214
    v_exp_f32 v88, v88
    v_exp_f32 v89, v89
    v_exp_f32 v90, v90
    v_exp_f32 v91, v91
    v_smfmac_f32_32x32x32_bf16 v[16:31], v[176:179], v[80:87], v214
    v_exp_f32 v92, v92
    v_exp_f32 v93, v93
    v_exp_f32 v94, v94
    v_exp_f32 v95, v95
    v_mfma_f32_32x32x8bf16_1k v[112:127], v[166:167], v[206:207], 0
    buffer_load_dwordx4 v[164:167], v209, s[48:51], s80 offen sc1
    v_exp_f32 v96, v96
    v_exp_f32 v97, v97
    v_exp_f32 v98, v98
    v_exp_f32 v99, v99
    v_mfma_f32_32x32x16_bf16 v[112:127], v[160:163], v[196:199], v[112:127]
    buffer_load_dwordx4 v[160:163], v208, s[48:51], s80 offen offset:512 sc1
    v_exp_f32 v100, v100
    v_exp_f32 v101, v101
    v_exp_f32 v102, v102
    v_exp_f32 v103, v103
    v_smfmac_f32_32x32x32_bf16 v[16:31], v[180:183], v[88:95], v214
    v_exp_f32 v104, v104
    v_exp_f32 v105, v105
    v_exp_f32 v106, v106
    v_exp_f32 v107, v107
    v_smfmac_f32_32x32x32_bf16 v[32:47], v[176:179], v[96:103], v214
    v_exp_f32 v108, v108
    v_exp_f32 v109, v109
    v_exp_f32 v110, v110
    v_exp_f32 v111, v111
    s_waitcnt vmcnt(7)
    v_mfma_f32_32x32x8bf16_1k v[64:79], v[136:137], v[200:201], 0
    v_exp_f32 v112, v112
    v_exp_f32 v113, v113
    v_exp_f32 v114, v114
    v_exp_f32 v115, v115
    v_mfma_f32_32x32x16_bf16 v[64:79], v[128:131], v[184:187], v[64:79]
    v_exp_f32 v116, v116
    v_exp_f32 v117, v117
    v_exp_f32 v118, v118
    v_exp_f32 v119, v119
    v_smfmac_f32_32x32x32_bf16 v[32:47], v[180:183], v[104:111], v214
    s_cmp_lg_u32 s80, s83
    v_exp_f32 v120, v120
    v_exp_f32 v121, v121
    v_exp_f32 v122, v122
    v_exp_f32 v123, v123
    v_smfmac_f32_32x32x32_bf16 v[48:63], v[176:179], v[112:119], v214
    buffer_load_dwordx4 v[176:179], v212, s[48:51], s80 offen sc1
    v_exp_f32 v124, v124
    v_exp_f32 v125, v125
    v_exp_f32 v126, v126
    v_exp_f32 v127, v127
    s_cbranch_scc1 L_attloop
    v_mfma_f32_32x32x8bf16_1k v[80:95], v[136:137], v[202:203], 0
    v_exp_f32 v64, v64
    v_exp_f32 v65, v65
    v_exp_f32 v66, v66
    v_exp_f32 v67, v67
    v_mfma_f32_32x32x16_bf16 v[80:95], v[128:131], v[188:191], v[80:95]
    v_exp_f32 v68, v68
    v_exp_f32 v69, v69
    v_exp_f32 v70, v70
    v_exp_f32 v71, v71
    v_smfmac_f32_32x32x32_bf16 v[48:63], v[180:183], v[120:127], v214
    buffer_load_dwordx4 v[180:183], v213, s[48:51], s80 offen sc1
    v_exp_f32 v72, v72
    v_exp_f32 v73, v73
    v_exp_f32 v74, v74
    v_exp_f32 v75, v75
    v_smfmac_f32_32x32x32_bf16 v[0:15], v[140:143], v[64:71], v214
    v_exp_f32 v76, v76
    v_exp_f32 v77, v77
    v_exp_f32 v78, v78
    v_exp_f32 v79, v79
    v_mfma_f32_32x32x8bf16_1k v[96:111], v[138:139], v[200:201], 0
    s_cmp_lg_u32 s84, 0
    v_exp_f32 v80, v80
    v_exp_f32 v81, v81
    v_exp_f32 v82, v82
    v_exp_f32 v83, v83
    v_mfma_f32_32x32x16_bf16 v[96:111], v[132:135], v[184:187], v[96:111]
    v_exp_f32 v84, v84
    v_exp_f32 v85, v85
    v_exp_f32 v86, v86
    v_exp_f32 v87, v87
    v_smfmac_f32_32x32x32_bf16 v[0:15], v[144:147], v[72:79], v214
    v_exp_f32 v88, v88
    v_exp_f32 v89, v89
    v_exp_f32 v90, v90
    v_exp_f32 v91, v91
    v_smfmac_f32_32x32x32_bf16 v[16:31], v[140:143], v[80:87], v214
    v_exp_f32 v92, v92
    v_exp_f32 v93, v93
    v_exp_f32 v94, v94
    v_exp_f32 v95, v95
    v_mfma_f32_32x32x8bf16_1k v[112:127], v[138:139], v[202:203], 0
    v_exp_f32 v96, v96
    v_exp_f32 v97, v97
    v_exp_f32 v98, v98
    v_exp_f32 v99, v99
    v_mfma_f32_32x32x16_bf16 v[112:127], v[132:135], v[188:191], v[112:127]
    v_exp_f32 v100, v100
    v_exp_f32 v101, v101
    v_exp_f32 v102, v102
    v_exp_f32 v103, v103
    v_smfmac_f32_32x32x32_bf16 v[16:31], v[144:147], v[88:95], v214
    v_exp_f32 v104, v104
    v_exp_f32 v105, v105
    v_exp_f32 v106, v106
    v_exp_f32 v107, v107
    s_waitcnt vmcnt(2)
    v_smfmac_f32_32x32x32_bf16 v[0:15], v[148:151], v[96:103], v214
    v_exp_f32 v108, v108
    v_exp_f32 v109, v109
    v_exp_f32 v110, v110
    v_exp_f32 v111, v111
    v_mfma_f32_32x32x8bf16_1k v[64:79], v[164:165], v[200:201], 0
    v_exp_f32 v112, v112
    v_exp_f32 v113, v113
    v_exp_f32 v114, v114
    v_exp_f32 v115, v115
    v_mfma_f32_32x32x16_bf16 v[64:79], v[156:159], v[184:187], v[64:79]
    v_exp_f32 v116, v116
    v_exp_f32 v117, v117
    v_exp_f32 v118, v118
    v_exp_f32 v119, v119
    v_smfmac_f32_32x32x32_bf16 v[0:15], v[152:155], v[104:111], v214
    v_exp_f32 v120, v120
    v_exp_f32 v121, v121
    v_exp_f32 v122, v122
    v_exp_f32 v123, v123
    v_smfmac_f32_32x32x32_bf16 v[16:31], v[148:151], v[112:119], v214
    v_exp_f32 v124, v124
    v_exp_f32 v125, v125
    v_exp_f32 v126, v126
    v_exp_f32 v127, v127
    v_mfma_f32_32x32x8bf16_1k v[80:95], v[164:165], v[202:203], 0
    v_exp_f32 v64, v64
    v_exp_f32 v65, v65
    v_exp_f32 v66, v66
    v_exp_f32 v67, v67
    v_mfma_f32_32x32x16_bf16 v[80:95], v[156:159], v[188:191], v[80:95]
    v_exp_f32 v68, v68
    v_exp_f32 v69, v69
    v_exp_f32 v70, v70
    v_exp_f32 v71, v71
    v_smfmac_f32_32x32x32_bf16 v[16:31], v[152:155], v[120:127], v214
    v_exp_f32 v72, v72
    v_exp_f32 v73, v73
    v_exp_f32 v74, v74
    v_exp_f32 v75, v75
    v_smfmac_f32_32x32x32_bf16 v[0:15], v[168:171], v[64:71], v214
    v_exp_f32 v76, v76
    v_exp_f32 v77, v77
    v_exp_f32 v78, v78
    v_exp_f32 v79, v79
    v_mfma_f32_32x32x8bf16_1k v[96:111], v[166:167], v[200:201], 0
    v_exp_f32 v80, v80
    v_exp_f32 v81, v81
    v_exp_f32 v82, v82
    v_exp_f32 v83, v83
    v_mfma_f32_32x32x16_bf16 v[96:111], v[160:163], v[184:187], v[96:111]
    v_exp_f32 v84, v84
    v_exp_f32 v85, v85
    v_exp_f32 v86, v86
    v_exp_f32 v87, v87
    v_smfmac_f32_32x32x32_bf16 v[0:15], v[172:175], v[72:79], v214
    v_exp_f32 v88, v88
    v_exp_f32 v89, v89
    v_exp_f32 v90, v90
    v_exp_f32 v91, v91
    v_smfmac_f32_32x32x32_bf16 v[16:31], v[168:171], v[80:87], v214
    v_exp_f32 v92, v92
    v_exp_f32 v93, v93
    v_exp_f32 v94, v94
    v_exp_f32 v95, v95
    v_mfma_f32_32x32x8bf16_1k v[112:127], v[166:167], v[202:203], 0
    v_exp_f32 v96, v96
    v_exp_f32 v97, v97
    v_exp_f32 v98, v98
    v_exp_f32 v99, v99
    v_mfma_f32_32x32x16_bf16 v[112:127], v[160:163], v[188:191], v[112:127]
    v_exp_f32 v100, v100
    v_exp_f32 v101, v101
    v_exp_f32 v102, v102
    v_exp_f32 v103, v103
    v_smfmac_f32_32x32x32_bf16 v[16:31], v[172:175], v[88:95], v214
    v_exp_f32 v104, v104
    v_exp_f32 v105, v105
    v_exp_f32 v106, v106
    v_exp_f32 v107, v107
    s_waitcnt vmcnt(0)
    v_smfmac_f32_32x32x32_bf16 v[0:15], v[176:179], v[96:103], v214
    v_exp_f32 v108, v108
    v_exp_f32 v109, v109
    v_exp_f32 v110, v110
    v_exp_f32 v111, v111
    v_mfma_f32_32x32x8bf16_1k v[64:79], v[136:137], v[204:205], 0
    v_exp_f32 v112, v112
    v_exp_f32 v113, v113
    v_exp_f32 v114, v114
    v_exp_f32 v115, v115
    v_mfma_f32_32x32x16_bf16 v[64:79], v[128:131], v[192:195], v[64:79]
    v_exp_f32 v116, v116
    v_exp_f32 v117, v117
    v_exp_f32 v118, v118
    v_exp_f32 v119, v119
    v_smfmac_f32_32x32x32_bf16 v[0:15], v[180:183], v[104:111], v214
    v_exp_f32 v120, v120
    v_exp_f32 v121, v121
    v_exp_f32 v122, v122
    v_exp_f32 v123, v123
    v_smfmac_f32_32x32x32_bf16 v[16:31], v[176:179], v[112:119], v214
    v_exp_f32 v124, v124
    v_exp_f32 v125, v125
    v_exp_f32 v126, v126
    v_exp_f32 v127, v127
    v_mfma_f32_32x32x8bf16_1k v[80:95], v[136:137], v[206:207], 0
    v_exp_f32 v64, v64
    v_exp_f32 v65, v65
    v_exp_f32 v66, v66
    v_exp_f32 v67, v67
    v_mfma_f32_32x32x16_bf16 v[80:95], v[128:131], v[196:199], v[80:95]
    v_exp_f32 v68, v68
    v_exp_f32 v69, v69
    v_exp_f32 v70, v70
    v_exp_f32 v71, v71
    v_smfmac_f32_32x32x32_bf16 v[16:31], v[180:183], v[120:127], v214
    v_exp_f32 v72, v72
    v_exp_f32 v73, v73
    v_exp_f32 v74, v74
    v_exp_f32 v75, v75
    v_smfmac_f32_32x32x32_bf16 v[32:47], v[140:143], v[64:71], v214
    s_cbranch_scc1 L_nosend0
    ds_write_b64 v241, v[216:217] offset:6144
    ds_write_b128 v240, v[0:3] offset:0
    ds_write_b128 v240, v[4:7] offset:1024
    ds_write_b128 v240, v[8:11] offset:2048
L_nosend0:
    v_exp_f32 v76, v76
    v_exp_f32 v77, v77
    v_exp_f32 v78, v78
    v_exp_f32 v79, v79
    v_mfma_f32_32x32x8bf16_1k v[96:111], v[138:139], v[204:205], 0
    v_exp_f32 v80, v80
    v_exp_f32 v81, v81
    v_exp_f32 v82, v82
    v_exp_f32 v83, v83
    v_mfma_f32_32x32x16_bf16 v[96:111], v[132:135], v[192:195], v[96:111]
    v_exp_f32 v84, v84
    v_exp_f32 v85, v85
    v_exp_f32 v86, v86
    v_exp_f32 v87, v87
    v_smfmac_f32_32x32x32_bf16 v[32:47], v[144:147], v[72:79], v214
    s_cbranch_scc1 L_nosend1
    ds_write_b128 v240, v[16:19] offset:3072
    ds_write_b128 v240, v[20:23] offset:4096
    ds_write_b128 v240, v[24:27] offset:5120
L_nosend1:
    v_exp_f32 v88, v88
    v_exp_f32 v89, v89
    v_exp_f32 v90, v90
    v_exp_f32 v91, v91
    v_smfmac_f32_32x32x32_bf16 v[48:63], v[140:143], v[80:87], v214
    v_mov_b32 v234, 6
    v_min_f32 v232, v8, v24
    v_add_f32 v233, v8, v24
    v_cmp_nle_f32 s[38:39], s10, v232
    v_cmp_nge_f32 vcc, s11, v233
    s_or_b32 s39, s39, vcc_hi
    s_cbranch_scc1 L_fb1
L_ok1:
    ds_write_b32 v253, v234
    v_exp_f32 v92, v92
    v_exp_f32 v93, v93
    v_exp_f32 v94, v94
    v_exp_f32 v95, v95
    v_mfma_f32_32x32x8bf16_1k v[112:127], v[138:139], v[206:207], 0
    v_exp_f32 v96, v96
    v_exp_f32 v97, v97
    v_exp_f32 v98, v98
    v_exp_f32 v99, v99
    v_mfma_f32_32x32x16_bf16 v[112:127], v[132:135], v[196:199], v[112:127]
    v_exp_f32 v100, v100
    v_exp_f32 v101, v101
    v_exp_f32 v102, v102
    v_exp_f32 v103, v103
    v_smfmac_f32_32x32x32_bf16 v[48:63], v[144:147], v[88:95], v214
    v_exp_f32 v104, v104
    v_exp_f32 v105, v105
    v_exp_f32 v106, v106
    v_exp_f32 v107, v107
    v_smfmac_f32_32x32x32_bf16 v[32:47], v[148:151], v[96:103], v214
    v_exp_f32 v108, v108
    v_exp_f32 v109, v109
    v_exp_f32 v110, v110
    v_exp_f32 v111, v111
    v_mfma_f32_32x32x8bf16_1k v[64:79], v[164:165], v[204:205], 0
    v_exp_f32 v112, v112
    v_exp_f32 v113, v113
    v_exp_f32 v114, v114
    v_exp_f32 v115, v115
    v_mfma_f32_32x32x16_bf16 v[64:79], v[156:159], v[192:195], v[64:79]
    v_exp_f32 v116, v116
    v_exp_f32 v117, v117
    v_exp_f32 v118, v118
    v_exp_f32 v119, v119
    v_smfmac_f32_32x32x32_bf16 v[32:47], v[152:155], v[104:111], v214
    v_exp_f32 v120, v120
    v_exp_f32 v121, v121
    v_exp_f32 v122, v122
    v_exp_f32 v123, v123
    v_smfmac_f32_32x32x32_bf16 v[48:63], v[148:151], v[112:119], v214
    v_exp_f32 v124, v124
    v_exp_f32 v125, v125
    v_exp_f32 v126, v126
    v_exp_f32 v127, v127
    v_mfma_f32_32x32x8bf16_1k v[80:95], v[164:165], v[206:207], 0
    v_exp_f32 v64, v64
    v_exp_f32 v65, v65
    v_exp_f32 v66, v66
    v_exp_f32 v67, v67
    v_mfma_f32_32x32x16_bf16 v[80:95], v[156:159], v[196:199], v[80:95]
    v_exp_f32 v68, v68
    v_exp_f32 v69, v69
    v_exp_f32 v70, v70
    v_exp_f32 v71, v71
    v_smfmac_f32_32x32x32_bf16 v[48:63], v[152:155], v[120:127], v214
    v_exp_f32 v72, v72
    v_exp_f32 v73, v73
    v_exp_f32 v74, v74
    v_exp_f32 v75, v75
    v_smfmac_f32_32x32x32_bf16 v[32:47], v[168:171], v[64:71], v214
    v_exp_f32 v76, v76
    v_exp_f32 v77, v77
    v_exp_f32 v78, v78
    v_exp_f32 v79, v79
    v_mfma_f32_32x32x8bf16_1k v[96:111], v[166:167], v[204:205], 0
    ds_read_b32 v235, v244
    ds_read_b64 v[238:239], v243 offset:6144
    ds_read_b128 v[8:11], v242 offset:2048
    ds_read_b128 v[24:27], v242 offset:5120
    v_exp_f32 v80, v80
    v_exp_f32 v81, v81
    v_exp_f32 v82, v82
    v_exp_f32 v83, v83
    v_mfma_f32_32x32x16_bf16 v[96:111], v[160:163], v[192:195], v[96:111]
    ds_read_b128 v[0:3], v242 offset:0
    ds_read_b128 v[4:7], v242 offset:1024
    ds_read_b128 v[16:19], v242 offset:3072
    ds_read_b128 v[20:23], v242 offset:4096
    v_exp_f32 v84, v84
    v_exp_f32 v85, v85
    v_exp_f32 v86, v86
    v_exp_f32 v87, v87
    v_smfmac_f32_32x32x32_bf16 v[32:47], v[172:175], v[72:79], v214
    v_exp_f32 v88, v88
    v_exp_f32 v89, v89
    v_exp_f32 v90, v90
    v_exp_f32 v91, v91
    v_smfmac_f32_32x32x32_bf16 v[48:63], v[168:171], v[80:87], v214
    v_exp_f32 v92, v92
    v_exp_f32 v93, v93
    v_exp_f32 v94, v94
    v_exp_f32 v95, v95
    v_mfma_f32_32x32x8bf16_1k v[112:127], v[166:167], v[206:207], 0
    v_exp_f32 v96, v96
    v_exp_f32 v97, v97
    v_exp_f32 v98, v98
    v_exp_f32 v99, v99
    v_mfma_f32_32x32x16_bf16 v[112:127], v[160:163], v[196:199], v[112:127]
    v_exp_f32 v100, v100
    v_exp_f32 v101, v101
    v_exp_f32 v102, v102
    v_exp_f32 v103, v103
    v_smfmac_f32_32x32x32_bf16 v[48:63], v[172:175], v[88:95], v214
    v_exp_f32 v104, v104
    v_exp_f32 v105, v105
    v_exp_f32 v106, v106
    v_exp_f32 v107, v107
    v_smfmac_f32_32x32x32_bf16 v[32:47], v[176:179], v[96:103], v214
    v_exp_f32 v108, v108
    v_exp_f32 v109, v109
    v_exp_f32 v110, v110
    v_exp_f32 v111, v111
    v_exp_f32 v112, v112
    v_exp_f32 v113, v113
    v_exp_f32 v114, v114
    v_exp_f32 v115, v115
    v_exp_f32 v116, v116
    v_exp_f32 v117, v117
    v_exp_f32 v118, v118
    v_exp_f32 v119, v119
    v_smfmac_f32_32x32x32_bf16 v[32:47], v[180:183], v[104:111], v214
    v_exp_f32 v120, v120
    v_exp_f32 v121, v121
    v_exp_f32 v122, v122
    v_exp_f32 v123, v123
    v_smfmac_f32_32x32x32_bf16 v[48:63], v[176:179], v[112:119], v214
    v_exp_f32 v124, v124
    v_exp_f32 v125, v125
    v_exp_f32 v126, v126
    v_exp_f32 v127, v127
    s_waitcnt lgkmcnt(0)
    v_cmp_gt_u32 vcc, 6, v235
    v_smfmac_f32_32x32x32_bf16 v[48:63], v[180:183], v[120:127], v214
    s_cbranch_vccnz L_pwait
L_pready:
L_attok:
    v_min_f32 v224, v218, v238
    v_min_f32 v225, v219, v239
    v_sub_f32 v220, v224, v218
    v_sub_f32 v222, v224, v238
    v_sub_f32 v221, v225, v219
    v_sub_f32 v223, v225, v239
    v_exp_f32 v220, v220
    v_exp_f32 v222, v222
    v_exp_f32 v221, v221
    v_exp_f32 v223, v223
    s_nop 0
    v_min_f32 v232, v40, v56
    v_add_f32 v233, v40, v56
    v_cmp_nle_f32 s[38:39], s10, v232
    v_cmp_nge_f32 vcc, s11, v233
    s_or_b32 s39, s39, vcc_hi
    s_cbranch_scc1 L_fb2
L_ok2:
    v_mul_f32 v224, v220, v40
    v_mul_f32 v225, v221, v56
    v_fmac_f32 v224, v222, v8
    v_fmac_f32 v225, v223, v24
    v_mov_b32 v226, v224
    v_mov_b32 v227, v225
    s_nop 0
    v_permlane32_swap_b32 v224, v226
    v_permlane32_swap_b32 v225, v227
    v_rcp_f32 v226, v226
    v_rcp_f32 v227, v227
    s_waitcnt vmcnt(0) lgkmcnt(0)
    v_mul_f32 v220, v220, v226
    v_mul_f32 v222, v222, v226
    v_mul_f32 v221, v221, v227
    v_mul_f32 v223, v223, v227
    v_pk_mul_f32 v[32:33], v[220:221], v[32:33] op_sel:[0,0] op_sel_hi:[0,1]
    v_pk_mul_f32 v[34:35], v[220:221], v[34:35] op_sel:[0,0] op_sel_hi:[0,1]
    v_pk_mul_f32 v[36:37], v[220:221], v[36:37] op_sel:[0,0] op_sel_hi:[0,1]
    v_pk_mul_f32 v[38:39], v[220:221], v[38:39] op_sel:[0,0] op_sel_hi:[0,1]
    v_pk_mul_f32 v[40:41], v[220:221], v[40:41] op_sel:[0,0] op_sel_hi:[0,1]
    v_pk_mul_f32 v[42:43], v[220:221], v[42:43] op_sel:[0,0] op_sel_hi:[0,1]
    v_pk_fma_f32 v[32:33], v[222:223], v[0:1], v[32:33] op_sel:[0,0,0] op_sel_hi:[0,1,1]
    v_pk_fma_f32 v[34:35], v[222:223], v[2:3], v[34:35] op_sel:[0,0,0] op_sel_hi:[0,1,1]
    v_pk_fma_f32 v[36:37], v[222:223], v[4:5], v[36:37] op_sel:[0,0,0] op_sel_hi:[0,1,1]
    v_pk_fma_f32 v[38:39], v[222:223], v[6:7], v[38:39] op_sel:[0,0,0] op_sel_hi:[0,1,1]
    v_pk_fma_f32 v[40:41], v[222:223], v[8:9], v[40:41] op_sel:[0,0,0] op_sel_hi:[0,1,1]
    v_pk_fma_f32 v[42:43], v[222:223], v[10:11], v[42:43] op_sel:[0,0,0] op_sel_hi:[0,1,1]
    v_cvt_pk_bf16_f32 v64, v32, v33
    v_cvt_pk_bf16_f32 v65, v34, v35
    v_cvt_pk_bf16_f32 v66, v36, v37
    v_cvt_pk_bf16_f32 v67, v38, v39
    v_cvt_pk_bf16_f32 v68, v40, v41
    v_cvt_pk_bf16_f32 v69, v42, v43
    buffer_store_dwordx4 v[64:67], v246, s[44:47], s41 offen sc1
    v_pk_mul_f32 v[48:49], v[220:221], v[48:49] op_sel:[1,0] op_sel_hi:[1,1]
    v_pk_mul_f32 v[50:51], v[220:221], v[50:51] op_sel:[1,0] op_sel_hi:[1,1]
    v_pk_mul_f32 v[52:53], v[220:221], v[52:53] op_sel:[1,0] op_sel_hi:[1,1]
    v_pk_mul_f32 v[54:55], v[220:221], v[54:55] op_sel:[1,0] op_sel_hi:[1,1]
    v_pk_mul_f32 v[56:57], v[220:221], v[56:57] op_sel:[1,0] op_sel_hi:[1,1]
    v_pk_mul_f32 v[58:59], v[220:221], v[58:59] op_sel:[1,0] op_sel_hi:[1,1]
    v_pk_fma_f32 v[48:49], v[222:223], v[16:17], v[48:49] op_sel:[1,0,0] op_sel_hi:[1,1,1]
    v_pk_fma_f32 v[50:51], v[222:223], v[18:19], v[50:51] op_sel:[1,0,0] op_sel_hi:[1,1,1]
    v_pk_fma_f32 v[52:53], v[222:223], v[20:21], v[52:53] op_sel:[1,0,0] op_sel_hi:[1,1,1]
    v_pk_fma_f32 v[54:55], v[222:223], v[22:23], v[54:55] op_sel:[1,0,0] op_sel_hi:[1,1,1]
    v_pk_fma_f32 v[56:57], v[222:223], v[24:25], v[56:57] op_sel:[1,0,0] op_sel_hi:[1,1,1]
    v_pk_fma_f32 v[58:59], v[222:223], v[26:27], v[58:59] op_sel:[1,0,0] op_sel_hi:[1,1,1]
    v_cvt_pk_bf16_f32 v72, v48, v49
    v_cvt_pk_bf16_f32 v73, v50, v51
    v_cvt_pk_bf16_f32 v74, v52, v53
    v_cvt_pk_bf16_f32 v75, v54, v55
    v_cvt_pk_bf16_f32 v76, v56, v57
    v_cvt_pk_bf16_f32 v77, v58, v59
    buffer_store_dwordx4 v[72:75], v246, s[44:47], s42 offen sc1
    s_nop 0
    v_permlane32_swap_b32 v68, v76
    v_permlane32_swap_b32 v69, v77
    buffer_store_dwordx2 v[68:69], v247, s[44:47], s40 offen offset:512 sc1
L_stored:
    v_mov_b32 v232, 8
    ds_write_b32 v253, v232
    ds_read_b32 v99, v249
L_pw_44:
    ds_read_b32 v98, v245
    s_waitcnt lgkmcnt(0)
    v_cmp_gt_u32 vcc, 14, v98
    s_cbranch_vccnz L_pwr_45
    v_lshrrev_b32 v21, 5, v254
    v_bfe_u32 v22, v254, 2, 3
    v_lshl_add_u32 v21, v21, 4, v22
    v_mul_u32_u24 v21, 160, v21
    v_and_b32 v22, 3, v254
    v_lshl_add_u32 v240, v22, 3, v21
    v_add_u32 v241, 51200, v240
    v_lshlrev_b32 v242, 4, v254
    v_lshrrev_b32 v21, 4, v254
    v_mul_u32_u24 v21, 20480, v21
    v_and_b32 v22, 15, v254
    v_lshl_add_u32 v244, v22, 2, v21
    s_and_b32 s12, s69, 1
    s_xor_b32 s13, s12, 1
    s_lshl_b32 s14, s13, 7
    v_add_u32 v246, s14, v240
    v_add_u32 v247, s14, v241
    s_lshl_b32 s14, s12, 5
    v_add_u32 v240, s14, v240
    v_add_u32 v241, s14, v241
    s_lshl_b32 s14, s13, 8
    v_add_u32 v244, s14, v244
L_pgO:
    v_lshrrev_b32 v21, 5, v254
    v_mul_u32_u24 v21, 40960, v21
    v_and_b32 v22, 31, v254
    v_lshl_add_u32 v21, v22, 2, v21
    s_lshl_b32 s14, s12, 6
    v_add_u32 v245, s14, v21
    s_mul_i32 s84, s69, 2560
    v_min_u32 v248, 19, v254
    v_lshl_add_u32 v248, v248, 7, s84
    s_lshl2_add_u32 s84, s68, s34
    s_mul_i32 s85, s84, 20480
    s_add_u32 s85, s85, 0xd00000
    s_mul_i32 s86, s84, 81920
    s_mul_i32 s88, s69, 320
    s_add_u32 s86, s86, s88
    s_add_u32 s4, s86, 0
    s_add_u32 s5, s86, 5120
    s_add_u32 s6, s86, 10240
    s_add_u32 s7, s86, 15360
    s_add_u32 s8, s86, 20480
    s_add_u32 s9, s86, 25600
    s_add_u32 s10, s86, 30720
    s_add_u32 s11, s86, 35840
    v_lshlrev_b32 v243, 7, v254
    s_lshl_b32 s88, s68, 12
    s_add_u32 s88, s88, 0xfc8000
    s_waitcnt vmcnt(0)
    v_mov_b32 v1, 1
    s_mov_b64 exec, 1
    buffer_store_dword v1, off, s[44:47], s43 sc1
    s_mov_b64 exec, -1
    ds_read_b64_tr_b16 v[100:101], v240 offset:0
    ds_read_b64_tr_b16 v[102:103], v240 offset:1280
    ds_read_b64_tr_b16 v[104:105], v240 offset:32
    ds_read_b64_tr_b16 v[106:107], v240 offset:1312
    ds_read_b64_tr_b16 v[108:109], v240 offset:64
    ds_read_b64_tr_b16 v[110:111], v240 offset:1344
    ds_read_b64_tr_b16 v[112:113], v240 offset:96
    ds_read_b64_tr_b16 v[114:115], v240 offset:1376
    ds_read_b64_tr_b16 v[116:117], v246 offset:0
    ds_read_b64_tr_b16 v[118:119], v246 offset:1280
    ds_read_b64_tr_b16 v[120:121], v240 offset:5120
    ds_read_b64_tr_b16 v[122:123], v240 offset:6400
    ds_read_b64_tr_b16 v[124:125], v240 offset:5152
    ds_read_b64_tr_b16 v[126:127], v240 offset:6432
    ds_read_b64_tr_b16 v[128:129], v240 offset:5184
    ds_read_b64_tr_b16 v[130:131], v240 offset:6464
    ds_read_b64_tr_b16 v[132:133], v240 offset:5216
    ds_read_b64_tr_b16 v[134:135], v240 offset:6496
    ds_read_b64_tr_b16 v[136:137], v246 offset:5120
    ds_read_b64_tr_b16 v[138:139], v246 offset:6400
    ds_read_b64_tr_b16 v[140:141], v240 offset:10240
    ds_read_b64_tr_b16 v[142:143], v240 offset:11520
    ds_read_b64_tr_b16 v[144:145], v240 offset:10272
    ds_read_b64_tr_b16 v[146:147], v240 offset:11552
    ds_read_b64_tr_b16 v[148:149], v240 offset:10304
    ds_read_b64_tr_b16 v[150:151], v240 offset:11584
    ds_read_b64_tr_b16 v[152:153], v240 offset:10336
    ds_read_b64_tr_b16 v[154:155], v240 offset:11616
    ds_read_b64_tr_b16 v[156:157], v246 offset:10240
    ds_read_b64_tr_b16 v[158:159], v246 offset:11520
    ds_read_b64_tr_b16 v[160:161], v240 offset:15360
    ds_read_b64_tr_b16 v[162:163], v240 offset:16640
    ds_read_b64_tr_b16 v[164:165], v240 offset:15392
    ds_read_b64_tr_b16 v[166:167], v240 offset:16672
    ds_read_b64_tr_b16 v[168:169], v240 offset:15424
    ds_read_b64_tr_b16 v[170:171], v240 offset:16704
    ds_read_b64_tr_b16 v[172:173], v240 offset:15456
    ds_read_b64_tr_b16 v[174:175], v240 offset:16736
    ds_read_b64_tr_b16 v[176:177], v246 offset:15360
    ds_read_b64_tr_b16 v[178:179], v246 offset:16640
    ds_read_b64_tr_b16 v[180:181], v240 offset:20480
    ds_read_b64_tr_b16 v[182:183], v240 offset:21760
    ds_read_b64_tr_b16 v[184:185], v240 offset:20512
    ds_read_b64_tr_b16 v[186:187], v240 offset:21792
    ds_read_b64_tr_b16 v[188:189], v240 offset:20544
    ds_read_b64_tr_b16 v[190:191], v240 offset:21824
    ds_read_b64_tr_b16 v[192:193], v240 offset:20576
    ds_read_b64_tr_b16 v[194:195], v240 offset:21856
    ds_read_b64_tr_b16 v[196:197], v246 offset:20480
    ds_read_b64_tr_b16 v[198:199], v246 offset:21760
    ds_read_b64_tr_b16 v[200:201], v240 offset:25600
    ds_read_b64_tr_b16 v[202:203], v240 offset:26880
    ds_read_b64_tr_b16 v[204:205], v240 offset:25632
    ds_read_b64_tr_b16 v[206:207], v240 offset:26912
    ds_read_b64_tr_b16 v[208:209], v240 offset:25664
    ds_read_b64_tr_b16 v[210:211], v240 offset:26944
    ds_read_b64_tr_b16 v[212:213], v240 offset:25696
    ds_read_b64_tr_b16 v[214:215], v240 offset:26976
    ds_read_b64_tr_b16 v[216:217], v246 offset:25600
    ds_read_b64_tr_b16 v[218:219], v246 offset:26880
    ds_read_b64_tr_b16 v[220:221], v240 offset:30720
    ds_read_b64_tr_b16 v[222:223], v240 offset:32000
    ds_read_b64_tr_b16 v[224:225], v240 offset:30752
    ds_read_b64_tr_b16 v[226:227], v240 offset:32032
    ds_read_b64_tr_b16 v[228:229], v240 offset:30784
    ds_read_b64_tr_b16 v[230:231], v240 offset:32064
    ds_read_b64_tr_b16 v[232:233], v240 offset:30816
    ds_read_b64_tr_b16 v[234:235], v240 offset:32096
    ds_read_b64_tr_b16 v[236:237], v246 offset:30720
    ds_read_b64_tr_b16 v[238:239], v246 offset:32000
    s_mov_b64 s[38:39], vcc
L_pw_46:
    ds_read_b32 v99, v249
    s_sub_u32 s96, s96, 1
    s_cbranch_scc1 L_exit
    s_waitcnt lgkmcnt(0)
    v_cmp_gt_u32 vcc, 8, v99
    s_cbranch_vccnz L_pw_46
    s_mov_b64 vcc, s[38:39]
    s_mov_b32 exec_hi, 0
L_pf_48:
    buffer_load_dword v252, v243, s[44:47], s88 offen sc1
    s_sub_u32 s96, s96, 1
    s_cbranch_scc1 L_exit
    s_waitcnt vmcnt(0)
    v_cmp_eq_u32 vcc, 0, v252
    s_and_b64 exec, exec, vcc
    s_cbranch_scc1 L_pf_48
    s_mov_b64 exec, -1
    buffer_load_dword v251, v248, s[44:47], s85 offen sc1
    buffer_load_dwordx4 v[0:3], v242, s[44:47], s85 offen offset:0 sc1
    buffer_load_dwordx4 v[4:7], v242, s[44:47], s85 offen offset:1024 sc1
    buffer_load_dwordx4 v[8:11], v242, s[44:47], s85 offen offset:2048 sc1
    buffer_load_dwordx4 v[12:15], v242, s[44:47], s85 offen offset:3072 sc1
    s_add_u32 s85, s85, 4096
    buffer_load_dwordx4 v[16:19], v242, s[44:47], s85 offen offset:0 sc1
    buffer_load_dwordx4 v[20:23], v242, s[44:47], s85 offen offset:1024 sc1
    buffer_load_dwordx4 v[24:27], v242, s[44:47], s85 offen offset:2048 sc1
    buffer_load_dwordx4 v[28:31], v242, s[44:47], s85 offen offset:3072 sc1
    s_add_u32 s85, s85, 4096
    buffer_load_dwordx4 v[32:35], v242, s[44:47], s85 offen offset:0 sc1
    buffer_load_dwordx4 v[36:39], v242, s[44:47], s85 offen offset:1024 sc1
    buffer_load_dwordx4 v[40:43], v242, s[44:47], s85 offen offset:2048 sc1
    buffer_load_dwordx4 v[44:47], v242, s[44:47], s85 offen offset:3072 sc1
    s_add_u32 s85, s85, 4096
    buffer_load_dwordx4 v[48:51], v242, s[44:47], s85 offen offset:0 sc1
    buffer_load_dwordx4 v[52:55], v242, s[44:47], s85 offen offset:1024 sc1
    buffer_load_dwordx4 v[56:59], v242, s[44:47], s85 offen offset:2048 sc1
    buffer_load_dwordx4 v[60:63], v242, s[44:47], s85 offen offset:3072 sc1
    s_add_u32 s85, s85, 4096
    buffer_load_dwordx4 v[64:67], v242, s[44:47], s85 offen offset:0 sc1
    buffer_load_dwordx4 v[68:71], v242, s[44:47], s85 offen offset:1024 sc1
    buffer_load_dwordx4 v[72:75], v242, s[44:47], s85 offen offset:2048 sc1
    buffer_load_dwordx4 v[76:79], v242, s[44:47], s85 offen offset:3072 sc1
L_p3go:
    s_waitcnt lgkmcnt(0)
    v_mov_b32 v250, 9
    ds_write_b32 v253, v250
    s_waitcnt vmcnt(19)
    v_mfma_f32_16x16x32_bf16 v[80:83], v[0:3], v[100:103], 0
    v_mfma_f32_16x16x32_bf16 v[84:87], v[0:3], v[104:107], 0
    ds_read_b64_tr_b16 v[100:101], v240 offset:35840
    ds_read_b64_tr_b16 v[102:103], v240 offset:37120
    v_mfma_f32_16x16x32_bf16 v[88:91], v[0:3], v[108:111], 0
    ds_read_b64_tr_b16 v[104:105], v240 offset:35872
    ds_read_b64_tr_b16 v[106:107], v240 offset:37152
    v_mfma_f32_16x16x32_bf16 v[92:95], v[0:3], v[112:115], 0
    ds_read_b64_tr_b16 v[108:109], v240 offset:35904
    ds_read_b64_tr_b16 v[110:111], v240 offset:37184
    v_mfma_f32_16x16x32_bf16 v[96:99], v[0:3], v[116:119], 0
    ds_read_b64_tr_b16 v[112:113], v240 offset:35936
    ds_read_b64_tr_b16 v[114:115], v240 offset:37216
    s_waitcnt vmcnt(18)
    v_mfma_f32_16x16x32_bf16 v[80:83], v[4:7], v[120:123], v[80:83]
    ds_read_b64_tr_b16 v[116:117], v246 offset:35840
    ds_read_b64_tr_b16 v[118:119], v246 offset:37120
    v_mfma_f32_16x16x32_bf16 v[84:87], v[4:7], v[124:127], v[84:87]
    ds_read_b64_tr_b16 v[120:121], v240 offset:40960
    ds_read_b64_tr_b16 v[122:123], v240 offset:42240
    v_mfma_f32_16x16x32_bf16 v[88:91], v[4:7], v[128:131], v[88:91]
    ds_read_b64_tr_b16 v[124:125], v240 offset:40992
    ds_read_b64_tr_b16 v[126:127], v240 offset:42272
    v_mfma_f32_16x16x32_bf16 v[92:95], v[4:7], v[132:135], v[92:95]
    ds_read_b64_tr_b16 v[128:129], v240 offset:41024
    ds_read_b64_tr_b16 v[130:131], v240 offset:42304
    v_mfma_f32_16x16x32_bf16 v[96:99], v[4:7], v[136:139], v[96:99]
    ds_read_b64_tr_b16 v[132:133], v240 offset:41056
    ds_read_b64_tr_b16 v[134:135], v240 offset:42336
    s_waitcnt vmcnt(17)
    v_mfma_f32_16x16x32_bf16 v[80:83], v[8:11], v[140:143], v[80:83]
    ds_read_b64_tr_b16 v[136:137], v246 offset:40960
    ds_read_b64_tr_b16 v[138:139], v246 offset:42240
    v_mfma_f32_16x16x32_bf16 v[84:87], v[8:11], v[144:147], v[84:87]
    ds_read_b64_tr_b16 v[140:141], v240 offset:46080
    ds_read_b64_tr_b16 v[142:143], v240 offset:47360
    v_mfma_f32_16x16x32_bf16 v[88:91], v[8:11], v[148:151], v[88:91]
    ds_read_b64_tr_b16 v[144:145], v240 offset:46112
    ds_read_b64_tr_b16 v[146:147], v240 offset:47392
    v_mfma_f32_16x16x32_bf16 v[92:95], v[8:11], v[152:155], v[92:95]
    ds_read_b64_tr_b16 v[148:149], v240 offset:46144
    ds_read_b64_tr_b16 v[150:151], v240 offset:47424
    v_mfma_f32_16x16x32_bf16 v[96:99], v[8:11], v[156:159], v[96:99]
    ds_read_b64_tr_b16 v[152:153], v240 offset:46176
    ds_read_b64_tr_b16 v[154:155], v240 offset:47456
    s_waitcnt vmcnt(16)
    v_mfma_f32_16x16x32_bf16 v[80:83], v[12:15], v[160:163], v[80:83]
    ds_read_b64_tr_b16 v[156:157], v246 offset:46080
    ds_read_b64_tr_b16 v[158:159], v246 offset:47360
    v_mfma_f32_16x16x32_bf16 v[84:87], v[12:15], v[164:167], v[84:87]
    ds_read_b64_tr_b16 v[160:161], v241 offset:0
    ds_read_b64_tr_b16 v[162:163], v241 offset:1280
    v_mfma_f32_16x16x32_bf16 v[88:91], v[12:15], v[168:171], v[88:91]
    ds_read_b64_tr_b16 v[164:165], v241 offset:32
    ds_read_b64_tr_b16 v[166:167], v241 offset:1312
    v_mfma_f32_16x16x32_bf16 v[92:95], v[12:15], v[172:175], v[92:95]
    ds_read_b64_tr_b16 v[168:169], v241 offset:64
    ds_read_b64_tr_b16 v[170:171], v241 offset:1344
    v_mfma_f32_16x16x32_bf16 v[96:99], v[12:15], v[176:179], v[96:99]
    ds_read_b64_tr_b16 v[172:173], v241 offset:96
    ds_read_b64_tr_b16 v[174:175], v241 offset:1376
    s_waitcnt vmcnt(15)
    v_mfma_f32_16x16x32_bf16 v[80:83], v[16:19], v[180:183], v[80:83]
    ds_read_b64_tr_b16 v[176:177], v247 offset:0
    ds_read_b64_tr_b16 v[178:179], v247 offset:1280
    v_mfma_f32_16x16x32_bf16 v[84:87], v[16:19], v[184:187], v[84:87]
    ds_read_b64_tr_b16 v[180:181], v241 offset:5120
    ds_read_b64_tr_b16 v[182:183], v241 offset:6400
    v_mfma_f32_16x16x32_bf16 v[88:91], v[16:19], v[188:191], v[88:91]
    ds_read_b64_tr_b16 v[184:185], v241 offset:5152
    ds_read_b64_tr_b16 v[186:187], v241 offset:6432
    v_mfma_f32_16x16x32_bf16 v[92:95], v[16:19], v[192:195], v[92:95]
    ds_read_b64_tr_b16 v[188:189], v241 offset:5184
    ds_read_b64_tr_b16 v[190:191], v241 offset:6464
    v_mfma_f32_16x16x32_bf16 v[96:99], v[16:19], v[196:199], v[96:99]
    ds_read_b64_tr_b16 v[192:193], v241 offset:5216
    ds_read_b64_tr_b16 v[194:195], v241 offset:6496
    s_waitcnt vmcnt(14)
    v_mfma_f32_16x16x32_bf16 v[80:83], v[20:23], v[200:203], v[80:83]
    ds_read_b64_tr_b16 v[196:197], v247 offset:5120
    ds_read_b64_tr_b16 v[198:199], v247 offset:6400
    v_mfma_f32_16x16x32_bf16 v[84:87], v[20:23], v[204:207], v[84:87]
    ds_read_b64_tr_b16 v[200:201], v241 offset:10240
    ds_read_b64_tr_b16 v[202:203], v241 offset:11520
    v_mfma_f32_16x16x32_bf16 v[88:91], v[20:23], v[208:211], v[88:91]
    ds_read_b64_tr_b16 v[204:205], v241 offset:10272
    ds_read_b64_tr_b16 v[206:207], v241 offset:11552
    v_mfma_f32_16x16x32_bf16 v[92:95], v[20:23], v[212:215], v[92:95]
    ds_read_b64_tr_b16 v[208:209], v241 offset:10304
    ds_read_b64_tr_b16 v[210:211], v241 offset:11584
    v_mfma_f32_16x16x32_bf16 v[96:99], v[20:23], v[216:219], v[96:99]
    ds_read_b64_tr_b16 v[212:213], v241 offset:10336
    ds_read_b64_tr_b16 v[214:215], v241 offset:11616
    s_waitcnt vmcnt(13)
    v_mfma_f32_16x16x32_bf16 v[80:83], v[24:27], v[220:223], v[80:83]
    ds_read_b64_tr_b16 v[216:217], v247 offset:10240
    ds_read_b64_tr_b16 v[218:219], v247 offset:11520
    v_mfma_f32_16x16x32_bf16 v[84:87], v[24:27], v[224:227], v[84:87]
    ds_read_b64_tr_b16 v[220:221], v241 offset:15360
    ds_read_b64_tr_b16 v[222:223], v241 offset:16640
    v_mfma_f32_16x16x32_bf16 v[88:91], v[24:27], v[228:231], v[88:91]
    ds_read_b64_tr_b16 v[224:225], v241 offset:15392
    ds_read_b64_tr_b16 v[226:227], v241 offset:16672
    v_mfma_f32_16x16x32_bf16 v[92:95], v[24:27], v[232:235], v[92:95]
    ds_read_b64_tr_b16 v[228:229], v241 offset:15424
    ds_read_b64_tr_b16 v[230:231], v241 offset:16704
    v_mfma_f32_16x16x32_bf16 v[96:99], v[24:27], v[236:239], v[96:99]
    ds_read_b64_tr_b16 v[232:233], v241 offset:15456
    ds_read_b64_tr_b16 v[234:235], v241 offset:16736
    s_waitcnt vmcnt(12) lgkmcnt(15)
    v_mfma_f32_16x16x32_bf16 v[80:83], v[28:31], v[100:103], v[80:83]
    ds_read_b64_tr_b16 v[236:237], v247 offset:15360
    ds_read_b64_tr_b16 v[238:239], v247 offset:16640
    v_mfma_f32_16x16x32_bf16 v[84:87], v[28:31], v[104:107], v[84:87]
    ds_read_b64_tr_b16 v[100:101], v241 offset:20480
    ds_read_b64_tr_b16 v[102:103], v241 offset:21760
    v_mfma_f32_16x16x32_bf16 v[88:91], v[28:31], v[108:111], v[88:91]
    ds_read_b64_tr_b16 v[104:105], v241 offset:20512
    ds_read_b64_tr_b16 v[106:107], v241 offset:21792
    v_mfma_f32_16x16x32_bf16 v[92:95], v[28:31], v[112:115], v[92:95]
    ds_read_b64_tr_b16 v[108:109], v241 offset:20544
    ds_read_b64_tr_b16 v[110:111], v241 offset:21824
    v_mfma_f32_16x16x32_bf16 v[96:99], v[28:31], v[116:119], v[96:99]
    ds_read_b64_tr_b16 v[112:113], v241 offset:20576
    ds_read_b64_tr_b16 v[114:115], v241 offset:21856
    s_waitcnt vmcnt(11) lgkmcnt(15)
    v_mfma_f32_16x16x32_bf16 v[80:83], v[32:35], v[120:123], v[80:83]
    ds_read_b64_tr_b16 v[116:117], v247 offset:20480
    ds_read_b64_tr_b16 v[118:119], v247 offset:21760
    v_mfma_f32_16x16x32_bf16 v[84:87], v[32:35], v[124:127], v[84:87]
    ds_read_b64_tr_b16 v[120:121], v241 offset:25600
    ds_read_b64_tr_b16 v[122:123], v241 offset:26880
    v_mfma_f32_16x16x32_bf16 v[88:91], v[32:35], v[128:131], v[88:91]
    ds_read_b64_tr_b16 v[124:125], v241 offset:25632
    ds_read_b64_tr_b16 v[126:127], v241 offset:26912
    v_mfma_f32_16x16x32_bf16 v[92:95], v[32:35], v[132:135], v[92:95]
    ds_read_b64_tr_b16 v[128:129], v241 offset:25664
    ds_read_b64_tr_b16 v[130:131], v241 offset:26944
    v_mfma_f32_16x16x32_bf16 v[96:99], v[32:35], v[136:139], v[96:99]
    ds_read_b64_tr_b16 v[132:133], v241 offset:25696
    ds_read_b64_tr_b16 v[134:135], v241 offset:26976
    s_waitcnt vmcnt(10) lgkmcnt(15)
    v_mfma_f32_16x16x32_bf16 v[80:83], v[36:39], v[140:143], v[80:83]
    ds_read_b64_tr_b16 v[136:137], v247 offset:25600
    ds_read_b64_tr_b16 v[138:139], v247 offset:26880
    v_mfma_f32_16x16x32_bf16 v[84:87], v[36:39], v[144:147], v[84:87]
    ds_read_b64_tr_b16 v[140:141], v241 offset:30720
    ds_read_b64_tr_b16 v[142:143], v241 offset:32000
    v_mfma_f32_16x16x32_bf16 v[88:91], v[36:39], v[148:151], v[88:91]
    ds_read_b64_tr_b16 v[144:145], v241 offset:30752
    ds_read_b64_tr_b16 v[146:147], v241 offset:32032
    v_mfma_f32_16x16x32_bf16 v[92:95], v[36:39], v[152:155], v[92:95]
    ds_read_b64_tr_b16 v[148:149], v241 offset:30784
    ds_read_b64_tr_b16 v[150:151], v241 offset:32064
    v_mfma_f32_16x16x32_bf16 v[96:99], v[36:39], v[156:159], v[96:99]
    ds_read_b64_tr_b16 v[152:153], v241 offset:30816
    ds_read_b64_tr_b16 v[154:155], v241 offset:32096
    s_waitcnt vmcnt(9) lgkmcnt(15)
    v_mfma_f32_16x16x32_bf16 v[80:83], v[40:43], v[160:163], v[80:83]
    ds_read_b64_tr_b16 v[156:157], v247 offset:30720
    ds_read_b64_tr_b16 v[158:159], v247 offset:32000
    v_mfma_f32_16x16x32_bf16 v[84:87], v[40:43], v[164:167], v[84:87]
    ds_read_b64_tr_b16 v[160:161], v241 offset:35840
    ds_read_b64_tr_b16 v[162:163], v241 offset:37120
    v_mfma_f32_16x16x32_bf16 v[88:91], v[40:43], v[168:171], v[88:91]
    ds_read_b64_tr_b16 v[164:165], v241 offset:35872
    ds_read_b64_tr_b16 v[166:167], v241 offset:37152
    v_mfma_f32_16x16x32_bf16 v[92:95], v[40:43], v[172:175], v[92:95]
    ds_read_b64_tr_b16 v[168:169], v241 offset:35904
    ds_read_b64_tr_b16 v[170:171], v241 offset:37184
    v_mfma_f32_16x16x32_bf16 v[96:99], v[40:43], v[176:179], v[96:99]
    ds_read_b64_tr_b16 v[172:173], v241 offset:35936
    ds_read_b64_tr_b16 v[174:175], v241 offset:37216
    s_waitcnt vmcnt(8) lgkmcnt(15)
    v_mfma_f32_16x16x32_bf16 v[80:83], v[44:47], v[180:183], v[80:83]
    ds_read_b64_tr_b16 v[176:177], v247 offset:35840
    ds_read_b64_tr_b16 v[178:179], v247 offset:37120
    v_mfma_f32_16x16x32_bf16 v[84:87], v[44:47], v[184:187], v[84:87]
    ds_read_b64_tr_b16 v[180:181], v241 offset:40960
    ds_read_b64_tr_b16 v[182:183], v241 offset:42240
    v_mfma_f32_16x16x32_bf16 v[88:91], v[44:47], v[188:191], v[88:91]
    ds_read_b64_tr_b16 v[184:185], v241 offset:40992
    ds_read_b64_tr_b16 v[186:187], v241 offset:42272
    v_mfma_f32_16x16x32_bf16 v[92:95], v[44:47], v[192:195], v[92:95]
    ds_read_b64_tr_b16 v[188:189], v241 offset:41024
    ds_read_b64_tr_b16 v[190:191], v241 offset:42304
    v_mfma_f32_16x16x32_bf16 v[96:99], v[44:47], v[196:199], v[96:99]
    ds_read_b64_tr_b16 v[192:193], v241 offset:41056
    ds_read_b64_tr_b16 v[194:195], v241 offset:42336
    s_waitcnt vmcnt(7) lgkmcnt(15)
    v_mfma_f32_16x16x32_bf16 v[80:83], v[48:51], v[200:203], v[80:83]
    ds_read_b64_tr_b16 v[196:197], v247 offset:40960
    ds_read_b64_tr_b16 v[198:199], v247 offset:42240
    v_mfma_f32_16x16x32_bf16 v[84:87], v[48:51], v[204:207], v[84:87]
    ds_read_b64_tr_b16 v[200:201], v241 offset:46080
    ds_read_b64_tr_b16 v[202:203], v241 offset:47360
    v_mfma_f32_16x16x32_bf16 v[88:91], v[48:51], v[208:211], v[88:91]
    ds_read_b64_tr_b16 v[204:205], v241 offset:46112
    ds_read_b64_tr_b16 v[206:207], v241 offset:47392
    v_mfma_f32_16x16x32_bf16 v[92:95], v[48:51], v[212:215], v[92:95]
    ds_read_b64_tr_b16 v[208:209], v241 offset:46144
    ds_read_b64_tr_b16 v[210:211], v241 offset:47424
    v_mfma_f32_16x16x32_bf16 v[96:99], v[48:51], v[216:219], v[96:99]
    ds_read_b64_tr_b16 v[212:213], v241 offset:46176
    ds_read_b64_tr_b16 v[214:215], v241 offset:47456
    s_waitcnt vmcnt(6) lgkmcnt(15)
    v_mfma_f32_16x16x32_bf16 v[80:83], v[52:55], v[220:223], v[80:83]
    ds_read_b64_tr_b16 v[216:217], v247 offset:46080
    ds_read_b64_tr_b16 v[218:219], v247 offset:47360
    v_mfma_f32_16x16x32_bf16 v[84:87], v[52:55], v[224:227], v[84:87]
    v_mfma_f32_16x16x32_bf16 v[88:91], v[52:55], v[228:231], v[88:91]
    v_mfma_f32_16x16x32_bf16 v[92:95], v[52:55], v[232:235], v[92:95]
    v_mfma_f32_16x16x32_bf16 v[96:99], v[52:55], v[236:239], v[96:99]
    s_waitcnt vmcnt(5) lgkmcnt(15)
    v_mfma_f32_16x16x32_bf16 v[80:83], v[56:59], v[100:103], v[80:83]
    v_mfma_f32_16x16x32_bf16 v[84:87], v[56:59], v[104:107], v[84:87]
    v_mfma_f32_16x16x32_bf16 v[88:91], v[56:59], v[108:111], v[88:91]
    v_mfma_f32_16x16x32_bf16 v[92:95], v[56:59], v[112:115], v[92:95]
    v_mfma_f32_16x16x32_bf16 v[96:99], v[56:59], v[116:119], v[96:99]
    s_waitcnt vmcnt(4) lgkmcnt(15)
    v_mfma_f32_16x16x32_bf16 v[80:83], v[60:63], v[120:123], v[80:83]
    v_mfma_f32_16x16x32_bf16 v[84:87], v[60:63], v[124:127], v[84:87]
    v_mfma_f32_16x16x32_bf16 v[88:91], v[60:63], v[128:131], v[88:91]
    v_mfma_f32_16x16x32_bf16 v[92:95], v[60:63], v[132:135], v[92:95]
    v_mfma_f32_16x16x32_bf16 v[96:99], v[60:63], v[136:139], v[96:99]
    s_waitcnt vmcnt(3) lgkmcnt(15)
    v_mfma_f32_16x16x32_bf16 v[80:83], v[64:67], v[140:143], v[80:83]
    v_mfma_f32_16x16x32_bf16 v[84:87], v[64:67], v[144:147], v[84:87]
    v_mfma_f32_16x16x32_bf16 v[88:91], v[64:67], v[148:151], v[88:91]
    v_mfma_f32_16x16x32_bf16 v[92:95], v[64:67], v[152:155], v[92:95]
    v_mfma_f32_16x16x32_bf16 v[96:99], v[64:67], v[156:159], v[96:99]
    s_waitcnt vmcnt(2) lgkmcnt(15)
    v_mfma_f32_16x16x32_bf16 v[80:83], v[68:71], v[160:163], v[80:83]
    v_mfma_f32_16x16x32_bf16 v[84:87], v[68:71], v[164:167], v[84:87]
    v_mfma_f32_16x16x32_bf16 v[88:91], v[68:71], v[168:171], v[88:91]
    v_mfma_f32_16x16x32_bf16 v[92:95], v[68:71], v[172:175], v[92:95]
    v_mfma_f32_16x16x32_bf16 v[96:99], v[68:71], v[176:179], v[96:99]
    s_waitcnt vmcnt(1) lgkmcnt(10)
    v_mfma_f32_16x16x32_bf16 v[80:83], v[72:75], v[180:183], v[80:83]
    v_mfma_f32_16x16x32_bf16 v[84:87], v[72:75], v[184:187], v[84:87]
    v_mfma_f32_16x16x32_bf16 v[88:91], v[72:75], v[188:191], v[88:91]
    v_mfma_f32_16x16x32_bf16 v[92:95], v[72:75], v[192:195], v[92:95]
    v_mfma_f32_16x16x32_bf16 v[96:99], v[72:75], v[196:199], v[96:99]
    s_waitcnt vmcnt(0) lgkmcnt(0)
    v_mfma_f32_16x16x32_bf16 v[80:83], v[76:79], v[200:203], v[80:83]
    v_mfma_f32_16x16x32_bf16 v[84:87], v[76:79], v[204:207], v[84:87]
    v_mfma_f32_16x16x32_bf16 v[88:91], v[76:79], v[208:211], v[88:91]
    v_mfma_f32_16x16x32_bf16 v[92:95], v[76:79], v[212:215], v[92:95]
    v_mfma_f32_16x16x32_bf16 v[96:99], v[76:79], v[216:219], v[96:99]
    s_nop 4
    v_permlane16_swap_b32 v80, v84
    v_permlane16_swap_b32 v81, v85
    v_permlane16_swap_b32 v82, v86
    v_permlane16_swap_b32 v83, v87
    buffer_store_dword v80, v245, s[52:55], s4 offen offset:0 sc1
    buffer_store_dword v81, v245, s[52:55], s5 offen offset:0 sc1
    buffer_store_dword v82, v245, s[52:55], s6 offen offset:0 sc1
    buffer_store_dword v83, v245, s[52:55], s7 offen offset:0 sc1
    buffer_store_dword v84, v245, s[52:55], s8 offen offset:0 sc1
    buffer_store_dword v85, v245, s[52:55], s9 offen offset:0 sc1
    buffer_store_dword v86, v245, s[52:55], s10 offen offset:0 sc1
    buffer_store_dword v87, v245, s[52:55], s11 offen offset:0 sc1
    v_permlane16_swap_b32 v88, v92
    v_permlane16_swap_b32 v89, v93
    v_permlane16_swap_b32 v90, v94
    v_permlane16_swap_b32 v91, v95
    buffer_store_dword v88, v245, s[52:55], s4 offen offset:128 sc1
    buffer_store_dword v89, v245, s[52:55], s5 offen offset:128 sc1
    buffer_store_dword v90, v245, s[52:55], s6 offen offset:128 sc1
    buffer_store_dword v91, v245, s[52:55], s7 offen offset:128 sc1
    buffer_store_dword v92, v245, s[52:55], s8 offen offset:128 sc1
    buffer_store_dword v93, v245, s[52:55], s9 offen offset:128 sc1
    buffer_store_dword v94, v245, s[52:55], s10 offen offset:128 sc1
    buffer_store_dword v95, v245, s[52:55], s11 offen offset:128 sc1
    buffer_store_dword v96, v244, s[52:55], s4 offen sc1
    buffer_store_dword v97, v244, s[52:55], s5 offen sc1
    buffer_store_dword v98, v244, s[52:55], s6 offen sc1
    buffer_store_dword v99, v244, s[52:55], s7 offen sc1
    s_endpgm
L_fb1:
    s_cmp_eq_u32 s82, 0
    s_cbranch_scc0 L_ok1
    s_mov_b32 s84, 0
    s_branch L_fallback
L_pwait:
L_pw_42:
    ds_read_b32 v235, v244
    ds_read_b64 v[238:239], v243 offset:6144
    ds_read_b128 v[8:11], v242 offset:2048
    ds_read_b128 v[24:27], v242 offset:5120
    ds_read_b128 v[0:3], v242 offset:0
    ds_read_b128 v[4:7], v242 offset:1024
    ds_read_b128 v[16:19], v242 offset:3072
    ds_read_b128 v[20:23], v242 offset:4096
    s_sub_u32 s96, s96, 1
    s_cbranch_scc1 L_exit
    s_waitcnt lgkmcnt(7)
    v_cmp_gt_u32 vcc, 6, v235
    s_cbranch_vccnz L_pw_42
    s_waitcnt lgkmcnt(0)
    s_branch L_pready
L_fallback:
    s_mov_b32 s82, 1
    s_waitcnt vmcnt(0) lgkmcnt(0)
    v_mov_b32 v232, 0
    v_cndmask_b32 v200, v200, v232, s[94:95]
    v_mov_b32 v220, 0xff800000
    v_cndmask_b32 v202, v202, v232, s[94:95]
    v_mov_b32 v221, 0xff800000
    v_cndmask_b32 v204, v204, v232, s[94:95]
    v_mov_b32 v222, 0xff800000
    v_cndmask_b32 v206, v206, v232, s[94:95]
    v_mov_b32 v223, 0xff800000
    s_mov_b32 s80, s70
    s_mov_b32 s83, 16
L_maxloop:
    buffer_load_dwordx4 v[128:131], v208, s[48:51], s80 offen offset:0 sc1
    buffer_load_dwordx4 v[132:135], v208, s[48:51], s80 offen offset:512 sc1
    buffer_load_dwordx4 v[136:139], v209, s[48:51], s80 offen sc1
    s_waitcnt vmcnt(0)
    v_mfma_f32_32x32x16_bf16 v[64:79], v[128:131], v[184:187], 0
    v_mfma_f32_32x32x8bf16_1k v[64:79], v[136:137], v[200:201], v[64:79]
    v_mfma_f32_32x32x16_bf16 v[80:95], v[128:131], v[188:191], 0
    v_mfma_f32_32x32x8bf16_1k v[80:95], v[136:137], v[202:203], v[80:95]
    v_mfma_f32_32x32x16_bf16 v[96:111], v[128:131], v[192:195], 0
    v_mfma_f32_32x32x8bf16_1k v[96:111], v[136:137], v[204:205], v[96:111]
    v_mfma_f32_32x32x16_bf16 v[112:127], v[128:131], v[196:199], 0
    v_mfma_f32_32x32x8bf16_1k v[112:127], v[136:137], v[206:207], v[112:127]
    s_nop 5
    v_max3_f32 v220, v220, v64, v65
    v_max3_f32 v220, v220, v66, v67
    v_max3_f32 v220, v220, v68, v69
    v_max3_f32 v220, v220, v70, v71
    v_max3_f32 v220, v220, v72, v73
    v_max3_f32 v220, v220, v74, v75
    v_max3_f32 v220, v220, v76, v77
    v_max3_f32 v220, v220, v78, v79
    v_max3_f32 v221, v221, v80, v81
    v_max3_f32 v221, v221, v82, v83
    v_max3_f32 v221, v221, v84, v85
    v_max3_f32 v221, v221, v86, v87
    v_max3_f32 v221, v221, v88, v89
    v_max3_f32 v221, v221, v90, v91
    v_max3_f32 v221, v221, v92, v93
    v_max3_f32 v221, v221, v94, v95
    v_max3_f32 v222, v222, v96, v97
    v_max3_f32 v222, v222, v98, v99
    v_max3_f32 v222, v222, v100, v101
    v_max3_f32 v222, v222, v102, v103
    v_max3_f32 v222, v222, v104, v105
    v_max3_f32 v222, v222, v106, v107
    v_max3_f32 v222, v222, v108, v109
    v_max3_f32 v222, v222, v110, v111
    v_max3_f32 v223, v223, v112, v113
    v_max3_f32 v223, v223, v114, v115
    v_max3_f32 v223, v223, v116, v117
    v_max3_f32 v223, v223, v118, v119
    v_max3_f32 v223, v223, v120, v121
    v_max3_f32 v223, v223, v122, v123
    v_max3_f32 v223, v223, v124, v125
    v_max3_f32 v223, v223, v126, v127
    v_mfma_f32_32x32x16_bf16 v[64:79], v[132:135], v[184:187], 0
    v_mfma_f32_32x32x8bf16_1k v[64:79], v[138:139], v[200:201], v[64:79]
    v_mfma_f32_32x32x16_bf16 v[80:95], v[132:135], v[188:191], 0
    v_mfma_f32_32x32x8bf16_1k v[80:95], v[138:139], v[202:203], v[80:95]
    v_mfma_f32_32x32x16_bf16 v[96:111], v[132:135], v[192:195], 0
    v_mfma_f32_32x32x8bf16_1k v[96:111], v[138:139], v[204:205], v[96:111]
    v_mfma_f32_32x32x16_bf16 v[112:127], v[132:135], v[196:199], 0
    v_mfma_f32_32x32x8bf16_1k v[112:127], v[138:139], v[206:207], v[112:127]
    s_nop 5
    v_max3_f32 v220, v220, v64, v65
    v_max3_f32 v220, v220, v66, v67
    v_max3_f32 v220, v220, v68, v69
    v_max3_f32 v220, v220, v70, v71
    v_max3_f32 v220, v220, v72, v73
    v_max3_f32 v220, v220, v74, v75
    v_max3_f32 v220, v220, v76, v77
    v_max3_f32 v220, v220, v78, v79
    v_max3_f32 v221, v221, v80, v81
    v_max3_f32 v221, v221, v82, v83
    v_max3_f32 v221, v221, v84, v85
    v_max3_f32 v221, v221, v86, v87
    v_max3_f32 v221, v221, v88, v89
    v_max3_f32 v221, v221, v90, v91
    v_max3_f32 v221, v221, v92, v93
    v_max3_f32 v221, v221, v94, v95
    v_max3_f32 v222, v222, v96, v97
    v_max3_f32 v222, v222, v98, v99
    v_max3_f32 v222, v222, v100, v101
    v_max3_f32 v222, v222, v102, v103
    v_max3_f32 v222, v222, v104, v105
    v_max3_f32 v222, v222, v106, v107
    v_max3_f32 v222, v222, v108, v109
    v_max3_f32 v222, v222, v110, v111
    v_max3_f32 v223, v223, v112, v113
    v_max3_f32 v223, v223, v114, v115
    v_max3_f32 v223, v223, v116, v117
    v_max3_f32 v223, v223, v118, v119
    v_max3_f32 v223, v223, v120, v121
    v_max3_f32 v223, v223, v122, v123
    v_max3_f32 v223, v223, v124, v125
    v_max3_f32 v223, v223, v126, v127
    s_add_u32 s80, s80, 247808
    s_sub_u32 s83, s83, 1
    s_cmp_lg_u32 s83, 0
    s_cbranch_scc1 L_maxloop
    v_mov_b32 v0, 0
    v_mov_b32 v1, 0
    v_mov_b32 v2, 0
    v_mov_b32 v3, 0
    v_mov_b32 v4, 0
    v_mov_b32 v5, 0
    v_mov_b32 v6, 0
    v_mov_b32 v7, 0
    v_mov_b32 v8, 0
    v_mov_b32 v9, 0
    v_mov_b32 v10, 0
    v_mov_b32 v11, 0
    v_mov_b32 v12, 0
    v_mov_b32 v13, 0
    v_mov_b32 v14, 0
    v_mov_b32 v15, 0
    v_mov_b32 v16, 0
    v_mov_b32 v17, 0
    v_mov_b32 v18, 0
    v_mov_b32 v19, 0
    v_mov_b32 v20, 0
    v_mov_b32 v21, 0
    v_mov_b32 v22, 0
    v_mov_b32 v23, 0
    v_mov_b32 v24, 0
    v_mov_b32 v25, 0
    v_mov_b32 v26, 0
    v_mov_b32 v27, 0
    v_mov_b32 v28, 0
    v_mov_b32 v29, 0
    v_mov_b32 v30, 0
    v_mov_b32 v31, 0
    v_mov_b32 v32, 0
    v_mov_b32 v33, 0
    v_mov_b32 v34, 0
    v_mov_b32 v35, 0
    v_mov_b32 v36, 0
    v_mov_b32 v37, 0
    v_mov_b32 v38, 0
    v_mov_b32 v39, 0
    v_mov_b32 v40, 0
    v_mov_b32 v41, 0
    v_mov_b32 v42, 0
    v_mov_b32 v43, 0
    v_mov_b32 v44, 0
    v_mov_b32 v45, 0
    v_mov_b32 v46, 0
    v_mov_b32 v47, 0
    v_mov_b32 v48, 0
    v_mov_b32 v49, 0
    v_mov_b32 v50, 0
    v_mov_b32 v51, 0
    v_mov_b32 v52, 0
    v_mov_b32 v53, 0
    v_mov_b32 v54, 0
    v_mov_b32 v55, 0
    v_mov_b32 v56, 0
    v_mov_b32 v57, 0
    v_mov_b32 v58, 0
    v_mov_b32 v59, 0
    v_mov_b32 v60, 0
    v_mov_b32 v61, 0
    v_mov_b32 v62, 0
    v_mov_b32 v63, 0
    s_branch L_attload
L_setc:
    v_mov_b32 v232, v220
    v_mov_b32 v233, v221
    v_mov_b32 v234, v222
    v_mov_b32 v235, v223
    v_permlane32_swap_b32 v220, v232
    v_permlane32_swap_b32 v221, v233
    v_permlane32_swap_b32 v222, v234
    v_permlane32_swap_b32 v223, v235
    v_min_f32 v220, -v220, -v232
    v_min_f32 v221, -v221, -v233
    v_min_f32 v222, -v222, -v234
    v_min_f32 v223, -v223, -v235
    v_cvt_pk_bf16_f32 v232, v220, v220
    v_cvt_pk_bf16_f32 v233, v221, v221
    v_cvt_pk_bf16_f32 v234, v222, v222
    v_cvt_pk_bf16_f32 v235, v223, v223
    v_and_b32 v232, 0xffff0000, v232
    v_and_b32 v233, 0xffff0000, v233
    v_and_b32 v234, 0xffff0000, v234
    v_and_b32 v235, 0xffff0000, v235
    v_sub_f32 v220, v220, v232
    v_sub_f32 v221, v221, v233
    v_sub_f32 v222, v222, v234
    v_sub_f32 v223, v223, v235
    v_cvt_pk_bf16_f32 v220, v232, v220
    v_cvt_pk_bf16_f32 v221, v233, v221
    v_cvt_pk_bf16_f32 v222, v234, v222
    v_cvt_pk_bf16_f32 v223, v235, v223
    v_cndmask_b32 v200, v200, v220, s[94:95]
    v_cndmask_b32 v202, v202, v221, s[94:95]
    v_cndmask_b32 v204, v204, v222, s[94:95]
    v_cndmask_b32 v206, v206, v223, s[94:95]
    v_mfma_f32_32x32x16_bf16 v[64:79], v[128:131], v[184:187], 0
    v_mfma_f32_32x32x8bf16_1k v[64:79], v[136:137], v[200:201], v[64:79]
    v_and_b32 v220, 0xffff0000, v220
    v_and_b32 v221, 0xffff0000, v221
    v_and_b32 v222, 0xffff0000, v222
    v_and_b32 v223, 0xffff0000, v223
    v_add_f32 v216, v220, v232
    v_add_f32 v217, v221, v233
    v_add_f32 v218, v222, v234
    v_add_f32 v219, v223, v235
    v_mov_b32 v120, 0
    v_mov_b32 v121, 0
    v_mov_b32 v122, 0
    v_mov_b32 v123, 0
    v_mov_b32 v124, 0
    v_mov_b32 v125, 0
    v_mov_b32 v126, 0
    v_mov_b32 v127, 0
    s_branch L_loopentry
L_fb2:
    s_cmp_eq_u32 s82, 0
    s_cbranch_scc0 L_ok2
    s_mov_b32 s84, 1
    s_branch L_fallback
L_pwr_45:
    s_sleep 1
    s_sub_u32 s96, s96, 1
    s_cbranch_scc0 L_pw_44
    s_endpgm
L_codeend:
.section .rodata,"a"
.p2align 6
.amdhsa_kernel concat_heads__mha_block__ssm_conv_s5__prompt_kernel
  .amdhsa_next_free_vgpr 256
  .amdhsa_next_free_sgpr 102
  .amdhsa_accum_offset 256
  .amdhsa_group_segment_fixed_size 0
  .amdhsa_kernarg_size 120
  .amdhsa_user_sgpr_count 2
  .amdhsa_user_sgpr_kernarg_segment_ptr 1
  .amdhsa_system_sgpr_workgroup_id_x 1
.end_amdhsa_kernel
```
